```python
import torch

def _softmax(x, axis=-1):
    return torch.softmax(x, dim=axis)
def _gelu(x):
    return torch.nn.functional.gelu(x, approximate="tanh")
def _silu(x):
    return torch.nn.functional.silu(x)
def _sigmoid(x):
    return torch.sigmoid(x)
def _layernorm(x, axis=-1, eps=1e-5):
    m = x.mean(dim=axis, keepdim=True)
    v = x.var(dim=axis, keepdim=True, unbiased=False)
    return (x - m) / torch.sqrt(v + eps)
def _scatter_add(tgt, idx, src, axis=0):
    return tgt.clone().index_add_(axis, idx, src)
def _segment_sum(src, seg, n):
    out = torch.zeros((n,) + src.shape[1:], dtype=src.dtype)
    return out.index_add_(0, seg, src)
def _pad(x, pw):
    flat = tuple(v for pair in reversed(pw) for v in pair)
    return torch.nn.functional.pad(x, flat)

kernel_name = 'recurrent_scan__softmax_full_mha__glu_gated_bilinear__prompt'

def setup_inputs():

    _w = (lambda a: (lambda t: t.to(torch.bfloat16) if t.is_floating_point() else t)(torch.as_tensor(a)))
    def _A_setup():
        B, S, D = 1, 2048, 576
        return {
            "x": _w((lambda *s: torch.randn(*s, dtype=torch.bfloat16) * 0.05)(B, S, D)),
            "wqkv": _w((lambda *s: torch.randn(*s, dtype=torch.bfloat16) * 0.2)(D, 3 * D)),
            "wo": _w((lambda *s: torch.randn(*s, dtype=torch.bfloat16) * 0.2)(D, D)),
        }
    _A_in = _A_setup()

    def _B_setup():
        B, S, D, F = 1, 2048, 576, 4608
        return {
            "x": _w((lambda *s: torch.randn(*s, dtype=torch.bfloat16) * 0.05)(B, S, D)),
            "w_gate": _w((lambda *s: torch.randn(*s, dtype=torch.bfloat16) * 0.1)(D, F) * (D ** -0.5)),
            "w_up": _w((lambda *s: torch.randn(*s, dtype=torch.bfloat16) * 0.1)(D, F) * (D ** -0.5)),
            "w_down": _w((lambda *s: torch.randn(*s, dtype=torch.bfloat16) * 0.1)(F, D) * (F ** -0.5)),
        }
    _B_in = _B_setup()

    return {
        "A_x": _A_in["x"],
        "A_wqkv": _A_in["wqkv"],
        "A_wo": _A_in["wo"],
        "B_x": _B_in["x"],
        "B_w_gate": _B_in["w_gate"],
        "B_w_up": _B_in["w_up"],
        "B_w_down": _B_in["w_down"],
    }

def reference(A_x, A_wqkv, A_wo, B_x, B_w_gate, B_w_up, B_w_down):
    def _A_ref(x, wqkv, wo):
        B, S, D = x.shape
        H = 32; Dh = D // H
        qkv = (lambda x, *d: x.permute(*d))((x @ wqkv).reshape(B, S, 3, H, Dh), 2, 0, 3, 1, 4)
        q, k, v = qkv[0], qkv[1], qkv[2]
        scale = Dh ** -0.5
        scores = torch.einsum("bhqd,bhkd->bhqk", q, k) * scale
        p = _softmax(scores, axis=-1)
        o = torch.einsum("bhqk,bhkd->bhqd", p, v)
        return (lambda x, *d: x.permute(*d))(o, 0, 2, 1, 3).reshape(B, S, D) @ wo

    def _B_ref(x, w_gate, w_up, w_down):
        g = torch.einsum("bsd,df->bsf", x, w_gate)
        u = torch.einsum("bsd,df->bsf", x, w_up)
        h = g * u
        return torch.einsum("bsf,fd->bsd", h, w_down)

    x = A_x
    xn = _layernorm(x, axis=-1)
    s = _A_ref(xn, A_wqkv, A_wo)
    g = _silu(_B_ref(xn, B_w_gate, B_w_up, B_w_down))
    return x + s * g
```

```asm
; @launch grid=(256,1,1) block=(256,1,1) lds=163840
.amdgcn_target "amdgcn-amd-amdhsa--gfx950"
.text
.globl recurrent_scan__softmax_full_mha__glu_gated_bilinear__prompt_kernel
.p2align 8
.type recurrent_scan__softmax_full_mha__glu_gated_bilinear__prompt_kernel,@function
recurrent_scan__softmax_full_mha__glu_gated_bilinear__prompt_kernel:
    s_load_dword s66, s[0:1], 0
    s_load_dword s67, s[0:1], 64
    s_cmp_ge_u32 s2, 256
    s_cbranch_scc1 L_mid_exit
    s_getpc_b64 s[60:61]
L_pc0:
    s_mov_b32 s62, L_code_end-L_pc0
    s_mov_b32 s63, 0x00020000
    s_lshr_b32 s50, s2, 3
    s_lshl_b32 s50, s50, 11
    v_lshlrev_b32 v254, 7, v0
    v_add_u32 v254, s50, v254
    v_cmp_gt_u32 vcc, 16, v0
    s_and_saveexec_b64 s[64:65], vcc
    buffer_load_dword a255, v254, s[60:63], 0 offen
    s_mov_b64 exec, s[64:65]
    s_lshr_b32 s50, s2, 3
    s_bfe_u32 s51, s50, 0x10001
    s_lshr_b32 s52, s50, 2
    s_lshl_b32 s52, s52, 1
    s_and_b32 s50, s50, 1
    s_or_b32 s50, s50, s52
    s_lshl_b32 s50, s50, 3
    s_lshl_b32 s51, s51, 7
    s_and_b32 s2, s2, 7
    s_or_b32 s2, s2, s50
    s_or_b32 s2, s2, s51
    s_cmp_ge_u32 s2, 128
    s_cbranch_scc1 L_mid_mlp
    v_mov_b32 v255, v0
    s_and_b32 s50, s2, 7
    s_lshr_b32 s51, s2, 3
    s_and_b32 s51, s51, 15
    s_and_b32 s52, s50, 1
    s_lshl_b32 s52, s52, 3
    s_and_b32 s53, s51, 7
    s_add_u32 s44, s52, s53
    s_lshr_b32 s52, s50, 1
    s_lshl_b32 s52, s52, 1
    s_lshr_b32 s53, s51, 3
    s_add_u32 s45, s52, s53
    s_load_dwordx2 s[4:5], s[0:1], 0
    s_load_dwordx2 s[8:9], s[0:1], 8
    s_load_dwordx2 s[12:13], s[0:1], 72
    v_lshrrev_b32 v184, 6, v0
    v_and_b32 v182, 63, v0
    s_nop 0
    v_readfirstlane_b32 s37, v184
    v_lshrrev_b32 v184, 3, v182
    v_lshrrev_b32 v185, 4, v182
    v_and_b32 v186, 7, v182
    v_xor_b32 v185, v185, v186
    v_lshlrev_b32 v185, 4, v185
    v_mul_u32_u24 v184, 1152, v184
    v_add_u32 v178, v184, v185
    v_xor_b32 v185, 64, v185
    v_add_u32 v179, v184, v185
    v_add_u32 v179, 9216, v179
    v_and_b32 v184, 15, v182
    v_lshrrev_b32 v185, 1, v184
    v_lshrrev_b32 v186, 4, v182
    v_xor_b32 v185, v185, v186
    v_lshlrev_b32 v185, 4, v185
    v_lshlrev_b32 v184, 7, v184
    v_add_u32 v180, v184, v185
    s_mul_i32 s36, s37, 18432
    s_add_u32 s36, s36, 0
    v_add_u32 v180, s36, v180
    v_xor_b32 v181, 64, v180
    s_mul_i32 s53, s44, 147456
    s_mul_i32 s40, s37, 36864
    s_add_u32 s53, s53, s40
    s_waitcnt lgkmcnt(0)
    s_mov_b32 s6, 2359296
    s_mov_b32 s7, 0x00020000
    s_mov_b32 s10, 1990656
    s_mov_b32 s11, 0x00020000
    s_mov_b32 s14, 268435456
    s_mov_b32 s15, 0x00020000
    s_add_u32 s54, s53, 0
    s_add_u32 m0, s36, 0
    s_nop 0
    buffer_load_dwordx4 v178, s[4:7], s54 offen  lds
    s_add_u32 m0, s36, 1024
    s_nop 0
    buffer_load_dwordx4 v179, s[4:7], s54 offen  lds
    s_add_u32 m0, s36, 2048
    s_add_u32 s54, s54, 128
    buffer_load_dwordx4 v178, s[4:7], s54 offen  lds
    s_add_u32 m0, s36, 3072
    s_nop 0
    buffer_load_dwordx4 v179, s[4:7], s54 offen  lds
    s_add_u32 m0, s36, 4096
    s_add_u32 s54, s54, 128
    buffer_load_dwordx4 v178, s[4:7], s54 offen  lds
    s_add_u32 m0, s36, 5120
    s_nop 0
    buffer_load_dwordx4 v179, s[4:7], s54 offen  lds
    s_add_u32 m0, s36, 6144
    s_add_u32 s54, s54, 128
    buffer_load_dwordx4 v178, s[4:7], s54 offen  lds
    s_add_u32 m0, s36, 7168
    s_nop 0
    buffer_load_dwordx4 v179, s[4:7], s54 offen  lds
    s_add_u32 m0, s36, 8192
    s_add_u32 s54, s54, 128
    buffer_load_dwordx4 v178, s[4:7], s54 offen  lds
    s_add_u32 m0, s36, 9216
    s_nop 0
    buffer_load_dwordx4 v179, s[4:7], s54 offen  lds
    s_add_u32 m0, s36, 10240
    s_add_u32 s54, s54, 128
    buffer_load_dwordx4 v178, s[4:7], s54 offen  lds
    s_add_u32 m0, s36, 11264
    s_nop 0
    buffer_load_dwordx4 v179, s[4:7], s54 offen  lds
    s_add_u32 m0, s36, 12288
    s_add_u32 s54, s54, 128
    buffer_load_dwordx4 v178, s[4:7], s54 offen  lds
    s_add_u32 m0, s36, 13312
    s_nop 0
    buffer_load_dwordx4 v179, s[4:7], s54 offen  lds
    s_add_u32 m0, s36, 14336
    s_add_u32 s54, s54, 128
    buffer_load_dwordx4 v178, s[4:7], s54 offen  lds
    s_add_u32 m0, s36, 15360
    s_nop 0
    buffer_load_dwordx4 v179, s[4:7], s54 offen  lds
    s_add_u32 m0, s36, 16384
    s_add_u32 s54, s54, 128
    buffer_load_dwordx4 v178, s[4:7], s54 offen  lds
    s_add_u32 m0, s36, 17408
    s_nop 0
    buffer_load_dwordx4 v179, s[4:7], s54 offen  lds
    s_add_u32 s54, s53, 18432
    s_add_u32 m0, s36, 73728
    s_nop 0
    buffer_load_dwordx4 v178, s[4:7], s54 offen  lds
    s_add_u32 m0, s36, 74752
    s_nop 0
    buffer_load_dwordx4 v179, s[4:7], s54 offen  lds
    s_add_u32 m0, s36, 75776
    s_add_u32 s54, s54, 128
    buffer_load_dwordx4 v178, s[4:7], s54 offen  lds
    s_add_u32 m0, s36, 76800
    s_nop 0
    buffer_load_dwordx4 v179, s[4:7], s54 offen  lds
    s_add_u32 m0, s36, 77824
    s_add_u32 s54, s54, 128
    buffer_load_dwordx4 v178, s[4:7], s54 offen  lds
    s_add_u32 m0, s36, 78848
    s_nop 0
    buffer_load_dwordx4 v179, s[4:7], s54 offen  lds
    s_add_u32 m0, s36, 79872
    s_add_u32 s54, s54, 128
    buffer_load_dwordx4 v178, s[4:7], s54 offen  lds
    s_add_u32 m0, s36, 80896
    s_nop 0
    buffer_load_dwordx4 v179, s[4:7], s54 offen  lds
    s_add_u32 m0, s36, 81920
    s_add_u32 s54, s54, 128
    buffer_load_dwordx4 v178, s[4:7], s54 offen  lds
    s_add_u32 m0, s36, 82944
    s_nop 0
    buffer_load_dwordx4 v179, s[4:7], s54 offen  lds
    s_add_u32 m0, s36, 83968
    s_add_u32 s54, s54, 128
    buffer_load_dwordx4 v178, s[4:7], s54 offen  lds
    s_add_u32 m0, s36, 84992
    s_nop 0
    buffer_load_dwordx4 v179, s[4:7], s54 offen  lds
    s_add_u32 m0, s36, 86016
    s_add_u32 s54, s54, 128
    buffer_load_dwordx4 v178, s[4:7], s54 offen  lds
    s_add_u32 m0, s36, 87040
    s_nop 0
    buffer_load_dwordx4 v179, s[4:7], s54 offen  lds
    s_add_u32 m0, s36, 88064
    s_add_u32 s54, s54, 128
    buffer_load_dwordx4 v178, s[4:7], s54 offen  lds
    s_add_u32 m0, s36, 89088
    s_nop 0
    buffer_load_dwordx4 v179, s[4:7], s54 offen  lds
    s_add_u32 m0, s36, 90112
    s_add_u32 s54, s54, 128
    buffer_load_dwordx4 v178, s[4:7], s54 offen  lds
    s_add_u32 m0, s36, 91136
    s_nop 0
    buffer_load_dwordx4 v179, s[4:7], s54 offen  lds
    v_lshrrev_b32 v184, 2, v182
    v_mul_u32_u24 v184, 1152, v184
    v_and_b32 v185, 3, v182
    v_lshlrev_b32 v185, 7, v185
    v_add_u32 v184, v184, v185
    s_add_u32 s42, s53, 18432
    s_mov_b32 m0, 155648
    v_mul_u32_u24 v184, 86, v182
    v_lshrrev_b32 v184, 8, v184
    v_mul_u32_u24 v185, 3, v184
    v_sub_u32 v185, v182, v185
    v_mul_u32_u24 v184, 3456, v184
    v_mul_u32_u24 v185, 1152, v185
    v_add_u32 v184, v184, v185
    v_mov_b32 v186, 0x80000000
    v_cmp_gt_u32 vcc, 54, v182
    s_nop 1
    v_cndmask_b32 v184, v186, v184, vcc
    s_and_b32 s42, s44, 7
    s_lshl_b32 s42, s42, 2
    s_add_u32 s42, s42, s37
    s_mul_i32 s42, s42, 62208
    s_mul_i32 s40, s45, 144
    s_add_u32 s42, s42, s40
    buffer_load_dword v184, s[8:11], s42 offen lds
    buffer_load_dword v184, s[8:11], s42 offen offset:140 lds
    s_lshl_b32 s42, s37, 6
    v_add_u32 v184, s42, v182
    v_mul_u32_u24 v185, 2185, v184
    v_lshrrev_b32 v185, 16, v185
    v_mul_u32_u24 v186, 30, v185
    v_sub_u32 v186, v184, v186
    v_mul_u32_u24 v187, 26, v186
    v_lshrrev_b32 v187, 8, v187
    v_mul_u32_u24 v188, 10, v187
    v_sub_u32 v186, v186, v188
    v_min_u32 v186, 8, v186
    v_lshlrev_b32 v186, 4, v186
    v_mul_u32_u24 v187, 1152, v187
    v_add_u32 v186, v186, v187
    v_bfe_u32 v187, v185, 2, 2
    v_lshlrev_b32 v187, 3, v187
    v_lshrrev_b32 v188, 4, v185
    v_lshlrev_b32 v188, 2, v188
    v_add_u32 v187, v187, v188
    v_and_b32 v188, 3, v185
    v_add_u32 v187, v187, v188
    v_mul_u32_u24 v187, 3456, v187
    v_add_u32 v174, v186, v187
    v_add_u32 v184, s42, v182
    v_add_u32 v184, 256, v184
    v_mul_u32_u24 v185, 2185, v184
    v_lshrrev_b32 v185, 16, v185
    v_mul_u32_u24 v186, 30, v185
    v_sub_u32 v186, v184, v186
    v_mul_u32_u24 v187, 26, v186
    v_lshrrev_b32 v187, 8, v187
    v_mul_u32_u24 v188, 10, v187
    v_sub_u32 v186, v186, v188
    v_min_u32 v186, 8, v186
    v_lshlrev_b32 v186, 4, v186
    v_mul_u32_u24 v187, 1152, v187
    v_add_u32 v186, v186, v187
    v_bfe_u32 v187, v185, 2, 2
    v_lshlrev_b32 v187, 3, v187
    v_lshrrev_b32 v188, 4, v185
    v_lshlrev_b32 v188, 2, v188
    v_add_u32 v187, v187, v188
    v_and_b32 v188, 3, v185
    v_add_u32 v187, v187, v188
    v_mul_u32_u24 v187, 3456, v187
    v_add_u32 v175, v186, v187
    v_add_u32 v184, s42, v182
    v_add_u32 v184, 512, v184
    v_mul_u32_u24 v185, 2185, v184
    v_lshrrev_b32 v185, 16, v185
    v_mul_u32_u24 v186, 30, v185
    v_sub_u32 v186, v184, v186
    v_mul_u32_u24 v187, 26, v186
    v_lshrrev_b32 v187, 8, v187
    v_mul_u32_u24 v188, 10, v187
    v_sub_u32 v186, v186, v188
    v_min_u32 v186, 8, v186
    v_lshlrev_b32 v186, 4, v186
    v_mul_u32_u24 v187, 1152, v187
    v_add_u32 v186, v186, v187
    v_bfe_u32 v187, v185, 2, 2
    v_lshlrev_b32 v187, 3, v187
    v_lshrrev_b32 v188, 4, v185
    v_lshlrev_b32 v188, 2, v188
    v_add_u32 v187, v187, v188
    v_and_b32 v188, 3, v185
    v_add_u32 v187, v187, v188
    v_mul_u32_u24 v187, 3456, v187
    v_add_u32 v176, v186, v187
    v_add_u32 v184, s42, v182
    v_add_u32 v184, 768, v184
    v_mul_u32_u24 v185, 2185, v184
    v_lshrrev_b32 v185, 16, v185
    v_mul_u32_u24 v186, 30, v185
    v_sub_u32 v186, v184, v186
    v_mul_u32_u24 v187, 26, v186
    v_lshrrev_b32 v187, 8, v187
    v_mul_u32_u24 v188, 10, v187
    v_sub_u32 v186, v186, v188
    v_min_u32 v186, 8, v186
    v_lshlrev_b32 v186, 4, v186
    v_mul_u32_u24 v187, 1152, v187
    v_add_u32 v186, v186, v187
    v_bfe_u32 v187, v185, 2, 2
    v_lshlrev_b32 v187, 3, v187
    v_lshrrev_b32 v188, 4, v185
    v_lshlrev_b32 v188, 2, v188
    v_add_u32 v187, v187, v188
    v_and_b32 v188, 3, v185
    v_add_u32 v187, v187, v188
    v_mul_u32_u24 v187, 3456, v187
    v_add_u32 v177, v186, v187
    v_lshrrev_b32 v184, 2, v182
    v_mul_u32_u24 v184, 480, v184
    v_and_b32 v185, 3, v182
    v_lshlrev_b32 v186, 3, v185
    v_add_u32 v168, v184, v186
    v_lshrrev_b32 v186, 1, v185
    v_mul_u32_u24 v186, 160, v186
    v_and_b32 v185, 1, v185
    v_mul_u32_u24 v185, 72, v185
    v_add3_u32 v171, v184, v185, v186
    v_add_u32 v171, 32, v171
    v_add_u32 v169, 65536, v168
    v_add_u32 v172, 65536, v171
    v_add_u32 v170, 131072, v168
    v_add_u32 v173, 131072, v171
    s_mov_b32 s39, 0x3f803f80
    s_mul_i32 s46, s45, 144
    s_lshl_b32 s47, s37, 10
    v_and_b32 v192, 15, v182
    v_lshrrev_b32 v193, 4, v182
    v_lshrrev_b32 v194, 2, v192
    v_cmp_eq_u32 vcc, v194, v193
    v_and_b32 v195, 1, v192
    v_lshlrev_b32 v195, 4, v195
    v_mov_b32 v196, 0x3f80
    v_lshlrev_b32 v196, v195, v196
    v_cndmask_b32 v196, 0, v196, vcc
    v_and_b32 v195, 2, v192
    v_cmp_eq_u32 vcc, 0, v195
    v_mov_b32 v144, 0
    v_mov_b32 v145, 0
    v_cndmask_b32 v146, 0, v196, vcc
    v_mov_b32 v148, 0
    v_mov_b32 v149, 0
    v_sub_u32 v147, v196, v146
    v_mov_b32 v152, 0x3f803f80
    v_mov_b32 v153, 0x3f803f80
    v_mov_b32 v154, 0x3f803f80
    v_mov_b32 v155, 0x3f803f80
    s_waitcnt vmcnt(20)
    ds_read_b128 v[0:3], v180 offset:0
    ds_read_b128 v[4:7], v181 offset:0
    ds_read_b128 v[8:11], v180 offset:2048
    ds_read_b128 v[12:15], v181 offset:2048
    ds_read_b128 v[16:19], v180 offset:4096
    ds_read_b128 v[20:23], v181 offset:4096
    ds_read_b128 v[24:27], v180 offset:6144
    ds_read_b128 v[28:31], v181 offset:6144
    ds_read_b128 v[32:35], v180 offset:8192
    ds_read_b128 v[36:39], v181 offset:8192
    ds_read_b128 v[40:43], v180 offset:10240
    ds_read_b128 v[44:47], v181 offset:10240
    ds_read_b128 v[48:51], v180 offset:12288
    ds_read_b128 v[52:55], v181 offset:12288
    ds_read_b128 v[56:59], v180 offset:14336
    ds_read_b128 v[60:63], v181 offset:14336
    ds_read_b128 v[64:67], v180 offset:16384
    ds_read_b128 v[68:71], v181 offset:16384
    s_waitcnt lgkmcnt(15)
    v_mfma_f32_16x16x32_bf16 v[156:159], v[152:155], v[0:3], 0
    v_mfma_f32_16x16x32_bf16 v[156:159], v[152:155], v[4:7], v[156:159]
    v_mfma_f32_16x16x32_bf16 v[156:159], v[152:155], v[8:11], v[156:159]
    s_waitcnt lgkmcnt(12)
    v_mfma_f32_16x16x32_bf16 v[156:159], v[152:155], v[12:15], v[156:159]
    v_mfma_f32_16x16x32_bf16 v[156:159], v[152:155], v[16:19], v[156:159]
    v_mfma_f32_16x16x32_bf16 v[156:159], v[152:155], v[20:23], v[156:159]
    s_waitcnt lgkmcnt(9)
    v_mfma_f32_16x16x32_bf16 v[156:159], v[152:155], v[24:27], v[156:159]
    v_mfma_f32_16x16x32_bf16 v[156:159], v[152:155], v[28:31], v[156:159]
    v_mfma_f32_16x16x32_bf16 v[156:159], v[152:155], v[32:35], v[156:159]
    s_waitcnt lgkmcnt(6)
    v_mfma_f32_16x16x32_bf16 v[156:159], v[152:155], v[36:39], v[156:159]
    v_mfma_f32_16x16x32_bf16 v[156:159], v[152:155], v[40:43], v[156:159]
    v_mfma_f32_16x16x32_bf16 v[156:159], v[152:155], v[44:47], v[156:159]
    s_waitcnt lgkmcnt(3)
    v_mfma_f32_16x16x32_bf16 v[156:159], v[152:155], v[48:51], v[156:159]
    v_mfma_f32_16x16x32_bf16 v[156:159], v[152:155], v[52:55], v[156:159]
    v_mfma_f32_16x16x32_bf16 v[156:159], v[152:155], v[56:59], v[156:159]
    s_waitcnt lgkmcnt(0)
    v_mfma_f32_16x16x32_bf16 v[156:159], v[152:155], v[60:63], v[156:159]
    v_mfma_f32_16x16x32_bf16 v[156:159], v[152:155], v[64:67], v[156:159]
    v_mfma_f32_16x16x32_bf16 v[156:159], v[152:155], v[68:71], v[156:159]
    s_barrier
    s_nop 6
    v_mul_f32 v156, 0xbae38e39, v156
    s_add_u32 m0, s47, 0
    s_nop 0
    buffer_load_dwordx4 v174, s[8:11], s46 offen  lds
    s_nop 2
    v_mul_f32 v157, 0xbae38e39, v157
    s_nop 1
    v_mul_f32 v158, 0xbae38e39, v158
    s_nop 0
    v_mul_f32 v159, 0xbae38e39, v159
    s_nop 1
    v_mfma_f32_16x16x32_bf16 v[184:187], v[146:149], v[0:3], v[156:159]
    s_nop 0
    v_mfma_f32_16x16x32_bf16 v[188:191], v[144:147], v[0:3], v[156:159]
    v_mfma_f32_16x16x32_bf16 v[192:195], v[146:149], v[4:7], v[156:159]
    s_add_u32 m0, s47, 4096
    s_nop 0
    buffer_load_dwordx4 v175, s[8:11], s46 offen  lds
    v_mfma_f32_16x16x32_bf16 v[196:199], v[144:147], v[4:7], v[156:159]
    v_mfma_f32_16x16x32_bf16 v[200:203], v[146:149], v[8:11], v[156:159]
    v_mfma_f32_16x16x32_bf16 v[204:207], v[144:147], v[8:11], v[156:159]
    v_cvt_pk_bf16_f32 v0, v184, v185
    v_cvt_pk_bf16_f32 v1, v186, v187
    v_cvt_pk_bf16_f32 v2, v188, v189
    v_cvt_pk_bf16_f32 v3, v190, v191
    s_add_u32 m0, s47, 8192
    s_nop 0
    buffer_load_dwordx4 v176, s[8:11], s46 offen  lds
    v_mfma_f32_16x16x32_bf16 v[184:187], v[146:149], v[12:15], v[156:159]
    v_mfma_f32_16x16x32_bf16 v[188:191], v[144:147], v[12:15], v[156:159]
    v_cvt_pk_bf16_f32 v4, v192, v193
    v_cvt_pk_bf16_f32 v5, v194, v195
    v_cvt_pk_bf16_f32 v6, v196, v197
    v_cvt_pk_bf16_f32 v7, v198, v199
    s_add_u32 m0, s47, 12288
    s_nop 0
    buffer_load_dwordx4 v177, s[8:11], s46 offen  lds
    s_add_u32 s46, s46, 110592
    v_mfma_f32_16x16x32_bf16 v[192:195], v[146:149], v[16:19], v[156:159]
    v_mfma_f32_16x16x32_bf16 v[196:199], v[144:147], v[16:19], v[156:159]
    v_cvt_pk_bf16_f32 v8, v200, v201
    v_cvt_pk_bf16_f32 v9, v202, v203
    v_cvt_pk_bf16_f32 v10, v204, v205
    v_cvt_pk_bf16_f32 v11, v206, v207
    v_mfma_f32_16x16x32_bf16 v[200:203], v[146:149], v[20:23], v[156:159]
    s_add_u32 m0, s47, 16384
    s_nop 0
    buffer_load_dwordx4 v174, s[8:11], s46 offen  lds
    v_mfma_f32_16x16x32_bf16 v[204:207], v[144:147], v[20:23], v[156:159]
    v_cvt_pk_bf16_f32 v12, v184, v185
    v_cvt_pk_bf16_f32 v13, v186, v187
    v_cvt_pk_bf16_f32 v14, v188, v189
    v_cvt_pk_bf16_f32 v15, v190, v191
    v_mfma_f32_16x16x32_bf16 v[184:187], v[146:149], v[24:27], v[156:159]
    s_add_u32 m0, s47, 20480
    s_nop 0
    buffer_load_dwordx4 v175, s[8:11], s46 offen  lds
    v_mfma_f32_16x16x32_bf16 v[188:191], v[144:147], v[24:27], v[156:159]
    v_cvt_pk_bf16_f32 v16, v192, v193
    v_cvt_pk_bf16_f32 v17, v194, v195
    v_cvt_pk_bf16_f32 v18, v196, v197
    v_cvt_pk_bf16_f32 v19, v198, v199
    v_mfma_f32_16x16x32_bf16 v[192:195], v[146:149], v[28:31], v[156:159]
    v_mfma_f32_16x16x32_bf16 v[196:199], v[144:147], v[28:31], v[156:159]
    s_add_u32 m0, s47, 24576
    s_nop 0
    buffer_load_dwordx4 v176, s[8:11], s46 offen  lds
    v_cvt_pk_bf16_f32 v20, v200, v201
    v_cvt_pk_bf16_f32 v21, v202, v203
    v_cvt_pk_bf16_f32 v22, v204, v205
    v_cvt_pk_bf16_f32 v23, v206, v207
    v_mfma_f32_16x16x32_bf16 v[200:203], v[146:149], v[32:35], v[156:159]
    v_mfma_f32_16x16x32_bf16 v[204:207], v[144:147], v[32:35], v[156:159]
    v_cvt_pk_bf16_f32 v24, v184, v185
    s_add_u32 m0, s47, 28672
    s_nop 0
    buffer_load_dwordx4 v177, s[8:11], s46 offen  lds
    s_add_u32 s46, s46, 110592
    v_cvt_pk_bf16_f32 v25, v186, v187
    v_cvt_pk_bf16_f32 v26, v188, v189
    v_cvt_pk_bf16_f32 v27, v190, v191
    v_mfma_f32_16x16x32_bf16 v[184:187], v[146:149], v[36:39], v[156:159]
    v_mfma_f32_16x16x32_bf16 v[188:191], v[144:147], v[36:39], v[156:159]
    v_cvt_pk_bf16_f32 v28, v192, v193
    s_add_u32 m0, s47, 32768
    s_nop 0
    buffer_load_dwordx4 v174, s[8:11], s46 offen  lds
    v_cvt_pk_bf16_f32 v29, v194, v195
    v_cvt_pk_bf16_f32 v30, v196, v197
    v_cvt_pk_bf16_f32 v31, v198, v199
    v_mfma_f32_16x16x32_bf16 v[192:195], v[146:149], v[40:43], v[156:159]
    v_mfma_f32_16x16x32_bf16 v[196:199], v[144:147], v[40:43], v[156:159]
    v_cvt_pk_bf16_f32 v32, v200, v201
    v_cvt_pk_bf16_f32 v33, v202, v203
    s_add_u32 m0, s47, 36864
    s_nop 0
    buffer_load_dwordx4 v175, s[8:11], s46 offen  lds
    v_cvt_pk_bf16_f32 v34, v204, v205
    v_cvt_pk_bf16_f32 v35, v206, v207
    v_mfma_f32_16x16x32_bf16 v[200:203], v[146:149], v[44:47], v[156:159]
    v_mfma_f32_16x16x32_bf16 v[204:207], v[144:147], v[44:47], v[156:159]
    v_cvt_pk_bf16_f32 v36, v184, v185
    v_cvt_pk_bf16_f32 v37, v186, v187
    s_add_u32 m0, s47, 40960
    s_nop 0
    buffer_load_dwordx4 v176, s[8:11], s46 offen  lds
    v_cvt_pk_bf16_f32 v38, v188, v189
    v_cvt_pk_bf16_f32 v39, v190, v191
    v_mfma_f32_16x16x32_bf16 v[184:187], v[146:149], v[48:51], v[156:159]
    v_mfma_f32_16x16x32_bf16 v[188:191], v[144:147], v[48:51], v[156:159]
    v_cvt_pk_bf16_f32 v40, v192, v193
    v_cvt_pk_bf16_f32 v41, v194, v195
    v_cvt_pk_bf16_f32 v42, v196, v197
    s_add_u32 m0, s47, 45056
    s_nop 0
    buffer_load_dwordx4 v177, s[8:11], s46 offen  lds
    s_add_u32 s46, s46, 110592
    v_cvt_pk_bf16_f32 v43, v198, v199
    v_mfma_f32_16x16x32_bf16 v[192:195], v[146:149], v[52:55], v[156:159]
    v_mfma_f32_16x16x32_bf16 v[196:199], v[144:147], v[52:55], v[156:159]
    v_cvt_pk_bf16_f32 v44, v200, v201
    v_cvt_pk_bf16_f32 v45, v202, v203
    v_cvt_pk_bf16_f32 v46, v204, v205
    v_cvt_pk_bf16_f32 v47, v206, v207
    s_add_u32 m0, s47, 49152
    s_nop 0
    buffer_load_dwordx4 v174, s[8:11], s46 offen  lds
    v_mfma_f32_16x16x32_bf16 v[200:203], v[146:149], v[56:59], v[156:159]
    v_mfma_f32_16x16x32_bf16 v[204:207], v[144:147], v[56:59], v[156:159]
    v_cvt_pk_bf16_f32 v48, v184, v185
    v_cvt_pk_bf16_f32 v49, v186, v187
    v_cvt_pk_bf16_f32 v50, v188, v189
    v_cvt_pk_bf16_f32 v51, v190, v191
    s_add_u32 m0, s47, 53248
    s_nop 0
    buffer_load_dwordx4 v175, s[8:11], s46 offen  lds
    v_mfma_f32_16x16x32_bf16 v[184:187], v[146:149], v[60:63], v[156:159]
    v_mfma_f32_16x16x32_bf16 v[188:191], v[144:147], v[60:63], v[156:159]
    v_cvt_pk_bf16_f32 v52, v192, v193
    v_cvt_pk_bf16_f32 v53, v194, v195
    v_cvt_pk_bf16_f32 v54, v196, v197
    v_cvt_pk_bf16_f32 v55, v198, v199
    v_mfma_f32_16x16x32_bf16 v[192:195], v[146:149], v[64:67], v[156:159]
    s_add_u32 m0, s47, 57344
    s_nop 0
    buffer_load_dwordx4 v176, s[8:11], s46 offen  lds
    v_mfma_f32_16x16x32_bf16 v[196:199], v[144:147], v[64:67], v[156:159]
    v_cvt_pk_bf16_f32 v56, v200, v201
    v_cvt_pk_bf16_f32 v57, v202, v203
    v_cvt_pk_bf16_f32 v58, v204, v205
    v_cvt_pk_bf16_f32 v59, v206, v207
    v_mfma_f32_16x16x32_bf16 v[200:203], v[146:149], v[68:71], v[156:159]
    s_add_u32 m0, s47, 61440
    s_nop 0
    buffer_load_dwordx4 v177, s[8:11], s46 offen  lds
    s_add_u32 s46, s46, 110592
    v_mfma_f32_16x16x32_bf16 v[204:207], v[144:147], v[68:71], v[156:159]
    v_cvt_pk_bf16_f32 v60, v184, v185
    v_cvt_pk_bf16_f32 v61, v186, v187
    v_cvt_pk_bf16_f32 v62, v188, v189
    v_cvt_pk_bf16_f32 v63, v190, v191
    v_cvt_pk_bf16_f32 v64, v192, v193
    v_cvt_pk_bf16_f32 v65, v194, v195
    v_cvt_pk_bf16_f32 v66, v196, v197
    v_cvt_pk_bf16_f32 v67, v198, v199
    v_cvt_pk_bf16_f32 v68, v200, v201
    v_cvt_pk_bf16_f32 v69, v202, v203
    v_cvt_pk_bf16_f32 v70, v204, v205
    v_cvt_pk_bf16_f32 v71, v206, v207
    v_mfma_f32_16x16x32_bf16 v[160:163], v[0:3], v[0:3], 0
    v_mfma_f32_16x16x32_bf16 v[160:163], v[4:7], v[4:7], v[160:163]
    v_mfma_f32_16x16x32_bf16 v[160:163], v[8:11], v[8:11], v[160:163]
    v_mfma_f32_16x16x32_bf16 v[160:163], v[12:15], v[12:15], v[160:163]
    v_mfma_f32_16x16x32_bf16 v[160:163], v[16:19], v[16:19], v[160:163]
    v_mfma_f32_16x16x32_bf16 v[160:163], v[20:23], v[20:23], v[160:163]
    v_mfma_f32_16x16x32_bf16 v[160:163], v[24:27], v[24:27], v[160:163]
    v_mfma_f32_16x16x32_bf16 v[160:163], v[28:31], v[28:31], v[160:163]
    v_mfma_f32_16x16x32_bf16 v[160:163], v[32:35], v[32:35], v[160:163]
    v_mfma_f32_16x16x32_bf16 v[160:163], v[36:39], v[36:39], v[160:163]
    v_mfma_f32_16x16x32_bf16 v[160:163], v[40:43], v[40:43], v[160:163]
    v_mfma_f32_16x16x32_bf16 v[160:163], v[44:47], v[44:47], v[160:163]
    v_mfma_f32_16x16x32_bf16 v[160:163], v[48:51], v[48:51], v[160:163]
    v_mfma_f32_16x16x32_bf16 v[160:163], v[52:55], v[52:55], v[160:163]
    v_mfma_f32_16x16x32_bf16 v[160:163], v[56:59], v[56:59], v[160:163]
    v_mfma_f32_16x16x32_bf16 v[160:163], v[60:63], v[60:63], v[160:163]
    v_mfma_f32_16x16x32_bf16 v[160:163], v[64:67], v[64:67], v[160:163]
    v_mfma_f32_16x16x32_bf16 v[160:163], v[68:71], v[68:71], v[160:163]
    s_waitcnt vmcnt(16)
    v_add_u32 v180, 73728, v180
    v_add_u32 v181, 73728, v181
    ds_read_b128 v[72:75], v180 offset:0
    ds_read_b128 v[76:79], v181 offset:0
    ds_read_b128 v[80:83], v180 offset:2048
    ds_read_b128 v[84:87], v181 offset:2048
    ds_read_b128 v[88:91], v180 offset:4096
    ds_read_b128 v[92:95], v181 offset:4096
    ds_read_b128 v[96:99], v180 offset:6144
    ds_read_b128 v[100:103], v181 offset:6144
    ds_read_b128 v[104:107], v180 offset:8192
    ds_read_b128 v[108:111], v181 offset:8192
    ds_read_b128 v[112:115], v180 offset:10240
    ds_read_b128 v[116:119], v181 offset:10240
    ds_read_b128 v[120:123], v180 offset:12288
    ds_read_b128 v[124:127], v181 offset:12288
    ds_read_b128 v[128:131], v180 offset:14336
    ds_read_b128 v[132:135], v181 offset:14336
    ds_read_b128 v[136:139], v180 offset:16384
    ds_read_b128 v[140:143], v181 offset:16384
    v_and_b32 v208, 3, v182
    v_cmp_eq_u32 vcc, 1, v208
    s_nop 1
    v_cndmask_b32 v160, v160, v161, vcc
    v_cmp_eq_u32 vcc, 2, v208
    s_nop 1
    v_cndmask_b32 v160, v160, v162, vcc
    v_cmp_eq_u32 vcc, 3, v208
    s_nop 1
    v_cndmask_b32 v160, v160, v163, vcc
    v_bfe_u32 v208, v182, 2, 2
    v_lshrrev_b32 v209, 4, v182
    v_cmp_eq_u32 vcc, v208, v209
    s_nop 1
    v_cndmask_b32 v160, 0, v160, vcc
    v_mov_b32 v210, v160
    s_nop 1
    v_permlane16_swap_b32 v160, v210
    s_nop 1
    v_add_f32 v160, v160, v210
    v_mov_b32 v210, v160
    s_nop 1
    v_permlane32_swap_b32 v160, v210
    s_nop 1
    v_add_f32 v160, v160, v210
    v_mul_f32 v160, 0x3ae38e39, v160
    v_add_f32 v160, 0x3727c5ac, v160
    v_rsq_f32 v232, v160
    s_waitcnt lgkmcnt(15)
    v_mfma_f32_16x16x32_bf16 v[156:159], v[152:155], v[72:75], 0
    v_mfma_f32_16x16x32_bf16 v[156:159], v[152:155], v[76:79], v[156:159]
    v_mfma_f32_16x16x32_bf16 v[156:159], v[152:155], v[80:83], v[156:159]
    s_waitcnt lgkmcnt(12)
    v_mfma_f32_16x16x32_bf16 v[156:159], v[152:155], v[84:87], v[156:159]
    v_mfma_f32_16x16x32_bf16 v[156:159], v[152:155], v[88:91], v[156:159]
    v_mfma_f32_16x16x32_bf16 v[156:159], v[152:155], v[92:95], v[156:159]
    s_waitcnt lgkmcnt(9)
    v_mfma_f32_16x16x32_bf16 v[156:159], v[152:155], v[96:99], v[156:159]
    v_mfma_f32_16x16x32_bf16 v[156:159], v[152:155], v[100:103], v[156:159]
    v_mfma_f32_16x16x32_bf16 v[156:159], v[152:155], v[104:107], v[156:159]
    s_waitcnt lgkmcnt(6)
    v_mfma_f32_16x16x32_bf16 v[156:159], v[152:155], v[108:111], v[156:159]
    v_mfma_f32_16x16x32_bf16 v[156:159], v[152:155], v[112:115], v[156:159]
    v_mfma_f32_16x16x32_bf16 v[156:159], v[152:155], v[116:119], v[156:159]
    s_waitcnt lgkmcnt(3)
    v_mfma_f32_16x16x32_bf16 v[156:159], v[152:155], v[120:123], v[156:159]
    v_mfma_f32_16x16x32_bf16 v[156:159], v[152:155], v[124:127], v[156:159]
    v_mfma_f32_16x16x32_bf16 v[156:159], v[152:155], v[128:131], v[156:159]
    s_waitcnt lgkmcnt(0)
    v_mfma_f32_16x16x32_bf16 v[156:159], v[152:155], v[132:135], v[156:159]
    v_mfma_f32_16x16x32_bf16 v[156:159], v[152:155], v[136:139], v[156:159]
    v_mfma_f32_16x16x32_bf16 v[156:159], v[152:155], v[140:143], v[156:159]
    s_barrier
    s_nop 6
    v_mul_f32 v156, 0xbae38e39, v156
    s_add_u32 m0, s47, 65536
    s_nop 0
    buffer_load_dwordx4 v174, s[8:11], s46 offen  lds
    s_nop 2
    v_mul_f32 v157, 0xbae38e39, v157
    s_nop 1
    v_mul_f32 v158, 0xbae38e39, v158
    s_nop 0
    v_mul_f32 v159, 0xbae38e39, v159
    s_nop 1
    v_mfma_f32_16x16x32_bf16 v[184:187], v[146:149], v[72:75], v[156:159]
    s_nop 0
    v_mfma_f32_16x16x32_bf16 v[188:191], v[144:147], v[72:75], v[156:159]
    v_mfma_f32_16x16x32_bf16 v[192:195], v[146:149], v[76:79], v[156:159]
    s_add_u32 m0, s47, 69632
    s_nop 0
    buffer_load_dwordx4 v175, s[8:11], s46 offen  lds
    v_mfma_f32_16x16x32_bf16 v[196:199], v[144:147], v[76:79], v[156:159]
    v_mfma_f32_16x16x32_bf16 v[200:203], v[146:149], v[80:83], v[156:159]
    v_mfma_f32_16x16x32_bf16 v[204:207], v[144:147], v[80:83], v[156:159]
    v_cvt_pk_bf16_f32 v72, v184, v185
    v_cvt_pk_bf16_f32 v73, v186, v187
    v_cvt_pk_bf16_f32 v74, v188, v189
    v_cvt_pk_bf16_f32 v75, v190, v191
    s_add_u32 m0, s47, 73728
    s_nop 0
    buffer_load_dwordx4 v176, s[8:11], s46 offen  lds
    v_mfma_f32_16x16x32_bf16 v[184:187], v[146:149], v[84:87], v[156:159]
    v_mfma_f32_16x16x32_bf16 v[188:191], v[144:147], v[84:87], v[156:159]
    v_cvt_pk_bf16_f32 v76, v192, v193
    v_cvt_pk_bf16_f32 v77, v194, v195
    v_cvt_pk_bf16_f32 v78, v196, v197
    v_cvt_pk_bf16_f32 v79, v198, v199
    s_add_u32 m0, s47, 77824
    s_nop 0
    buffer_load_dwordx4 v177, s[8:11], s46 offen  lds
    s_add_u32 s46, s46, 110592
    v_mfma_f32_16x16x32_bf16 v[192:195], v[146:149], v[88:91], v[156:159]
    v_mfma_f32_16x16x32_bf16 v[196:199], v[144:147], v[88:91], v[156:159]
    v_cvt_pk_bf16_f32 v80, v200, v201
    v_cvt_pk_bf16_f32 v81, v202, v203
    v_cvt_pk_bf16_f32 v82, v204, v205
    v_cvt_pk_bf16_f32 v83, v206, v207
    v_mfma_f32_16x16x32_bf16 v[200:203], v[146:149], v[92:95], v[156:159]
    s_add_u32 m0, s47, 81920
    s_nop 0
    buffer_load_dwordx4 v174, s[8:11], s46 offen  lds
    v_mfma_f32_16x16x32_bf16 v[204:207], v[144:147], v[92:95], v[156:159]
    v_cvt_pk_bf16_f32 v84, v184, v185
    v_cvt_pk_bf16_f32 v85, v186, v187
    v_cvt_pk_bf16_f32 v86, v188, v189
    v_cvt_pk_bf16_f32 v87, v190, v191
    v_mfma_f32_16x16x32_bf16 v[184:187], v[146:149], v[96:99], v[156:159]
    s_add_u32 m0, s47, 86016
    s_nop 0
    buffer_load_dwordx4 v175, s[8:11], s46 offen  lds
    v_mfma_f32_16x16x32_bf16 v[188:191], v[144:147], v[96:99], v[156:159]
    v_cvt_pk_bf16_f32 v88, v192, v193
    v_cvt_pk_bf16_f32 v89, v194, v195
    v_cvt_pk_bf16_f32 v90, v196, v197
    v_cvt_pk_bf16_f32 v91, v198, v199
    v_mfma_f32_16x16x32_bf16 v[192:195], v[146:149], v[100:103], v[156:159]
    v_mfma_f32_16x16x32_bf16 v[196:199], v[144:147], v[100:103], v[156:159]
    s_add_u32 m0, s47, 90112
    s_nop 0
    buffer_load_dwordx4 v176, s[8:11], s46 offen  lds
    v_cvt_pk_bf16_f32 v92, v200, v201
    v_cvt_pk_bf16_f32 v93, v202, v203
    v_cvt_pk_bf16_f32 v94, v204, v205
    v_cvt_pk_bf16_f32 v95, v206, v207
    v_mfma_f32_16x16x32_bf16 v[200:203], v[146:149], v[104:107], v[156:159]
    v_mfma_f32_16x16x32_bf16 v[204:207], v[144:147], v[104:107], v[156:159]
    v_cvt_pk_bf16_f32 v96, v184, v185
    s_add_u32 m0, s47, 94208
    s_nop 0
    buffer_load_dwordx4 v177, s[8:11], s46 offen  lds
    s_add_u32 s46, s46, 110592
    v_cvt_pk_bf16_f32 v97, v186, v187
    v_cvt_pk_bf16_f32 v98, v188, v189
    v_cvt_pk_bf16_f32 v99, v190, v191
    v_mfma_f32_16x16x32_bf16 v[184:187], v[146:149], v[108:111], v[156:159]
    v_mfma_f32_16x16x32_bf16 v[188:191], v[144:147], v[108:111], v[156:159]
    v_cvt_pk_bf16_f32 v100, v192, v193
    s_add_u32 m0, s47, 98304
    s_nop 0
    buffer_load_dwordx4 v174, s[8:11], s46 offen  lds
    v_cvt_pk_bf16_f32 v101, v194, v195
    v_cvt_pk_bf16_f32 v102, v196, v197
    v_cvt_pk_bf16_f32 v103, v198, v199
    v_mfma_f32_16x16x32_bf16 v[192:195], v[146:149], v[112:115], v[156:159]
    v_mfma_f32_16x16x32_bf16 v[196:199], v[144:147], v[112:115], v[156:159]
    v_cvt_pk_bf16_f32 v104, v200, v201
    v_cvt_pk_bf16_f32 v105, v202, v203
    s_add_u32 m0, s47, 102400
    s_nop 0
    buffer_load_dwordx4 v175, s[8:11], s46 offen  lds
    v_cvt_pk_bf16_f32 v106, v204, v205
    v_cvt_pk_bf16_f32 v107, v206, v207
    v_mfma_f32_16x16x32_bf16 v[200:203], v[146:149], v[116:119], v[156:159]
    v_mfma_f32_16x16x32_bf16 v[204:207], v[144:147], v[116:119], v[156:159]
    v_cvt_pk_bf16_f32 v108, v184, v185
    v_cvt_pk_bf16_f32 v109, v186, v187
    s_add_u32 m0, s47, 106496
    s_nop 0
    buffer_load_dwordx4 v176, s[8:11], s46 offen  lds
    v_cvt_pk_bf16_f32 v110, v188, v189
    v_cvt_pk_bf16_f32 v111, v190, v191
    v_mfma_f32_16x16x32_bf16 v[184:187], v[146:149], v[120:123], v[156:159]
    v_mfma_f32_16x16x32_bf16 v[188:191], v[144:147], v[120:123], v[156:159]
    v_cvt_pk_bf16_f32 v112, v192, v193
    v_cvt_pk_bf16_f32 v113, v194, v195
    v_cvt_pk_bf16_f32 v114, v196, v197
    s_add_u32 m0, s47, 110592
    s_nop 0
    buffer_load_dwordx4 v177, s[8:11], s46 offen  lds
    s_add_u32 s46, s46, 110592
    v_cvt_pk_bf16_f32 v115, v198, v199
    v_mfma_f32_16x16x32_bf16 v[192:195], v[146:149], v[124:127], v[156:159]
    v_mfma_f32_16x16x32_bf16 v[196:199], v[144:147], v[124:127], v[156:159]
    v_cvt_pk_bf16_f32 v116, v200, v201
    v_cvt_pk_bf16_f32 v117, v202, v203
    v_cvt_pk_bf16_f32 v118, v204, v205
    v_cvt_pk_bf16_f32 v119, v206, v207
    s_add_u32 m0, s47, 114688
    s_nop 0
    buffer_load_dwordx4 v174, s[8:11], s46 offen  lds
    v_mfma_f32_16x16x32_bf16 v[200:203], v[146:149], v[128:131], v[156:159]
    v_mfma_f32_16x16x32_bf16 v[204:207], v[144:147], v[128:131], v[156:159]
    v_cvt_pk_bf16_f32 v120, v184, v185
    v_cvt_pk_bf16_f32 v121, v186, v187
    v_cvt_pk_bf16_f32 v122, v188, v189
    v_cvt_pk_bf16_f32 v123, v190, v191
    s_add_u32 m0, s47, 118784
    s_nop 0
    buffer_load_dwordx4 v175, s[8:11], s46 offen  lds
    v_mfma_f32_16x16x32_bf16 v[184:187], v[146:149], v[132:135], v[156:159]
    v_mfma_f32_16x16x32_bf16 v[188:191], v[144:147], v[132:135], v[156:159]
    v_cvt_pk_bf16_f32 v124, v192, v193
    v_cvt_pk_bf16_f32 v125, v194, v195
    v_cvt_pk_bf16_f32 v126, v196, v197
    v_cvt_pk_bf16_f32 v127, v198, v199
    v_mfma_f32_16x16x32_bf16 v[192:195], v[146:149], v[136:139], v[156:159]
    s_add_u32 m0, s47, 122880
    s_nop 0
    buffer_load_dwordx4 v176, s[8:11], s46 offen  lds
    v_mfma_f32_16x16x32_bf16 v[196:199], v[144:147], v[136:139], v[156:159]
    v_cvt_pk_bf16_f32 v128, v200, v201
    v_cvt_pk_bf16_f32 v129, v202, v203
    v_cvt_pk_bf16_f32 v130, v204, v205
    v_cvt_pk_bf16_f32 v131, v206, v207
    v_mfma_f32_16x16x32_bf16 v[200:203], v[146:149], v[140:143], v[156:159]
    s_add_u32 m0, s47, 126976
    s_nop 0
    buffer_load_dwordx4 v177, s[8:11], s46 offen  lds
    s_add_u32 s46, s46, 110592
    v_mfma_f32_16x16x32_bf16 v[204:207], v[144:147], v[140:143], v[156:159]
    v_cvt_pk_bf16_f32 v132, v184, v185
    v_cvt_pk_bf16_f32 v133, v186, v187
    v_cvt_pk_bf16_f32 v134, v188, v189
    v_cvt_pk_bf16_f32 v135, v190, v191
    v_cvt_pk_bf16_f32 v136, v192, v193
    v_cvt_pk_bf16_f32 v137, v194, v195
    v_cvt_pk_bf16_f32 v138, v196, v197
    v_cvt_pk_bf16_f32 v139, v198, v199
    v_cvt_pk_bf16_f32 v140, v200, v201
    v_cvt_pk_bf16_f32 v141, v202, v203
    v_cvt_pk_bf16_f32 v142, v204, v205
    v_cvt_pk_bf16_f32 v143, v206, v207
    v_mfma_f32_16x16x32_bf16 v[164:167], v[72:75], v[72:75], 0
    v_mfma_f32_16x16x32_bf16 v[164:167], v[76:79], v[76:79], v[164:167]
    v_mfma_f32_16x16x32_bf16 v[164:167], v[80:83], v[80:83], v[164:167]
    v_mfma_f32_16x16x32_bf16 v[164:167], v[84:87], v[84:87], v[164:167]
    v_mfma_f32_16x16x32_bf16 v[164:167], v[88:91], v[88:91], v[164:167]
    v_mfma_f32_16x16x32_bf16 v[164:167], v[92:95], v[92:95], v[164:167]
    v_mfma_f32_16x16x32_bf16 v[164:167], v[96:99], v[96:99], v[164:167]
    v_mfma_f32_16x16x32_bf16 v[164:167], v[100:103], v[100:103], v[164:167]
    v_mfma_f32_16x16x32_bf16 v[164:167], v[104:107], v[104:107], v[164:167]
    v_mfma_f32_16x16x32_bf16 v[164:167], v[108:111], v[108:111], v[164:167]
    v_mfma_f32_16x16x32_bf16 v[164:167], v[112:115], v[112:115], v[164:167]
    v_mfma_f32_16x16x32_bf16 v[164:167], v[116:119], v[116:119], v[164:167]
    v_mfma_f32_16x16x32_bf16 v[164:167], v[120:123], v[120:123], v[164:167]
    v_mfma_f32_16x16x32_bf16 v[164:167], v[124:127], v[124:127], v[164:167]
    v_mfma_f32_16x16x32_bf16 v[164:167], v[128:131], v[128:131], v[164:167]
    v_mfma_f32_16x16x32_bf16 v[164:167], v[132:135], v[132:135], v[164:167]
    v_mfma_f32_16x16x32_bf16 v[164:167], v[136:139], v[136:139], v[164:167]
    v_mfma_f32_16x16x32_bf16 v[164:167], v[140:143], v[140:143], v[164:167]
    v_and_b32 v208, 3, v182
    v_cmp_eq_u32 vcc, 1, v208
    s_nop 5
    v_cndmask_b32 v164, v164, v165, vcc
    v_cmp_eq_u32 vcc, 2, v208
    s_nop 3
    v_cndmask_b32 v164, v164, v166, vcc
    v_cmp_eq_u32 vcc, 3, v208
    s_nop 1
    v_cndmask_b32 v164, v164, v167, vcc
    v_bfe_u32 v208, v182, 2, 2
    v_lshrrev_b32 v209, 4, v182
    v_cmp_eq_u32 vcc, v208, v209
    s_nop 1
    v_cndmask_b32 v164, 0, v164, vcc
    v_mov_b32 v210, v164
    s_nop 1
    v_permlane16_swap_b32 v164, v210
    s_nop 1
    v_add_f32 v164, v164, v210
    v_mov_b32 v210, v164
    s_nop 1
    v_permlane32_swap_b32 v164, v210
    s_nop 1
    v_add_f32 v164, v164, v210
    v_mul_f32 v164, 0x3ae38e39, v164
    v_add_f32 v164, 0x3727c5ac, v164
    v_rsq_f32 v233, v164
    s_waitcnt vmcnt(28)
    s_barrier
    ds_read_b64_tr_b16 v[144:145], v168 offset:0
    ds_read_b64_tr_b16 v[146:147], v168 offset:7680
    ds_read_b64_tr_b16 v[148:149], v168 offset:40
    ds_read_b64_tr_b16 v[150:151], v168 offset:7720
    ds_read_b64_tr_b16 v[152:153], v168 offset:72
    ds_read_b64_tr_b16 v[154:155], v168 offset:7752
    ds_read_b64_tr_b16 v[156:157], v168 offset:112
    ds_read_b64_tr_b16 v[158:159], v168 offset:7792
    ds_read_b64_tr_b16 v[160:161], v168 offset:160
    ds_read_b64_tr_b16 v[162:163], v168 offset:7840
    s_waitcnt lgkmcnt(6)
    v_mfma_f32_16x16x32_bf16 a[0:3], v[144:147], v[0:3], 0
    ds_read_b64_tr_b16 v[164:165], v168 offset:200
    v_mfma_f32_16x16x32_bf16 a[4:7], v[144:147], v[72:75], 0
    ds_read_b64_tr_b16 v[166:167], v168 offset:7880
    s_add_u32 m0, s47, 131072
    s_nop 0
    buffer_load_dwordx4 v174, s[8:11], s46 offen  lds
    v_mfma_f32_16x16x32_bf16 a[8:11], v[148:151], v[0:3], 0
    ds_read_b64_tr_b16 v[144:145], v168 offset:232
    v_mfma_f32_16x16x32_bf16 a[12:15], v[148:151], v[72:75], 0
    ds_read_b64_tr_b16 v[146:147], v168 offset:7912
    s_add_u32 m0, s47, 135168
    s_nop 0
    buffer_load_dwordx4 v175, s[8:11], s46 offen  lds
    s_waitcnt lgkmcnt(6)
    v_mfma_f32_16x16x32_bf16 a[16:19], v[152:155], v[0:3], 0
    ds_read_b64_tr_b16 v[148:149], v168 offset:272
    v_mfma_f32_16x16x32_bf16 a[20:23], v[152:155], v[72:75], 0
    ds_read_b64_tr_b16 v[150:151], v168 offset:7952
    s_add_u32 m0, s47, 139264
    s_nop 0
    buffer_load_dwordx4 v176, s[8:11], s46 offen  lds
    v_mfma_f32_16x16x32_bf16 a[24:27], v[156:159], v[0:3], 0
    ds_read_b64_tr_b16 v[152:153], v171 offset:0
    v_mfma_f32_16x16x32_bf16 a[28:31], v[156:159], v[72:75], 0
    ds_read_b64_tr_b16 v[154:155], v171 offset:7680
    s_add_u32 m0, s47, 143360
    s_nop 0
    buffer_load_dwordx4 v177, s[8:11], s46 offen  lds
    s_add_u32 s46, s46, 110592
    s_waitcnt lgkmcnt(6)
    v_mfma_f32_16x16x32_bf16 a[32:35], v[160:163], v[0:3], 0
    ds_read_b64_tr_b16 v[156:157], v168 offset:320
    v_mfma_f32_16x16x32_bf16 a[36:39], v[160:163], v[72:75], 0
    ds_read_b64_tr_b16 v[158:159], v168 offset:8000
    v_mfma_f32_16x16x32_bf16 a[40:43], v[164:167], v[0:3], 0
    ds_read_b64_tr_b16 v[160:161], v168 offset:352
    v_mfma_f32_16x16x32_bf16 a[44:47], v[164:167], v[72:75], 0
    ds_read_b64_tr_b16 v[162:163], v168 offset:8032
    s_waitcnt lgkmcnt(6)
    v_mfma_f32_16x16x32_bf16 a[48:51], v[144:147], v[0:3], 0
    ds_read_b64_tr_b16 v[164:165], v168 offset:384
    v_mfma_f32_16x16x32_bf16 a[52:55], v[144:147], v[72:75], 0
    ds_read_b64_tr_b16 v[166:167], v168 offset:8064
    v_mfma_f32_16x16x32_bf16 a[56:59], v[148:151], v[0:3], 0
    ds_read_b64_tr_b16 v[144:145], v168 offset:416
    v_mfma_f32_16x16x32_bf16 a[60:63], v[148:151], v[72:75], 0
    ds_read_b64_tr_b16 v[146:147], v168 offset:8096
    s_waitcnt lgkmcnt(6)
    v_mfma_f32_16x16x32_bf16 a[64:67], v[152:155], v[0:3], 0
    ds_read_b64_tr_b16 v[148:149], v168 offset:448
    v_mfma_f32_16x16x32_bf16 a[68:71], v[152:155], v[72:75], 0
    ds_read_b64_tr_b16 v[150:151], v168 offset:8128
    s_waitcnt vmcnt(28)
    s_barrier
    v_mfma_f32_16x16x32_bf16 a[72:75], v[0:3], v[156:159], 0
    ds_read_b64_tr_b16 v[152:153], v168 offset:16384
    v_mfma_f32_16x16x32_bf16 a[76:79], v[72:75], v[156:159], 0
    ds_read_b64_tr_b16 v[154:155], v168 offset:24064
    s_waitcnt lgkmcnt(6)
    v_mfma_f32_16x16x32_bf16 a[80:83], v[0:3], v[160:163], 0
    ds_read_b64_tr_b16 v[156:157], v168 offset:16424
    v_mfma_f32_16x16x32_bf16 a[84:87], v[72:75], v[160:163], 0
    ds_read_b64_tr_b16 v[158:159], v168 offset:24104
    v_mfma_f32_16x16x32_bf16 a[88:91], v[0:3], v[164:167], 0
    ds_read_b64_tr_b16 v[160:161], v168 offset:16456
    v_mfma_f32_16x16x32_bf16 a[92:95], v[72:75], v[164:167], 0
    ds_read_b64_tr_b16 v[162:163], v168 offset:24136
    s_waitcnt lgkmcnt(6)
    v_mfma_f32_16x16x32_bf16 a[96:99], v[0:3], v[144:147], 0
    ds_read_b64_tr_b16 v[164:165], v168 offset:16496
    v_mfma_f32_16x16x32_bf16 a[100:103], v[72:75], v[144:147], 0
    ds_read_b64_tr_b16 v[166:167], v168 offset:24176
    v_mfma_f32_16x16x32_bf16 a[104:107], v[0:3], v[148:151], 0
    ds_read_b64_tr_b16 v[144:145], v168 offset:16544
    v_mfma_f32_16x16x32_bf16 a[108:111], v[72:75], v[148:151], 0
    ds_read_b64_tr_b16 v[146:147], v168 offset:24224
    s_waitcnt lgkmcnt(6)
    v_mfma_f32_16x16x32_bf16 a[0:3], v[152:155], v[4:7], a[0:3]
    ds_read_b64_tr_b16 v[148:149], v168 offset:16584
    v_mfma_f32_16x16x32_bf16 a[4:7], v[152:155], v[76:79], a[4:7]
    ds_read_b64_tr_b16 v[150:151], v168 offset:24264
    v_mfma_f32_16x16x32_bf16 a[8:11], v[156:159], v[4:7], a[8:11]
    ds_read_b64_tr_b16 v[152:153], v168 offset:16616
    v_mfma_f32_16x16x32_bf16 a[12:15], v[156:159], v[76:79], a[12:15]
    ds_read_b64_tr_b16 v[154:155], v168 offset:24296
    s_waitcnt lgkmcnt(6)
    v_mfma_f32_16x16x32_bf16 a[16:19], v[160:163], v[4:7], a[16:19]
    ds_read_b64_tr_b16 v[156:157], v168 offset:16656
    v_mfma_f32_16x16x32_bf16 a[20:23], v[160:163], v[76:79], a[20:23]
    ds_read_b64_tr_b16 v[158:159], v168 offset:24336
    v_mfma_f32_16x16x32_bf16 a[24:27], v[164:167], v[4:7], a[24:27]
    ds_read_b64_tr_b16 v[160:161], v171 offset:16384
    v_mfma_f32_16x16x32_bf16 a[28:31], v[164:167], v[76:79], a[28:31]
    ds_read_b64_tr_b16 v[162:163], v171 offset:24064
    s_waitcnt lgkmcnt(6)
    v_mfma_f32_16x16x32_bf16 a[32:35], v[144:147], v[4:7], a[32:35]
    ds_read_b64_tr_b16 v[164:165], v168 offset:16704
    v_mfma_f32_16x16x32_bf16 a[36:39], v[144:147], v[76:79], a[36:39]
    ds_read_b64_tr_b16 v[166:167], v168 offset:24384
    v_mfma_f32_16x16x32_bf16 a[40:43], v[148:151], v[4:7], a[40:43]
    ds_read_b64_tr_b16 v[144:145], v168 offset:16736
    v_mfma_f32_16x16x32_bf16 a[44:47], v[148:151], v[76:79], a[44:47]
    ds_read_b64_tr_b16 v[146:147], v168 offset:24416
    s_waitcnt lgkmcnt(6)
    v_mfma_f32_16x16x32_bf16 a[48:51], v[152:155], v[4:7], a[48:51]
    ds_read_b64_tr_b16 v[148:149], v168 offset:16768
    v_mfma_f32_16x16x32_bf16 a[52:55], v[152:155], v[76:79], a[52:55]
    ds_read_b64_tr_b16 v[150:151], v168 offset:24448
    v_mfma_f32_16x16x32_bf16 a[56:59], v[156:159], v[4:7], a[56:59]
    ds_read_b64_tr_b16 v[152:153], v168 offset:16800
    v_mfma_f32_16x16x32_bf16 a[60:63], v[156:159], v[76:79], a[60:63]
    ds_read_b64_tr_b16 v[154:155], v168 offset:24480
    s_waitcnt lgkmcnt(6)
    v_mfma_f32_16x16x32_bf16 a[64:67], v[160:163], v[4:7], a[64:67]
    ds_read_b64_tr_b16 v[156:157], v168 offset:16832
    v_mfma_f32_16x16x32_bf16 a[68:71], v[160:163], v[76:79], a[68:71]
    ds_read_b64_tr_b16 v[158:159], v168 offset:24512
    s_waitcnt vmcnt(24)
    s_barrier
    v_mfma_f32_16x16x32_bf16 a[72:75], v[4:7], v[164:167], a[72:75]
    ds_read_b64_tr_b16 v[160:161], v168 offset:32768
    v_mfma_f32_16x16x32_bf16 a[76:79], v[76:79], v[164:167], a[76:79]
    ds_read_b64_tr_b16 v[162:163], v168 offset:40448
    s_add_u32 m0, s47, 0
    s_nop 0
    buffer_load_dwordx4 v174, s[8:11], s46 offen  lds
    s_waitcnt lgkmcnt(6)
    v_mfma_f32_16x16x32_bf16 a[80:83], v[4:7], v[144:147], a[80:83]
    ds_read_b64_tr_b16 v[164:165], v168 offset:32808
    v_mfma_f32_16x16x32_bf16 a[84:87], v[76:79], v[144:147], a[84:87]
    ds_read_b64_tr_b16 v[166:167], v168 offset:40488
    s_add_u32 m0, s47, 4096
    s_nop 0
    buffer_load_dwordx4 v175, s[8:11], s46 offen  lds
    v_mfma_f32_16x16x32_bf16 a[88:91], v[4:7], v[148:151], a[88:91]
    ds_read_b64_tr_b16 v[144:145], v168 offset:32840
    v_mfma_f32_16x16x32_bf16 a[92:95], v[76:79], v[148:151], a[92:95]
    ds_read_b64_tr_b16 v[146:147], v168 offset:40520
    s_add_u32 m0, s47, 8192
    s_nop 0
    buffer_load_dwordx4 v176, s[8:11], s46 offen  lds
    s_waitcnt lgkmcnt(6)
    v_mfma_f32_16x16x32_bf16 a[96:99], v[4:7], v[152:155], a[96:99]
    ds_read_b64_tr_b16 v[148:149], v168 offset:32880
    v_mfma_f32_16x16x32_bf16 a[100:103], v[76:79], v[152:155], a[100:103]
    ds_read_b64_tr_b16 v[150:151], v168 offset:40560
    s_add_u32 m0, s47, 12288
    s_nop 0
    buffer_load_dwordx4 v177, s[8:11], s46 offen  lds
    s_add_u32 s46, s46, 110592
    v_mfma_f32_16x16x32_bf16 a[104:107], v[4:7], v[156:159], a[104:107]
    ds_read_b64_tr_b16 v[152:153], v168 offset:32928
    v_mfma_f32_16x16x32_bf16 a[108:111], v[76:79], v[156:159], a[108:111]
    ds_read_b64_tr_b16 v[154:155], v168 offset:40608
    s_waitcnt lgkmcnt(6)
    v_mfma_f32_16x16x32_bf16 a[0:3], v[160:163], v[8:11], a[0:3]
    ds_read_b64_tr_b16 v[156:157], v168 offset:32968
    v_and_b32 v244, 15, v182
    v_mfma_f32_16x16x32_bf16 a[4:7], v[160:163], v[80:83], a[4:7]
    ds_read_b64_tr_b16 v[158:159], v168 offset:40648
    v_mfma_f32_16x16x32_bf16 a[8:11], v[164:167], v[8:11], a[8:11]
    ds_read_b64_tr_b16 v[160:161], v168 offset:33000
    v_lshrrev_b32 v245, 4, v182
    v_mfma_f32_16x16x32_bf16 a[12:15], v[164:167], v[80:83], a[12:15]
    ds_read_b64_tr_b16 v[162:163], v168 offset:40680
    s_waitcnt lgkmcnt(6)
    v_mfma_f32_16x16x32_bf16 a[16:19], v[144:147], v[8:11], a[16:19]
    ds_read_b64_tr_b16 v[164:165], v168 offset:33040
    v_lshlrev_b32 v228, 4, v245
    v_mfma_f32_16x16x32_bf16 a[20:23], v[144:147], v[80:83], a[20:23]
    ds_read_b64_tr_b16 v[166:167], v168 offset:40720
    v_mfma_f32_16x16x32_bf16 a[24:27], v[148:151], v[8:11], a[24:27]
    ds_read_b64_tr_b16 v[144:145], v171 offset:32768
    v_lshlrev_b32 v229, 4, v245
    v_mfma_f32_16x16x32_bf16 a[28:31], v[148:151], v[80:83], a[28:31]
    ds_read_b64_tr_b16 v[146:147], v171 offset:40448
    s_waitcnt lgkmcnt(6)
    v_mfma_f32_16x16x32_bf16 a[32:35], v[152:155], v[8:11], a[32:35]
    ds_read_b64_tr_b16 v[148:149], v168 offset:33088
    v_add_u32 v229, 4, v229
    v_mfma_f32_16x16x32_bf16 a[36:39], v[152:155], v[80:83], a[36:39]
    ds_read_b64_tr_b16 v[150:151], v168 offset:40768
    v_mfma_f32_16x16x32_bf16 a[40:43], v[156:159], v[8:11], a[40:43]
    ds_read_b64_tr_b16 v[152:153], v168 offset:33120
    v_lshlrev_b32 v230, 4, v245
    v_mfma_f32_16x16x32_bf16 a[44:47], v[156:159], v[80:83], a[44:47]
    ds_read_b64_tr_b16 v[154:155], v168 offset:40800
    s_waitcnt lgkmcnt(6)
    v_mfma_f32_16x16x32_bf16 a[48:51], v[160:163], v[8:11], a[48:51]
    ds_read_b64_tr_b16 v[156:157], v168 offset:33152
    v_add_u32 v230, 8, v230
    v_mfma_f32_16x16x32_bf16 a[52:55], v[160:163], v[80:83], a[52:55]
    ds_read_b64_tr_b16 v[158:159], v168 offset:40832
    v_mfma_f32_16x16x32_bf16 a[56:59], v[164:167], v[8:11], a[56:59]
    ds_read_b64_tr_b16 v[160:161], v168 offset:33184
    v_lshlrev_b32 v231, 4, v245
    v_mfma_f32_16x16x32_bf16 a[60:63], v[164:167], v[80:83], a[60:63]
    ds_read_b64_tr_b16 v[162:163], v168 offset:40864
    s_waitcnt lgkmcnt(6)
    v_mfma_f32_16x16x32_bf16 a[64:67], v[144:147], v[8:11], a[64:67]
    ds_read_b64_tr_b16 v[164:165], v168 offset:33216
    v_add_u32 v231, 12, v231
    v_mfma_f32_16x16x32_bf16 a[68:71], v[144:147], v[80:83], a[68:71]
    ds_read_b64_tr_b16 v[166:167], v168 offset:40896
    s_waitcnt vmcnt(24)
    s_barrier
    v_mfma_f32_16x16x32_bf16 a[72:75], v[8:11], v[148:151], a[72:75]
    ds_read_b64_tr_b16 v[144:145], v168 offset:49152
    v_lshrrev_b32 v186, 1, v245
    v_mfma_f32_16x16x32_bf16 a[76:79], v[80:83], v[148:151], a[76:79]
    ds_read_b64_tr_b16 v[146:147], v168 offset:56832
    s_add_u32 m0, s47, 16384
    s_nop 0
    buffer_load_dwordx4 v174, s[8:11], s46 offen  lds
    s_waitcnt lgkmcnt(6)
    v_mfma_f32_16x16x32_bf16 a[80:83], v[8:11], v[152:155], a[80:83]
    ds_read_b64_tr_b16 v[148:149], v168 offset:49192
    v_lshlrev_b32 v186, 9, v186
    v_mfma_f32_16x16x32_bf16 a[84:87], v[80:83], v[152:155], a[84:87]
    ds_read_b64_tr_b16 v[150:151], v168 offset:56872
    s_add_u32 m0, s47, 20480
    s_nop 0
    buffer_load_dwordx4 v175, s[8:11], s46 offen  lds
    v_mfma_f32_16x16x32_bf16 a[88:91], v[8:11], v[156:159], a[88:91]
    ds_read_b64_tr_b16 v[152:153], v168 offset:49224
    v_lshlrev_b32 v187, 4, v244
    v_mfma_f32_16x16x32_bf16 a[92:95], v[80:83], v[156:159], a[92:95]
    ds_read_b64_tr_b16 v[154:155], v168 offset:56904
    s_add_u32 m0, s47, 24576
    s_nop 0
    buffer_load_dwordx4 v176, s[8:11], s46 offen  lds
    s_waitcnt lgkmcnt(6)
    v_mfma_f32_16x16x32_bf16 a[96:99], v[8:11], v[160:163], a[96:99]
    ds_read_b64_tr_b16 v[156:157], v168 offset:49264
    v_add_u32 v246, v186, v187
    v_mfma_f32_16x16x32_bf16 a[100:103], v[80:83], v[160:163], a[100:103]
    ds_read_b64_tr_b16 v[158:159], v168 offset:56944
    s_add_u32 m0, s47, 28672
    s_nop 0
    buffer_load_dwordx4 v177, s[8:11], s46 offen  lds
    s_add_u32 s46, s46, 110592
    v_mfma_f32_16x16x32_bf16 a[104:107], v[8:11], v[164:167], a[104:107]
    ds_read_b64_tr_b16 v[160:161], v168 offset:49312
    v_and_b32 v186, 1, v245
    v_mfma_f32_16x16x32_bf16 a[108:111], v[80:83], v[164:167], a[108:111]
    ds_read_b64_tr_b16 v[162:163], v168 offset:56992
    s_waitcnt lgkmcnt(6)
    v_mfma_f32_16x16x32_bf16 a[0:3], v[144:147], v[12:15], a[0:3]
    ds_read_b64_tr_b16 v[164:165], v168 offset:49352
    v_lshlrev_b32 v187, 8, v186
    v_mfma_f32_16x16x32_bf16 a[4:7], v[144:147], v[84:87], a[4:7]
    ds_read_b64_tr_b16 v[166:167], v168 offset:57032
    v_mfma_f32_16x16x32_bf16 a[8:11], v[148:151], v[12:15], a[8:11]
    ds_read_b64_tr_b16 v[144:145], v168 offset:49384
    v_add_u32 v246, v246, v187
    v_mfma_f32_16x16x32_bf16 a[12:15], v[148:151], v[84:87], a[12:15]
    ds_read_b64_tr_b16 v[146:147], v168 offset:57064
    s_waitcnt lgkmcnt(6)
    v_mfma_f32_16x16x32_bf16 a[16:19], v[152:155], v[12:15], a[16:19]
    ds_read_b64_tr_b16 v[148:149], v168 offset:49424
    v_lshlrev_b32 v247, 15, v186
    v_mfma_f32_16x16x32_bf16 a[20:23], v[152:155], v[84:87], a[20:23]
    ds_read_b64_tr_b16 v[150:151], v168 offset:57104
    v_mfma_f32_16x16x32_bf16 a[24:27], v[156:159], v[12:15], a[24:27]
    ds_read_b64_tr_b16 v[152:153], v171 offset:49152
    v_lshrrev_b32 v187, 1, v245
    v_mfma_f32_16x16x32_bf16 a[28:31], v[156:159], v[84:87], a[28:31]
    ds_read_b64_tr_b16 v[154:155], v171 offset:56832
    s_waitcnt lgkmcnt(6)
    v_mfma_f32_16x16x32_bf16 a[32:35], v[160:163], v[12:15], a[32:35]
    ds_read_b64_tr_b16 v[156:157], v168 offset:49472
    v_lshlrev_b32 v187, 19, v187
    v_mfma_f32_16x16x32_bf16 a[36:39], v[160:163], v[84:87], a[36:39]
    ds_read_b64_tr_b16 v[158:159], v168 offset:57152
    v_mfma_f32_16x16x32_bf16 a[40:43], v[164:167], v[12:15], a[40:43]
    ds_read_b64_tr_b16 v[160:161], v168 offset:49504
    v_add_u32 v247, v247, v187
    v_mfma_f32_16x16x32_bf16 a[44:47], v[164:167], v[84:87], a[44:47]
    ds_read_b64_tr_b16 v[162:163], v168 offset:57184
    s_waitcnt lgkmcnt(6)
    v_mfma_f32_16x16x32_bf16 a[48:51], v[144:147], v[12:15], a[48:51]
    ds_read_b64_tr_b16 v[164:165], v168 offset:49536
    v_lshlrev_b32 v187, 3, v244
    v_mfma_f32_16x16x32_bf16 a[52:55], v[144:147], v[84:87], a[52:55]
    ds_read_b64_tr_b16 v[166:167], v168 offset:57216
    v_mfma_f32_16x16x32_bf16 a[56:59], v[148:151], v[12:15], a[56:59]
    ds_read_b64_tr_b16 v[144:145], v168 offset:49568
    v_add_u32 v247, v247, v187
    v_mfma_f32_16x16x32_bf16 a[60:63], v[148:151], v[84:87], a[60:63]
    ds_read_b64_tr_b16 v[146:147], v168 offset:57248
    s_waitcnt lgkmcnt(6)
    v_mfma_f32_16x16x32_bf16 a[64:67], v[152:155], v[12:15], a[64:67]
    ds_read_b64_tr_b16 v[148:149], v168 offset:49600
    v_mul_u32_u24 v200, 304, v186
    v_mfma_f32_16x16x32_bf16 a[68:71], v[152:155], v[84:87], a[68:71]
    ds_read_b64_tr_b16 v[150:151], v168 offset:57280
    s_waitcnt vmcnt(24)
    s_barrier
    v_mfma_f32_16x16x32_bf16 a[72:75], v[12:15], v[156:159], a[72:75]
    ds_read_b64_tr_b16 v[152:153], v169 offset:0
    v_lshrrev_b32 v187, 1, v245
    v_mfma_f32_16x16x32_bf16 a[76:79], v[84:87], v[156:159], a[76:79]
    ds_read_b64_tr_b16 v[154:155], v169 offset:7680
    s_add_u32 m0, s47, 32768
    s_nop 0
    buffer_load_dwordx4 v174, s[8:11], s46 offen  lds
    s_waitcnt lgkmcnt(6)
    v_mfma_f32_16x16x32_bf16 a[80:83], v[12:15], v[160:163], a[80:83]
    ds_read_b64_tr_b16 v[156:157], v169 offset:40
    v_mul_u32_u24 v187, 608, v187
    v_mfma_f32_16x16x32_bf16 a[84:87], v[84:87], v[160:163], a[84:87]
    ds_read_b64_tr_b16 v[158:159], v169 offset:7720
    s_add_u32 m0, s47, 36864
    s_nop 0
    buffer_load_dwordx4 v175, s[8:11], s46 offen  lds
    v_mfma_f32_16x16x32_bf16 a[88:91], v[12:15], v[164:167], a[88:91]
    ds_read_b64_tr_b16 v[160:161], v169 offset:72
    v_add_u32 v200, v200, v187
    v_mfma_f32_16x16x32_bf16 a[92:95], v[84:87], v[164:167], a[92:95]
    ds_read_b64_tr_b16 v[162:163], v169 offset:7752
    s_add_u32 m0, s47, 40960
    s_nop 0
    buffer_load_dwordx4 v176, s[8:11], s46 offen  lds
    s_waitcnt lgkmcnt(6)
    v_mfma_f32_16x16x32_bf16 a[96:99], v[12:15], v[144:147], a[96:99]
    ds_read_b64_tr_b16 v[164:165], v169 offset:112
    v_add_u32 v186, 0, v244
    v_mfma_f32_16x16x32_bf16 a[100:103], v[84:87], v[144:147], a[100:103]
    ds_read_b64_tr_b16 v[166:167], v169 offset:7792
    s_add_u32 m0, s47, 45056
    s_nop 0
    buffer_load_dwordx4 v177, s[8:11], s46 offen  lds
    s_add_u32 s46, s46, 110592
    v_mfma_f32_16x16x32_bf16 a[104:107], v[12:15], v[148:151], a[104:107]
    ds_read_b64_tr_b16 v[144:145], v169 offset:160
    v_mul_u32_u24 v187, 57, v186
    v_mfma_f32_16x16x32_bf16 a[108:111], v[84:87], v[148:151], a[108:111]
    ds_read_b64_tr_b16 v[146:147], v169 offset:7840
    s_waitcnt lgkmcnt(6)
    v_mfma_f32_16x16x32_bf16 a[0:3], v[152:155], v[16:19], a[0:3]
    ds_read_b64_tr_b16 v[148:149], v169 offset:200
    v_lshrrev_b32 v187, 10, v187
    v_mfma_f32_16x16x32_bf16 a[4:7], v[152:155], v[88:91], a[4:7]
    ds_read_b64_tr_b16 v[150:151], v169 offset:7880
    v_mfma_f32_16x16x32_bf16 a[8:11], v[156:159], v[16:19], a[8:11]
    ds_read_b64_tr_b16 v[152:153], v169 offset:232
    v_mul_u32_u24 v201, 18, v187
    v_mfma_f32_16x16x32_bf16 a[12:15], v[156:159], v[88:91], a[12:15]
    ds_read_b64_tr_b16 v[154:155], v169 offset:7912
    s_waitcnt lgkmcnt(6)
    v_mfma_f32_16x16x32_bf16 a[16:19], v[160:163], v[16:19], a[16:19]
    ds_read_b64_tr_b16 v[156:157], v169 offset:272
    v_sub_u32 v186, v186, v201
    v_mfma_f32_16x16x32_bf16 a[20:23], v[160:163], v[88:91], a[20:23]
    ds_read_b64_tr_b16 v[158:159], v169 offset:7952
    v_mfma_f32_16x16x32_bf16 a[24:27], v[164:167], v[16:19], a[24:27]
    ds_read_b64_tr_b16 v[160:161], v172 offset:0
    v_mul_u32_u24 v187, 77824, v187
    v_mfma_f32_16x16x32_bf16 a[28:31], v[164:167], v[88:91], a[28:31]
    ds_read_b64_tr_b16 v[162:163], v172 offset:7680
    s_waitcnt lgkmcnt(6)
    v_mfma_f32_16x16x32_bf16 a[32:35], v[144:147], v[16:19], a[32:35]
    ds_read_b64_tr_b16 v[164:165], v169 offset:320
    v_lshlrev_b32 v186, 4, v186
    v_mfma_f32_16x16x32_bf16 a[36:39], v[144:147], v[88:91], a[36:39]
    ds_read_b64_tr_b16 v[166:167], v169 offset:8000
    v_mfma_f32_16x16x32_bf16 a[40:43], v[148:151], v[16:19], a[40:43]
    ds_read_b64_tr_b16 v[144:145], v169 offset:352
    v_add3_u32 v248, v186, v187, v200
    v_mfma_f32_16x16x32_bf16 a[44:47], v[148:151], v[88:91], a[44:47]
    ds_read_b64_tr_b16 v[146:147], v169 offset:8032
    s_waitcnt lgkmcnt(6)
    v_mfma_f32_16x16x32_bf16 a[48:51], v[152:155], v[16:19], a[48:51]
    ds_read_b64_tr_b16 v[148:149], v169 offset:384
    v_add_u32 v186, 16, v244
    v_mfma_f32_16x16x32_bf16 a[52:55], v[152:155], v[88:91], a[52:55]
    ds_read_b64_tr_b16 v[150:151], v169 offset:8064
    v_mfma_f32_16x16x32_bf16 a[56:59], v[156:159], v[16:19], a[56:59]
    ds_read_b64_tr_b16 v[152:153], v169 offset:416
    v_mul_u32_u24 v187, 57, v186
    v_mfma_f32_16x16x32_bf16 a[60:63], v[156:159], v[88:91], a[60:63]
    ds_read_b64_tr_b16 v[154:155], v169 offset:8096
    s_waitcnt lgkmcnt(6)
    v_mfma_f32_16x16x32_bf16 a[64:67], v[160:163], v[16:19], a[64:67]
    ds_read_b64_tr_b16 v[156:157], v169 offset:448
    v_lshrrev_b32 v187, 10, v187
    v_mfma_f32_16x16x32_bf16 a[68:71], v[160:163], v[88:91], a[68:71]
    ds_read_b64_tr_b16 v[158:159], v169 offset:8128
    s_waitcnt vmcnt(24)
    s_barrier
    v_mfma_f32_16x16x32_bf16 a[72:75], v[16:19], v[164:167], a[72:75]
    ds_read_b64_tr_b16 v[160:161], v169 offset:16384
    v_mul_u32_u24 v201, 18, v187
    v_mfma_f32_16x16x32_bf16 a[76:79], v[88:91], v[164:167], a[76:79]
    ds_read_b64_tr_b16 v[162:163], v169 offset:24064
    s_add_u32 m0, s47, 49152
    s_nop 0
    buffer_load_dwordx4 v174, s[8:11], s46 offen  lds
    s_waitcnt lgkmcnt(6)
    v_mfma_f32_16x16x32_bf16 a[80:83], v[16:19], v[144:147], a[80:83]
    ds_read_b64_tr_b16 v[164:165], v169 offset:16424
    v_sub_u32 v186, v186, v201
    v_mfma_f32_16x16x32_bf16 a[84:87], v[88:91], v[144:147], a[84:87]
    ds_read_b64_tr_b16 v[166:167], v169 offset:24104
    s_add_u32 m0, s47, 53248
    s_nop 0
    buffer_load_dwordx4 v175, s[8:11], s46 offen  lds
    v_mfma_f32_16x16x32_bf16 a[88:91], v[16:19], v[148:151], a[88:91]
    ds_read_b64_tr_b16 v[144:145], v169 offset:16456
    v_mul_u32_u24 v187, 77824, v187
    v_mfma_f32_16x16x32_bf16 a[92:95], v[88:91], v[148:151], a[92:95]
    ds_read_b64_tr_b16 v[146:147], v169 offset:24136
    s_add_u32 m0, s47, 57344
    s_nop 0
    buffer_load_dwordx4 v176, s[8:11], s46 offen  lds
    s_waitcnt lgkmcnt(6)
    v_mfma_f32_16x16x32_bf16 a[96:99], v[16:19], v[152:155], a[96:99]
    ds_read_b64_tr_b16 v[148:149], v169 offset:16496
    v_lshlrev_b32 v186, 4, v186
    v_mfma_f32_16x16x32_bf16 a[100:103], v[88:91], v[152:155], a[100:103]
    ds_read_b64_tr_b16 v[150:151], v169 offset:24176
    s_add_u32 m0, s47, 61440
    s_nop 0
    buffer_load_dwordx4 v177, s[8:11], s46 offen  lds
    s_add_u32 s46, s46, 110592
    v_mfma_f32_16x16x32_bf16 a[104:107], v[16:19], v[156:159], a[104:107]
    ds_read_b64_tr_b16 v[152:153], v169 offset:16544
    v_add3_u32 v249, v186, v187, v200
    v_mfma_f32_16x16x32_bf16 a[108:111], v[88:91], v[156:159], a[108:111]
    ds_read_b64_tr_b16 v[154:155], v169 offset:24224
    s_waitcnt lgkmcnt(6)
    v_mfma_f32_16x16x32_bf16 a[0:3], v[160:163], v[20:23], a[0:3]
    ds_read_b64_tr_b16 v[156:157], v169 offset:16584
    v_add_u32 v186, 32, v244
    v_mfma_f32_16x16x32_bf16 a[4:7], v[160:163], v[92:95], a[4:7]
    ds_read_b64_tr_b16 v[158:159], v169 offset:24264
    v_mfma_f32_16x16x32_bf16 a[8:11], v[164:167], v[20:23], a[8:11]
    ds_read_b64_tr_b16 v[160:161], v169 offset:16616
    v_mul_u32_u24 v187, 57, v186
    v_mfma_f32_16x16x32_bf16 a[12:15], v[164:167], v[92:95], a[12:15]
    ds_read_b64_tr_b16 v[162:163], v169 offset:24296
    s_waitcnt lgkmcnt(6)
    v_mfma_f32_16x16x32_bf16 a[16:19], v[144:147], v[20:23], a[16:19]
    ds_read_b64_tr_b16 v[164:165], v169 offset:16656
    v_lshrrev_b32 v187, 10, v187
    v_mfma_f32_16x16x32_bf16 a[20:23], v[144:147], v[92:95], a[20:23]
    ds_read_b64_tr_b16 v[166:167], v169 offset:24336
    v_mfma_f32_16x16x32_bf16 a[24:27], v[148:151], v[20:23], a[24:27]
    ds_read_b64_tr_b16 v[144:145], v172 offset:16384
    v_mul_u32_u24 v201, 18, v187
    v_mfma_f32_16x16x32_bf16 a[28:31], v[148:151], v[92:95], a[28:31]
    ds_read_b64_tr_b16 v[146:147], v172 offset:24064
    s_waitcnt lgkmcnt(6)
    v_mfma_f32_16x16x32_bf16 a[32:35], v[152:155], v[20:23], a[32:35]
    ds_read_b64_tr_b16 v[148:149], v169 offset:16704
    v_sub_u32 v186, v186, v201
    v_mfma_f32_16x16x32_bf16 a[36:39], v[152:155], v[92:95], a[36:39]
    ds_read_b64_tr_b16 v[150:151], v169 offset:24384
    v_mfma_f32_16x16x32_bf16 a[40:43], v[156:159], v[20:23], a[40:43]
    ds_read_b64_tr_b16 v[152:153], v169 offset:16736
    v_mul_u32_u24 v187, 77824, v187
    v_mfma_f32_16x16x32_bf16 a[44:47], v[156:159], v[92:95], a[44:47]
    ds_read_b64_tr_b16 v[154:155], v169 offset:24416
    s_waitcnt lgkmcnt(6)
    v_mfma_f32_16x16x32_bf16 a[48:51], v[160:163], v[20:23], a[48:51]
    ds_read_b64_tr_b16 v[156:157], v169 offset:16768
    v_lshlrev_b32 v186, 4, v186
    v_mfma_f32_16x16x32_bf16 a[52:55], v[160:163], v[92:95], a[52:55]
    ds_read_b64_tr_b16 v[158:159], v169 offset:24448
    v_mfma_f32_16x16x32_bf16 a[56:59], v[164:167], v[20:23], a[56:59]
    ds_read_b64_tr_b16 v[160:161], v169 offset:16800
    v_add3_u32 v250, v186, v187, v200
    v_mfma_f32_16x16x32_bf16 a[60:63], v[164:167], v[92:95], a[60:63]
    ds_read_b64_tr_b16 v[162:163], v169 offset:24480
    s_waitcnt lgkmcnt(6)
    v_mfma_f32_16x16x32_bf16 a[64:67], v[144:147], v[20:23], a[64:67]
    ds_read_b64_tr_b16 v[164:165], v169 offset:16832
    v_add_u32 v186, 48, v244
    v_mfma_f32_16x16x32_bf16 a[68:71], v[144:147], v[92:95], a[68:71]
    ds_read_b64_tr_b16 v[166:167], v169 offset:24512
    s_waitcnt vmcnt(24)
    s_barrier
    v_mfma_f32_16x16x32_bf16 a[72:75], v[20:23], v[148:151], a[72:75]
    ds_read_b64_tr_b16 v[144:145], v169 offset:32768
    v_mul_u32_u24 v187, 57, v186
    v_mfma_f32_16x16x32_bf16 a[76:79], v[92:95], v[148:151], a[76:79]
    ds_read_b64_tr_b16 v[146:147], v169 offset:40448
    s_add_u32 m0, s47, 65536
    s_nop 0
    buffer_load_dwordx4 v174, s[8:11], s46 offen  lds
    s_waitcnt lgkmcnt(6)
    v_mfma_f32_16x16x32_bf16 a[80:83], v[20:23], v[152:155], a[80:83]
    ds_read_b64_tr_b16 v[148:149], v169 offset:32808
    v_lshrrev_b32 v187, 10, v187
    v_mfma_f32_16x16x32_bf16 a[84:87], v[92:95], v[152:155], a[84:87]
    ds_read_b64_tr_b16 v[150:151], v169 offset:40488
    s_add_u32 m0, s47, 69632
    s_nop 0
    buffer_load_dwordx4 v175, s[8:11], s46 offen  lds
    v_mfma_f32_16x16x32_bf16 a[88:91], v[20:23], v[156:159], a[88:91]
    ds_read_b64_tr_b16 v[152:153], v169 offset:32840
    v_mul_u32_u24 v201, 18, v187
    v_mfma_f32_16x16x32_bf16 a[92:95], v[92:95], v[156:159], a[92:95]
    ds_read_b64_tr_b16 v[154:155], v169 offset:40520
    s_add_u32 m0, s47, 73728
    s_nop 0
    buffer_load_dwordx4 v176, s[8:11], s46 offen  lds
    s_waitcnt lgkmcnt(6)
    v_mfma_f32_16x16x32_bf16 a[96:99], v[20:23], v[160:163], a[96:99]
    ds_read_b64_tr_b16 v[156:157], v169 offset:32880
    v_sub_u32 v186, v186, v201
    v_mfma_f32_16x16x32_bf16 a[100:103], v[92:95], v[160:163], a[100:103]
    ds_read_b64_tr_b16 v[158:159], v169 offset:40560
    s_add_u32 m0, s47, 77824
    s_nop 0
    buffer_load_dwordx4 v177, s[8:11], s46 offen  lds
    s_add_u32 s46, s46, 110592
    v_mfma_f32_16x16x32_bf16 a[104:107], v[20:23], v[164:167], a[104:107]
    ds_read_b64_tr_b16 v[160:161], v169 offset:32928
    v_mul_u32_u24 v187, 77824, v187
    v_mfma_f32_16x16x32_bf16 a[108:111], v[92:95], v[164:167], a[108:111]
    ds_read_b64_tr_b16 v[162:163], v169 offset:40608
    s_waitcnt lgkmcnt(6)
    v_mfma_f32_16x16x32_bf16 a[0:3], v[144:147], v[24:27], a[0:3]
    ds_read_b64_tr_b16 v[164:165], v169 offset:32968
    v_lshlrev_b32 v186, 4, v186
    v_mfma_f32_16x16x32_bf16 a[4:7], v[144:147], v[96:99], a[4:7]
    ds_read_b64_tr_b16 v[166:167], v169 offset:40648
    v_mfma_f32_16x16x32_bf16 a[8:11], v[148:151], v[24:27], a[8:11]
    ds_read_b64_tr_b16 v[144:145], v169 offset:33000
    v_add3_u32 v251, v186, v187, v200
    v_mfma_f32_16x16x32_bf16 a[12:15], v[148:151], v[96:99], a[12:15]
    ds_read_b64_tr_b16 v[146:147], v169 offset:40680
    s_waitcnt lgkmcnt(6)
    v_mfma_f32_16x16x32_bf16 a[16:19], v[152:155], v[24:27], a[16:19]
    ds_read_b64_tr_b16 v[148:149], v169 offset:33040
    v_add_u32 v186, 64, v244
    v_mfma_f32_16x16x32_bf16 a[20:23], v[152:155], v[96:99], a[20:23]
    ds_read_b64_tr_b16 v[150:151], v169 offset:40720
    v_mfma_f32_16x16x32_bf16 a[24:27], v[156:159], v[24:27], a[24:27]
    ds_read_b64_tr_b16 v[152:153], v172 offset:32768
    v_subrev_u32 v187, 8, v244
    v_mfma_f32_16x16x32_bf16 a[28:31], v[156:159], v[96:99], a[28:31]
    ds_read_b64_tr_b16 v[154:155], v172 offset:40448
    s_waitcnt lgkmcnt(6)
    v_mfma_f32_16x16x32_bf16 a[32:35], v[160:163], v[24:27], a[32:35]
    ds_read_b64_tr_b16 v[156:157], v169 offset:33088
    v_cmp_gt_u32 vcc, 8, v244
    v_mfma_f32_16x16x32_bf16 a[36:39], v[160:163], v[96:99], a[36:39]
    ds_read_b64_tr_b16 v[158:159], v169 offset:40768
    v_mfma_f32_16x16x32_bf16 a[40:43], v[164:167], v[24:27], a[40:43]
    ds_read_b64_tr_b16 v[160:161], v169 offset:33120
    v_mov_b32 v201, 3
    v_mfma_f32_16x16x32_bf16 a[44:47], v[164:167], v[96:99], a[44:47]
    ds_read_b64_tr_b16 v[162:163], v169 offset:40800
    s_waitcnt lgkmcnt(6)
    v_mfma_f32_16x16x32_bf16 a[48:51], v[144:147], v[24:27], a[48:51]
    ds_read_b64_tr_b16 v[164:165], v169 offset:33152
    v_mov_b32 v202, 18
    v_mfma_f32_16x16x32_bf16 a[52:55], v[144:147], v[96:99], a[52:55]
    ds_read_b64_tr_b16 v[166:167], v169 offset:40832
    v_mfma_f32_16x16x32_bf16 a[56:59], v[148:151], v[24:27], a[56:59]
    ds_read_b64_tr_b16 v[144:145], v169 offset:33184
    v_cndmask_b32 v187, v187, v201, vcc
    v_mfma_f32_16x16x32_bf16 a[60:63], v[148:151], v[96:99], a[60:63]
    ds_read_b64_tr_b16 v[146:147], v169 offset:40864
    s_waitcnt lgkmcnt(6)
    v_mfma_f32_16x16x32_bf16 a[64:67], v[152:155], v[24:27], a[64:67]
    ds_read_b64_tr_b16 v[148:149], v169 offset:33216
    v_add_u32 v186, 10, v244
    v_mfma_f32_16x16x32_bf16 a[68:71], v[152:155], v[96:99], a[68:71]
    ds_read_b64_tr_b16 v[150:151], v169 offset:40896
    s_waitcnt vmcnt(24)
    s_barrier
    v_mfma_f32_16x16x32_bf16 a[72:75], v[24:27], v[156:159], a[72:75]
    ds_read_b64_tr_b16 v[152:153], v169 offset:49152
    v_cndmask_b32 v186, v202, v186, vcc
    v_mfma_f32_16x16x32_bf16 a[76:79], v[96:99], v[156:159], a[76:79]
    ds_read_b64_tr_b16 v[154:155], v169 offset:56832
    s_add_u32 m0, s47, 81920
    s_nop 0
    buffer_load_dwordx4 v174, s[8:11], s46 offen  lds
    s_waitcnt lgkmcnt(6)
    v_mfma_f32_16x16x32_bf16 a[80:83], v[24:27], v[160:163], a[80:83]
    ds_read_b64_tr_b16 v[156:157], v169 offset:49192
    v_mul_u32_u24 v187, 77824, v187
    v_mfma_f32_16x16x32_bf16 a[84:87], v[96:99], v[160:163], a[84:87]
    ds_read_b64_tr_b16 v[158:159], v169 offset:56872
    s_add_u32 m0, s47, 86016
    s_nop 0
    buffer_load_dwordx4 v175, s[8:11], s46 offen  lds
    v_mfma_f32_16x16x32_bf16 a[88:91], v[24:27], v[164:167], a[88:91]
    ds_read_b64_tr_b16 v[160:161], v169 offset:49224
    v_lshlrev_b32 v186, 4, v186
    v_mfma_f32_16x16x32_bf16 a[92:95], v[96:99], v[164:167], a[92:95]
    ds_read_b64_tr_b16 v[162:163], v169 offset:56904
    s_add_u32 m0, s47, 90112
    s_nop 0
    buffer_load_dwordx4 v176, s[8:11], s46 offen  lds
    s_waitcnt lgkmcnt(6)
    v_mfma_f32_16x16x32_bf16 a[96:99], v[24:27], v[144:147], a[96:99]
    ds_read_b64_tr_b16 v[164:165], v169 offset:49264
    v_add3_u32 v252, v186, v187, v200
    v_mfma_f32_16x16x32_bf16 a[100:103], v[96:99], v[144:147], a[100:103]
    ds_read_b64_tr_b16 v[166:167], v169 offset:56944
    s_add_u32 m0, s47, 94208
    s_nop 0
    buffer_load_dwordx4 v177, s[8:11], s46 offen  lds
    s_add_u32 s46, s46, 110592
    v_mfma_f32_16x16x32_bf16 a[104:107], v[24:27], v[148:151], a[104:107]
    ds_read_b64_tr_b16 v[144:145], v169 offset:49312
    v_mov_b32 v201, 0x80000000
    v_mfma_f32_16x16x32_bf16 a[108:111], v[96:99], v[148:151], a[108:111]
    ds_read_b64_tr_b16 v[146:147], v169 offset:56992
    s_waitcnt lgkmcnt(6)
    v_mfma_f32_16x16x32_bf16 a[0:3], v[152:155], v[28:31], a[0:3]
    ds_read_b64_tr_b16 v[148:149], v169 offset:49352
    v_cmp_gt_u32 vcc, 12, v244
    v_mfma_f32_16x16x32_bf16 a[4:7], v[152:155], v[100:103], a[4:7]
    ds_read_b64_tr_b16 v[150:151], v169 offset:57032
    v_mfma_f32_16x16x32_bf16 a[8:11], v[156:159], v[28:31], a[8:11]
    ds_read_b64_tr_b16 v[152:153], v169 offset:49384
    v_cndmask_b32 v252, v201, v252, vcc
    v_mfma_f32_16x16x32_bf16 a[12:15], v[156:159], v[100:103], a[12:15]
    ds_read_b64_tr_b16 v[154:155], v169 offset:57064
    s_waitcnt lgkmcnt(6)
    v_mfma_f32_16x16x32_bf16 a[16:19], v[160:163], v[28:31], a[16:19]
    ds_read_b64_tr_b16 v[156:157], v169 offset:49424
    s_lshl_b32 s40, s44, 2
    s_add_u32 s40, s40, s37
    s_lshl_b32 s48, s40, 10
    s_lshl_b32 s41, s45, 18
    s_add_u32 s48, s48, s41
    s_add_u32 s49, s48, 2097152
    s_lshl_b32 s50, s40, 8
    s_lshl_b32 s41, s45, 16
    s_add_u32 s50, s50, s41
    s_add_u32 s50, s50, 4194304
    s_mul_i32 s51, s40, 1216
    s_mul_i32 s41, s45, 311296
    s_add_u32 s51, s51, s41
    s_add_u32 s51, s51, 5242880
    v_mfma_f32_16x16x32_bf16 a[20:23], v[160:163], v[100:103], a[20:23]
    ds_read_b64_tr_b16 v[158:159], v169 offset:57104
    v_mfma_f32_16x16x32_bf16 a[24:27], v[164:167], v[28:31], a[24:27]
    ds_read_b64_tr_b16 v[160:161], v172 offset:49152
    v_mfma_f32_16x16x32_bf16 a[28:31], v[164:167], v[100:103], a[28:31]
    ds_read_b64_tr_b16 v[162:163], v172 offset:56832
    s_waitcnt lgkmcnt(6)
    v_mfma_f32_16x16x32_bf16 a[32:35], v[144:147], v[28:31], a[32:35]
    ds_read_b64_tr_b16 v[164:165], v169 offset:49472
    v_mfma_f32_16x16x32_bf16 a[36:39], v[144:147], v[100:103], a[36:39]
    ds_read_b64_tr_b16 v[166:167], v169 offset:57152
    v_mfma_f32_16x16x32_bf16 a[40:43], v[148:151], v[28:31], a[40:43]
    ds_read_b64_tr_b16 v[144:145], v169 offset:49504
    v_mfma_f32_16x16x32_bf16 a[44:47], v[148:151], v[100:103], a[44:47]
    ds_read_b64_tr_b16 v[146:147], v169 offset:57184
    s_waitcnt lgkmcnt(6)
    v_mfma_f32_16x16x32_bf16 a[48:51], v[152:155], v[28:31], a[48:51]
    ds_read_b64_tr_b16 v[148:149], v169 offset:49536
    v_mfma_f32_16x16x32_bf16 a[52:55], v[152:155], v[100:103], a[52:55]
    ds_read_b64_tr_b16 v[150:151], v169 offset:57216
    v_mfma_f32_16x16x32_bf16 a[56:59], v[156:159], v[28:31], a[56:59]
    ds_read_b64_tr_b16 v[152:153], v169 offset:49568
    v_mfma_f32_16x16x32_bf16 a[60:63], v[156:159], v[100:103], a[60:63]
    ds_read_b64_tr_b16 v[154:155], v169 offset:57248
    s_waitcnt lgkmcnt(6)
    v_mfma_f32_16x16x32_bf16 a[64:67], v[160:163], v[28:31], a[64:67]
    ds_read_b64_tr_b16 v[156:157], v169 offset:49600
    v_mfma_f32_16x16x32_bf16 a[68:71], v[160:163], v[100:103], a[68:71]
    ds_read_b64_tr_b16 v[158:159], v169 offset:57280
    s_waitcnt vmcnt(24)
    s_barrier
    v_mfma_f32_16x16x32_bf16 a[72:75], v[28:31], v[164:167], a[72:75]
    ds_read_b64_tr_b16 v[160:161], v170 offset:0
    v_mfma_f32_16x16x32_bf16 a[76:79], v[100:103], v[164:167], a[76:79]
    ds_read_b64_tr_b16 v[162:163], v170 offset:7680
    s_add_u32 m0, s47, 98304
    s_nop 0
    buffer_load_dwordx4 v174, s[8:11], s46 offen  lds
    s_waitcnt lgkmcnt(6)
    v_mfma_f32_16x16x32_bf16 a[80:83], v[28:31], v[144:147], a[80:83]
    ds_read_b64_tr_b16 v[164:165], v170 offset:40
    v_mfma_f32_16x16x32_bf16 a[84:87], v[100:103], v[144:147], a[84:87]
    ds_read_b64_tr_b16 v[166:167], v170 offset:7720
    s_add_u32 m0, s47, 102400
    s_nop 0
    buffer_load_dwordx4 v175, s[8:11], s46 offen  lds
    v_mfma_f32_16x16x32_bf16 a[88:91], v[28:31], v[148:151], a[88:91]
    ds_read_b64_tr_b16 v[144:145], v170 offset:72
    v_mfma_f32_16x16x32_bf16 a[92:95], v[100:103], v[148:151], a[92:95]
    ds_read_b64_tr_b16 v[146:147], v170 offset:7752
    s_add_u32 m0, s47, 106496
    s_nop 0
    buffer_load_dwordx4 v176, s[8:11], s46 offen  lds
    s_waitcnt lgkmcnt(6)
    v_mfma_f32_16x16x32_bf16 a[96:99], v[28:31], v[152:155], a[96:99]
    ds_read_b64_tr_b16 v[148:149], v170 offset:112
    v_mfma_f32_16x16x32_bf16 a[100:103], v[100:103], v[152:155], a[100:103]
    ds_read_b64_tr_b16 v[150:151], v170 offset:7792
    s_add_u32 m0, s47, 110592
    s_nop 0
    buffer_load_dwordx4 v177, s[8:11], s46 offen  lds
    s_add_u32 s46, s46, 110592
    v_mfma_f32_16x16x32_bf16 a[104:107], v[28:31], v[156:159], a[104:107]
    ds_read_b64_tr_b16 v[152:153], v170 offset:160
    v_mfma_f32_16x16x32_bf16 a[108:111], v[100:103], v[156:159], a[108:111]
    ds_read_b64_tr_b16 v[154:155], v170 offset:7840
    s_waitcnt lgkmcnt(6)
    v_mfma_f32_16x16x32_bf16 a[0:3], v[160:163], v[32:35], a[0:3]
    ds_read_b64_tr_b16 v[156:157], v170 offset:200
    v_mfma_f32_16x16x32_bf16 a[4:7], v[160:163], v[104:107], a[4:7]
    ds_read_b64_tr_b16 v[158:159], v170 offset:7880
    v_mfma_f32_16x16x32_bf16 a[8:11], v[164:167], v[32:35], a[8:11]
    ds_read_b64_tr_b16 v[160:161], v170 offset:232
    v_mfma_f32_16x16x32_bf16 a[12:15], v[164:167], v[104:107], a[12:15]
    ds_read_b64_tr_b16 v[162:163], v170 offset:7912
    s_waitcnt lgkmcnt(6)
    v_mfma_f32_16x16x32_bf16 a[16:19], v[144:147], v[32:35], a[16:19]
    ds_read_b64_tr_b16 v[164:165], v170 offset:272
    v_mfma_f32_16x16x32_bf16 a[20:23], v[144:147], v[104:107], a[20:23]
    ds_read_b64_tr_b16 v[166:167], v170 offset:7952
    v_mfma_f32_16x16x32_bf16 a[24:27], v[148:151], v[32:35], a[24:27]
    ds_read_b64_tr_b16 v[144:145], v173 offset:0
    v_mfma_f32_16x16x32_bf16 a[28:31], v[148:151], v[104:107], a[28:31]
    ds_read_b64_tr_b16 v[146:147], v173 offset:7680
    s_waitcnt lgkmcnt(6)
    v_mfma_f32_16x16x32_bf16 a[32:35], v[152:155], v[32:35], a[32:35]
    ds_read_b64_tr_b16 v[148:149], v170 offset:320
    v_mfma_f32_16x16x32_bf16 a[36:39], v[152:155], v[104:107], a[36:39]
    ds_read_b64_tr_b16 v[150:151], v170 offset:8000
    v_mfma_f32_16x16x32_bf16 a[40:43], v[156:159], v[32:35], a[40:43]
    ds_read_b64_tr_b16 v[152:153], v170 offset:352
    v_mfma_f32_16x16x32_bf16 a[44:47], v[156:159], v[104:107], a[44:47]
    ds_read_b64_tr_b16 v[154:155], v170 offset:8032
    s_waitcnt lgkmcnt(6)
    v_mfma_f32_16x16x32_bf16 a[48:51], v[160:163], v[32:35], a[48:51]
    ds_read_b64_tr_b16 v[156:157], v170 offset:384
    v_mfma_f32_16x16x32_bf16 a[52:55], v[160:163], v[104:107], a[52:55]
    ds_read_b64_tr_b16 v[158:159], v170 offset:8064
    v_mfma_f32_16x16x32_bf16 a[56:59], v[164:167], v[32:35], a[56:59]
    ds_read_b64_tr_b16 v[160:161], v170 offset:416
    v_mfma_f32_16x16x32_bf16 a[60:63], v[164:167], v[104:107], a[60:63]
    ds_read_b64_tr_b16 v[162:163], v170 offset:8096
    s_waitcnt lgkmcnt(6)
    v_mfma_f32_16x16x32_bf16 a[64:67], v[144:147], v[32:35], a[64:67]
    ds_read_b64_tr_b16 v[164:165], v170 offset:448
    v_mfma_f32_16x16x32_bf16 a[68:71], v[144:147], v[104:107], a[68:71]
    ds_read_b64_tr_b16 v[166:167], v170 offset:8128
    s_waitcnt vmcnt(24)
    s_barrier
    v_mfma_f32_16x16x32_bf16 a[72:75], v[32:35], v[148:151], a[72:75]
    ds_read_b64_tr_b16 v[144:145], v168 offset:0
    v_mfma_f32_16x16x32_bf16 a[76:79], v[104:107], v[148:151], a[76:79]
    ds_read_b64_tr_b16 v[146:147], v168 offset:7680
    s_add_u32 m0, s47, 114688
    s_nop 0
    buffer_load_dwordx4 v174, s[8:11], s46 offen  lds
    s_waitcnt lgkmcnt(6)
    v_mfma_f32_16x16x32_bf16 a[80:83], v[32:35], v[152:155], a[80:83]
    ds_read_b64_tr_b16 v[148:149], v168 offset:40
    v_mfma_f32_16x16x32_bf16 a[84:87], v[104:107], v[152:155], a[84:87]
    ds_read_b64_tr_b16 v[150:151], v168 offset:7720
    s_add_u32 m0, s47, 118784
    s_nop 0
    buffer_load_dwordx4 v175, s[8:11], s46 offen  lds
    v_mfma_f32_16x16x32_bf16 a[88:91], v[32:35], v[156:159], a[88:91]
    ds_read_b64_tr_b16 v[152:153], v168 offset:72
    v_mfma_f32_16x16x32_bf16 a[92:95], v[104:107], v[156:159], a[92:95]
    ds_read_b64_tr_b16 v[154:155], v168 offset:7752
    s_add_u32 m0, s47, 122880
    s_nop 0
    buffer_load_dwordx4 v176, s[8:11], s46 offen  lds
    s_waitcnt lgkmcnt(6)
    v_mfma_f32_16x16x32_bf16 a[96:99], v[32:35], v[160:163], a[96:99]
    ds_read_b64_tr_b16 v[156:157], v168 offset:112
    v_mfma_f32_16x16x32_bf16 a[100:103], v[104:107], v[160:163], a[100:103]
    ds_read_b64_tr_b16 v[158:159], v168 offset:7792
    s_add_u32 m0, s47, 126976
    s_nop 0
    buffer_load_dwordx4 v177, s[8:11], s46 offen  lds
    s_add_u32 s46, s46, 110592
    v_mfma_f32_16x16x32_bf16 a[104:107], v[32:35], v[164:167], a[104:107]
    ds_read_b64_tr_b16 v[160:161], v168 offset:160
    v_mfma_f32_16x16x32_bf16 a[108:111], v[104:107], v[164:167], a[108:111]
    ds_read_b64_tr_b16 v[162:163], v168 offset:7840
    s_waitcnt lgkmcnt(6)
    v_mfma_f32_16x16x32_bf16 a[0:3], v[144:147], v[36:39], a[0:3]
    ds_read_b64_tr_b16 v[164:165], v168 offset:200
    v_mfma_f32_16x16x32_bf16 a[4:7], v[144:147], v[108:111], a[4:7]
    ds_read_b64_tr_b16 v[166:167], v168 offset:7880
    v_mfma_f32_16x16x32_bf16 a[8:11], v[148:151], v[36:39], a[8:11]
    ds_read_b64_tr_b16 v[144:145], v168 offset:232
    v_mfma_f32_16x16x32_bf16 a[12:15], v[148:151], v[108:111], a[12:15]
    ds_read_b64_tr_b16 v[146:147], v168 offset:7912
    s_waitcnt lgkmcnt(6)
    v_mfma_f32_16x16x32_bf16 a[16:19], v[152:155], v[36:39], a[16:19]
    ds_read_b64_tr_b16 v[148:149], v168 offset:272
    v_mfma_f32_16x16x32_bf16 a[20:23], v[152:155], v[108:111], a[20:23]
    ds_read_b64_tr_b16 v[150:151], v168 offset:7952
    v_mfma_f32_16x16x32_bf16 a[24:27], v[156:159], v[36:39], a[24:27]
    ds_read_b64_tr_b16 v[152:153], v171 offset:0
    v_mfma_f32_16x16x32_bf16 a[28:31], v[156:159], v[108:111], a[28:31]
    ds_read_b64_tr_b16 v[154:155], v171 offset:7680
    s_waitcnt lgkmcnt(6)
    v_mfma_f32_16x16x32_bf16 a[32:35], v[160:163], v[36:39], a[32:35]
    ds_read_b64_tr_b16 v[156:157], v168 offset:320
    v_mfma_f32_16x16x32_bf16 a[36:39], v[160:163], v[108:111], a[36:39]
    ds_read_b64_tr_b16 v[158:159], v168 offset:8000
    v_mfma_f32_16x16x32_bf16 a[40:43], v[164:167], v[36:39], a[40:43]
    ds_read_b64_tr_b16 v[160:161], v168 offset:352
    v_mfma_f32_16x16x32_bf16 a[44:47], v[164:167], v[108:111], a[44:47]
    ds_read_b64_tr_b16 v[162:163], v168 offset:8032
    s_waitcnt lgkmcnt(6)
    v_mfma_f32_16x16x32_bf16 a[48:51], v[144:147], v[36:39], a[48:51]
    ds_read_b64_tr_b16 v[164:165], v168 offset:384
    v_mfma_f32_16x16x32_bf16 a[52:55], v[144:147], v[108:111], a[52:55]
    ds_read_b64_tr_b16 v[166:167], v168 offset:8064
    v_mfma_f32_16x16x32_bf16 a[56:59], v[148:151], v[36:39], a[56:59]
    ds_read_b64_tr_b16 v[144:145], v168 offset:416
    v_mfma_f32_16x16x32_bf16 a[60:63], v[148:151], v[108:111], a[60:63]
    ds_read_b64_tr_b16 v[146:147], v168 offset:8096
    s_waitcnt lgkmcnt(6)
    v_mfma_f32_16x16x32_bf16 a[64:67], v[152:155], v[36:39], a[64:67]
    ds_read_b64_tr_b16 v[148:149], v168 offset:448
    v_mfma_f32_16x16x32_bf16 a[68:71], v[152:155], v[108:111], a[68:71]
    ds_read_b64_tr_b16 v[150:151], v168 offset:8128
    s_waitcnt vmcnt(24)
    s_barrier
    v_mfma_f32_16x16x32_bf16 a[72:75], v[36:39], v[156:159], a[72:75]
    ds_read_b64_tr_b16 v[152:153], v168 offset:16384
    v_mfma_f32_16x16x32_bf16 a[76:79], v[108:111], v[156:159], a[76:79]
    ds_read_b64_tr_b16 v[154:155], v168 offset:24064
    s_add_u32 m0, s47, 131072
    s_nop 0
    buffer_load_dwordx4 v174, s[8:11], s46 offen  lds
    s_waitcnt lgkmcnt(6)
    v_mfma_f32_16x16x32_bf16 a[80:83], v[36:39], v[160:163], a[80:83]
    ds_read_b64_tr_b16 v[156:157], v168 offset:16424
    v_mfma_f32_16x16x32_bf16 a[84:87], v[108:111], v[160:163], a[84:87]
    ds_read_b64_tr_b16 v[158:159], v168 offset:24104
    s_add_u32 m0, s47, 135168
    s_nop 0
    buffer_load_dwordx4 v175, s[8:11], s46 offen  lds
    v_mfma_f32_16x16x32_bf16 a[88:91], v[36:39], v[164:167], a[88:91]
    ds_read_b64_tr_b16 v[160:161], v168 offset:16456
    v_mfma_f32_16x16x32_bf16 a[92:95], v[108:111], v[164:167], a[92:95]
    ds_read_b64_tr_b16 v[162:163], v168 offset:24136
    s_add_u32 m0, s47, 139264
    s_nop 0
    buffer_load_dwordx4 v176, s[8:11], s46 offen  lds
    s_waitcnt lgkmcnt(6)
    v_mfma_f32_16x16x32_bf16 a[96:99], v[36:39], v[144:147], a[96:99]
    ds_read_b64_tr_b16 v[164:165], v168 offset:16496
    v_mfma_f32_16x16x32_bf16 a[100:103], v[108:111], v[144:147], a[100:103]
    ds_read_b64_tr_b16 v[166:167], v168 offset:24176
    s_add_u32 m0, s47, 143360
    s_nop 0
    buffer_load_dwordx4 v177, s[8:11], s46 offen  lds
    s_add_u32 s46, s46, 110592
    v_mfma_f32_16x16x32_bf16 a[104:107], v[36:39], v[148:151], a[104:107]
    ds_read_b64_tr_b16 v[144:145], v168 offset:16544
    v_mfma_f32_16x16x32_bf16 a[108:111], v[108:111], v[148:151], a[108:111]
    ds_read_b64_tr_b16 v[146:147], v168 offset:24224
    s_waitcnt lgkmcnt(6)
    v_mfma_f32_16x16x32_bf16 a[0:3], v[152:155], v[40:43], a[0:3]
    ds_read_b64_tr_b16 v[148:149], v168 offset:16584
    v_mfma_f32_16x16x32_bf16 a[4:7], v[152:155], v[112:115], a[4:7]
    ds_read_b64_tr_b16 v[150:151], v168 offset:24264
    v_mfma_f32_16x16x32_bf16 a[8:11], v[156:159], v[40:43], a[8:11]
    ds_read_b64_tr_b16 v[152:153], v168 offset:16616
    v_mfma_f32_16x16x32_bf16 a[12:15], v[156:159], v[112:115], a[12:15]
    ds_read_b64_tr_b16 v[154:155], v168 offset:24296
    s_waitcnt lgkmcnt(6)
    v_mfma_f32_16x16x32_bf16 a[16:19], v[160:163], v[40:43], a[16:19]
    ds_read_b64_tr_b16 v[156:157], v168 offset:16656
    v_mfma_f32_16x16x32_bf16 a[20:23], v[160:163], v[112:115], a[20:23]
    ds_read_b64_tr_b16 v[158:159], v168 offset:24336
    v_mfma_f32_16x16x32_bf16 a[24:27], v[164:167], v[40:43], a[24:27]
    ds_read_b64_tr_b16 v[160:161], v171 offset:16384
    v_mfma_f32_16x16x32_bf16 a[28:31], v[164:167], v[112:115], a[28:31]
    ds_read_b64_tr_b16 v[162:163], v171 offset:24064
    s_waitcnt lgkmcnt(6)
    v_mfma_f32_16x16x32_bf16 a[32:35], v[144:147], v[40:43], a[32:35]
    ds_read_b64_tr_b16 v[164:165], v168 offset:16704
    v_mfma_f32_16x16x32_bf16 a[36:39], v[144:147], v[112:115], a[36:39]
    ds_read_b64_tr_b16 v[166:167], v168 offset:24384
    v_mfma_f32_16x16x32_bf16 a[40:43], v[148:151], v[40:43], a[40:43]
    ds_read_b64_tr_b16 v[144:145], v168 offset:16736
    v_mfma_f32_16x16x32_bf16 a[44:47], v[148:151], v[112:115], a[44:47]
    ds_read_b64_tr_b16 v[146:147], v168 offset:24416
    s_waitcnt lgkmcnt(6)
    v_mfma_f32_16x16x32_bf16 a[48:51], v[152:155], v[40:43], a[48:51]
    ds_read_b64_tr_b16 v[148:149], v168 offset:16768
    v_mfma_f32_16x16x32_bf16 a[52:55], v[152:155], v[112:115], a[52:55]
    ds_read_b64_tr_b16 v[150:151], v168 offset:24448
    v_mfma_f32_16x16x32_bf16 a[56:59], v[156:159], v[40:43], a[56:59]
    ds_read_b64_tr_b16 v[152:153], v168 offset:16800
    v_mfma_f32_16x16x32_bf16 a[60:63], v[156:159], v[112:115], a[60:63]
    ds_read_b64_tr_b16 v[154:155], v168 offset:24480
    s_waitcnt lgkmcnt(6)
    v_mfma_f32_16x16x32_bf16 a[64:67], v[160:163], v[40:43], a[64:67]
    ds_read_b64_tr_b16 v[156:157], v168 offset:16832
    v_mfma_f32_16x16x32_bf16 a[68:71], v[160:163], v[112:115], a[68:71]
    ds_read_b64_tr_b16 v[158:159], v168 offset:24512
    s_waitcnt vmcnt(24)
    s_barrier
    v_mfma_f32_16x16x32_bf16 a[72:75], v[40:43], v[164:167], a[72:75]
    ds_read_b64_tr_b16 v[160:161], v168 offset:32768
    v_mfma_f32_16x16x32_bf16 a[76:79], v[112:115], v[164:167], a[76:79]
    ds_read_b64_tr_b16 v[162:163], v168 offset:40448
    s_waitcnt lgkmcnt(6)
    v_mfma_f32_16x16x32_bf16 a[80:83], v[40:43], v[144:147], a[80:83]
    ds_read_b64_tr_b16 v[164:165], v168 offset:32808
    v_mfma_f32_16x16x32_bf16 a[84:87], v[112:115], v[144:147], a[84:87]
    ds_read_b64_tr_b16 v[166:167], v168 offset:40488
    v_mfma_f32_16x16x32_bf16 a[88:91], v[40:43], v[148:151], a[88:91]
    ds_read_b64_tr_b16 v[144:145], v168 offset:32840
    v_mfma_f32_16x16x32_bf16 a[92:95], v[112:115], v[148:151], a[92:95]
    ds_read_b64_tr_b16 v[146:147], v168 offset:40520
    s_waitcnt lgkmcnt(6)
    v_mfma_f32_16x16x32_bf16 a[96:99], v[40:43], v[152:155], a[96:99]
    ds_read_b64_tr_b16 v[148:149], v168 offset:32880
    v_mfma_f32_16x16x32_bf16 a[100:103], v[112:115], v[152:155], a[100:103]
    ds_read_b64_tr_b16 v[150:151], v168 offset:40560
    v_mfma_f32_16x16x32_bf16 a[104:107], v[40:43], v[156:159], a[104:107]
    ds_read_b64_tr_b16 v[152:153], v168 offset:32928
    v_mfma_f32_16x16x32_bf16 a[108:111], v[112:115], v[156:159], a[108:111]
    ds_read_b64_tr_b16 v[154:155], v168 offset:40608
    s_waitcnt lgkmcnt(6)
    v_mfma_f32_16x16x32_bf16 a[0:3], v[160:163], v[44:47], a[0:3]
    ds_read_b64_tr_b16 v[156:157], v168 offset:32968
    v_mfma_f32_16x16x32_bf16 a[4:7], v[160:163], v[116:119], a[4:7]
    ds_read_b64_tr_b16 v[158:159], v168 offset:40648
    v_mfma_f32_16x16x32_bf16 a[8:11], v[164:167], v[44:47], a[8:11]
    ds_read_b64_tr_b16 v[160:161], v168 offset:33000
    v_mfma_f32_16x16x32_bf16 a[12:15], v[164:167], v[116:119], a[12:15]
    ds_read_b64_tr_b16 v[162:163], v168 offset:40680
    s_waitcnt lgkmcnt(6)
    v_mfma_f32_16x16x32_bf16 a[16:19], v[144:147], v[44:47], a[16:19]
    ds_read_b64_tr_b16 v[164:165], v168 offset:33040
    v_mfma_f32_16x16x32_bf16 a[20:23], v[144:147], v[116:119], a[20:23]
    ds_read_b64_tr_b16 v[166:167], v168 offset:40720
    v_mfma_f32_16x16x32_bf16 a[24:27], v[148:151], v[44:47], a[24:27]
    ds_read_b64_tr_b16 v[144:145], v171 offset:32768
    v_mfma_f32_16x16x32_bf16 a[28:31], v[148:151], v[116:119], a[28:31]
    ds_read_b64_tr_b16 v[146:147], v171 offset:40448
    s_waitcnt lgkmcnt(6)
    v_mfma_f32_16x16x32_bf16 a[32:35], v[152:155], v[44:47], a[32:35]
    ds_read_b64_tr_b16 v[148:149], v168 offset:33088
    v_mfma_f32_16x16x32_bf16 a[36:39], v[152:155], v[116:119], a[36:39]
    ds_read_b64_tr_b16 v[150:151], v168 offset:40768
    v_mfma_f32_16x16x32_bf16 a[40:43], v[156:159], v[44:47], a[40:43]
    ds_read_b64_tr_b16 v[152:153], v168 offset:33120
    v_mfma_f32_16x16x32_bf16 a[44:47], v[156:159], v[116:119], a[44:47]
    ds_read_b64_tr_b16 v[154:155], v168 offset:40800
    s_waitcnt lgkmcnt(6)
    v_mfma_f32_16x16x32_bf16 a[48:51], v[160:163], v[44:47], a[48:51]
    ds_read_b64_tr_b16 v[156:157], v168 offset:33152
    v_mfma_f32_16x16x32_bf16 a[52:55], v[160:163], v[116:119], a[52:55]
    ds_read_b64_tr_b16 v[158:159], v168 offset:40832
    v_mfma_f32_16x16x32_bf16 a[56:59], v[164:167], v[44:47], a[56:59]
    ds_read_b64_tr_b16 v[160:161], v168 offset:33184
    v_mfma_f32_16x16x32_bf16 a[60:63], v[164:167], v[116:119], a[60:63]
    ds_read_b64_tr_b16 v[162:163], v168 offset:40864
    s_waitcnt lgkmcnt(6)
    v_mfma_f32_16x16x32_bf16 a[64:67], v[144:147], v[44:47], a[64:67]
    ds_read_b64_tr_b16 v[164:165], v168 offset:33216
    v_mfma_f32_16x16x32_bf16 a[68:71], v[144:147], v[116:119], a[68:71]
    ds_read_b64_tr_b16 v[166:167], v168 offset:40896
    s_waitcnt vmcnt(20)
    s_barrier
    v_mfma_f32_16x16x32_bf16 a[72:75], v[44:47], v[148:151], a[72:75]
    ds_read_b64_tr_b16 v[144:145], v168 offset:49152
    v_mfma_f32_16x16x32_bf16 a[76:79], v[116:119], v[148:151], a[76:79]
    ds_read_b64_tr_b16 v[146:147], v168 offset:56832
    s_waitcnt lgkmcnt(6)
    v_mfma_f32_16x16x32_bf16 a[80:83], v[44:47], v[152:155], a[80:83]
    ds_read_b64_tr_b16 v[148:149], v168 offset:49192
    v_mfma_f32_16x16x32_bf16 a[84:87], v[116:119], v[152:155], a[84:87]
    ds_read_b64_tr_b16 v[150:151], v168 offset:56872
    v_mfma_f32_16x16x32_bf16 a[88:91], v[44:47], v[156:159], a[88:91]
    ds_read_b64_tr_b16 v[152:153], v168 offset:49224
    v_mfma_f32_16x16x32_bf16 a[92:95], v[116:119], v[156:159], a[92:95]
    ds_read_b64_tr_b16 v[154:155], v168 offset:56904
    s_waitcnt lgkmcnt(6)
    v_mfma_f32_16x16x32_bf16 a[96:99], v[44:47], v[160:163], a[96:99]
    ds_read_b64_tr_b16 v[156:157], v168 offset:49264
    v_mfma_f32_16x16x32_bf16 a[100:103], v[116:119], v[160:163], a[100:103]
    ds_read_b64_tr_b16 v[158:159], v168 offset:56944
    v_mfma_f32_16x16x32_bf16 a[104:107], v[44:47], v[164:167], a[104:107]
    ds_read_b64_tr_b16 v[160:161], v168 offset:49312
    v_mfma_f32_16x16x32_bf16 a[108:111], v[116:119], v[164:167], a[108:111]
    ds_read_b64_tr_b16 v[162:163], v168 offset:56992
    s_waitcnt lgkmcnt(6)
    v_mfma_f32_16x16x32_bf16 a[0:3], v[144:147], v[48:51], a[0:3]
    ds_read_b64_tr_b16 v[164:165], v168 offset:49352
    v_mfma_f32_16x16x32_bf16 a[4:7], v[144:147], v[120:123], a[4:7]
    ds_read_b64_tr_b16 v[166:167], v168 offset:57032
    v_mfma_f32_16x16x32_bf16 a[8:11], v[148:151], v[48:51], a[8:11]
    ds_read_b64_tr_b16 v[144:145], v168 offset:49384
    v_mfma_f32_16x16x32_bf16 a[12:15], v[148:151], v[120:123], a[12:15]
    ds_read_b64_tr_b16 v[146:147], v168 offset:57064
    s_waitcnt lgkmcnt(6)
    v_mfma_f32_16x16x32_bf16 a[16:19], v[152:155], v[48:51], a[16:19]
    ds_read_b64_tr_b16 v[148:149], v168 offset:49424
    v_mfma_f32_16x16x32_bf16 a[20:23], v[152:155], v[120:123], a[20:23]
    ds_read_b64_tr_b16 v[150:151], v168 offset:57104
    v_mfma_f32_16x16x32_bf16 a[24:27], v[156:159], v[48:51], a[24:27]
    ds_read_b64_tr_b16 v[152:153], v171 offset:49152
    v_mfma_f32_16x16x32_bf16 a[28:31], v[156:159], v[120:123], a[28:31]
    ds_read_b64_tr_b16 v[154:155], v171 offset:56832
    s_waitcnt lgkmcnt(6)
    v_mfma_f32_16x16x32_bf16 a[32:35], v[160:163], v[48:51], a[32:35]
    ds_read_b64_tr_b16 v[156:157], v168 offset:49472
    v_mfma_f32_16x16x32_bf16 a[36:39], v[160:163], v[120:123], a[36:39]
    ds_read_b64_tr_b16 v[158:159], v168 offset:57152
    v_mfma_f32_16x16x32_bf16 a[40:43], v[164:167], v[48:51], a[40:43]
    ds_read_b64_tr_b16 v[160:161], v168 offset:49504
    v_mfma_f32_16x16x32_bf16 a[44:47], v[164:167], v[120:123], a[44:47]
    ds_read_b64_tr_b16 v[162:163], v168 offset:57184
    s_waitcnt lgkmcnt(6)
    v_mfma_f32_16x16x32_bf16 a[48:51], v[144:147], v[48:51], a[48:51]
    ds_read_b64_tr_b16 v[164:165], v168 offset:49536
    v_mfma_f32_16x16x32_bf16 a[52:55], v[144:147], v[120:123], a[52:55]
    ds_read_b64_tr_b16 v[166:167], v168 offset:57216
    v_mfma_f32_16x16x32_bf16 a[56:59], v[148:151], v[48:51], a[56:59]
    ds_read_b64_tr_b16 v[144:145], v168 offset:49568
    v_mfma_f32_16x16x32_bf16 a[60:63], v[148:151], v[120:123], a[60:63]
    ds_read_b64_tr_b16 v[146:147], v168 offset:57248
    s_waitcnt lgkmcnt(6)
    v_mfma_f32_16x16x32_bf16 a[64:67], v[152:155], v[48:51], a[64:67]
    ds_read_b64_tr_b16 v[148:149], v168 offset:49600
    v_mfma_f32_16x16x32_bf16 a[68:71], v[152:155], v[120:123], a[68:71]
    ds_read_b64_tr_b16 v[150:151], v168 offset:57280
    s_waitcnt vmcnt(16)
    s_barrier
    v_mfma_f32_16x16x32_bf16 a[72:75], v[48:51], v[156:159], a[72:75]
    ds_read_b64_tr_b16 v[152:153], v169 offset:0
    v_mfma_f32_16x16x32_bf16 a[76:79], v[120:123], v[156:159], a[76:79]
    ds_read_b64_tr_b16 v[154:155], v169 offset:7680
    s_waitcnt lgkmcnt(6)
    v_mfma_f32_16x16x32_bf16 a[80:83], v[48:51], v[160:163], a[80:83]
    ds_read_b64_tr_b16 v[156:157], v169 offset:40
    v_mfma_f32_16x16x32_bf16 a[84:87], v[120:123], v[160:163], a[84:87]
    ds_read_b64_tr_b16 v[158:159], v169 offset:7720
    v_mfma_f32_16x16x32_bf16 a[88:91], v[48:51], v[164:167], a[88:91]
    ds_read_b64_tr_b16 v[160:161], v169 offset:72
    v_mfma_f32_16x16x32_bf16 a[92:95], v[120:123], v[164:167], a[92:95]
    ds_read_b64_tr_b16 v[162:163], v169 offset:7752
    s_waitcnt lgkmcnt(6)
    v_mfma_f32_16x16x32_bf16 a[96:99], v[48:51], v[144:147], a[96:99]
    ds_read_b64_tr_b16 v[164:165], v169 offset:112
    v_mfma_f32_16x16x32_bf16 a[100:103], v[120:123], v[144:147], a[100:103]
    ds_read_b64_tr_b16 v[166:167], v169 offset:7792
    v_mfma_f32_16x16x32_bf16 a[104:107], v[48:51], v[148:151], a[104:107]
    ds_read_b64_tr_b16 v[144:145], v169 offset:160
    v_mfma_f32_16x16x32_bf16 a[108:111], v[120:123], v[148:151], a[108:111]
    ds_read_b64_tr_b16 v[146:147], v169 offset:7840
    s_waitcnt lgkmcnt(6)
    v_mfma_f32_16x16x32_bf16 a[0:3], v[152:155], v[52:55], a[0:3]
    ds_read_b64_tr_b16 v[148:149], v169 offset:200
    v_mfma_f32_16x16x32_bf16 a[4:7], v[152:155], v[124:127], a[4:7]
    ds_read_b64_tr_b16 v[150:151], v169 offset:7880
    v_mfma_f32_16x16x32_bf16 a[8:11], v[156:159], v[52:55], a[8:11]
    ds_read_b64_tr_b16 v[152:153], v169 offset:232
    v_mfma_f32_16x16x32_bf16 a[12:15], v[156:159], v[124:127], a[12:15]
    ds_read_b64_tr_b16 v[154:155], v169 offset:7912
    s_waitcnt lgkmcnt(6)
    v_mfma_f32_16x16x32_bf16 a[16:19], v[160:163], v[52:55], a[16:19]
    ds_read_b64_tr_b16 v[156:157], v169 offset:272
    v_mfma_f32_16x16x32_bf16 a[20:23], v[160:163], v[124:127], a[20:23]
    ds_read_b64_tr_b16 v[158:159], v169 offset:7952
    v_mfma_f32_16x16x32_bf16 a[24:27], v[164:167], v[52:55], a[24:27]
    ds_read_b64_tr_b16 v[160:161], v172 offset:0
    v_mfma_f32_16x16x32_bf16 a[28:31], v[164:167], v[124:127], a[28:31]
    ds_read_b64_tr_b16 v[162:163], v172 offset:7680
    s_waitcnt lgkmcnt(6)
    v_mfma_f32_16x16x32_bf16 a[32:35], v[144:147], v[52:55], a[32:35]
    ds_read_b64_tr_b16 v[164:165], v169 offset:320
    v_mfma_f32_16x16x32_bf16 a[36:39], v[144:147], v[124:127], a[36:39]
    ds_read_b64_tr_b16 v[166:167], v169 offset:8000
    v_mfma_f32_16x16x32_bf16 a[40:43], v[148:151], v[52:55], a[40:43]
    ds_read_b64_tr_b16 v[144:145], v169 offset:352
    v_mfma_f32_16x16x32_bf16 a[44:47], v[148:151], v[124:127], a[44:47]
    ds_read_b64_tr_b16 v[146:147], v169 offset:8032
    s_waitcnt lgkmcnt(6)
    v_mfma_f32_16x16x32_bf16 a[48:51], v[152:155], v[52:55], a[48:51]
    ds_read_b64_tr_b16 v[148:149], v169 offset:384
    v_mfma_f32_16x16x32_bf16 a[52:55], v[152:155], v[124:127], a[52:55]
    ds_read_b64_tr_b16 v[150:151], v169 offset:8064
    v_mfma_f32_16x16x32_bf16 a[56:59], v[156:159], v[52:55], a[56:59]
    ds_read_b64_tr_b16 v[152:153], v169 offset:416
    v_mfma_f32_16x16x32_bf16 a[60:63], v[156:159], v[124:127], a[60:63]
    ds_read_b64_tr_b16 v[154:155], v169 offset:8096
    s_waitcnt lgkmcnt(6)
    v_mfma_f32_16x16x32_bf16 a[64:67], v[160:163], v[52:55], a[64:67]
    ds_read_b64_tr_b16 v[156:157], v169 offset:448
    v_mfma_f32_16x16x32_bf16 a[68:71], v[160:163], v[124:127], a[68:71]
    ds_read_b64_tr_b16 v[158:159], v169 offset:8128
    s_waitcnt vmcnt(12)
    s_barrier
    v_mfma_f32_16x16x32_bf16 a[72:75], v[52:55], v[164:167], a[72:75]
    ds_read_b64_tr_b16 v[160:161], v169 offset:16384
    v_mfma_f32_16x16x32_bf16 a[76:79], v[124:127], v[164:167], a[76:79]
    ds_read_b64_tr_b16 v[162:163], v169 offset:24064
    s_waitcnt lgkmcnt(6)
    v_mfma_f32_16x16x32_bf16 a[80:83], v[52:55], v[144:147], a[80:83]
    ds_read_b64_tr_b16 v[164:165], v169 offset:16424
    v_mfma_f32_16x16x32_bf16 a[84:87], v[124:127], v[144:147], a[84:87]
    ds_read_b64_tr_b16 v[166:167], v169 offset:24104
    v_mfma_f32_16x16x32_bf16 a[88:91], v[52:55], v[148:151], a[88:91]
    ds_read_b64_tr_b16 v[144:145], v169 offset:16456
    v_mfma_f32_16x16x32_bf16 a[92:95], v[124:127], v[148:151], a[92:95]
    ds_read_b64_tr_b16 v[146:147], v169 offset:24136
    s_waitcnt lgkmcnt(6)
    v_mfma_f32_16x16x32_bf16 a[96:99], v[52:55], v[152:155], a[96:99]
    ds_read_b64_tr_b16 v[148:149], v169 offset:16496
    v_mfma_f32_16x16x32_bf16 a[100:103], v[124:127], v[152:155], a[100:103]
    ds_read_b64_tr_b16 v[150:151], v169 offset:24176
    v_mfma_f32_16x16x32_bf16 a[104:107], v[52:55], v[156:159], a[104:107]
    ds_read_b64_tr_b16 v[152:153], v169 offset:16544
    v_mfma_f32_16x16x32_bf16 a[108:111], v[124:127], v[156:159], a[108:111]
    ds_read_b64_tr_b16 v[154:155], v169 offset:24224
    s_waitcnt lgkmcnt(6)
    v_mfma_f32_16x16x32_bf16 a[0:3], v[160:163], v[56:59], a[0:3]
    ds_read_b64_tr_b16 v[156:157], v169 offset:16584
    v_mfma_f32_16x16x32_bf16 a[4:7], v[160:163], v[128:131], a[4:7]
    ds_read_b64_tr_b16 v[158:159], v169 offset:24264
    v_mfma_f32_16x16x32_bf16 a[8:11], v[164:167], v[56:59], a[8:11]
    ds_read_b64_tr_b16 v[160:161], v169 offset:16616
    v_mfma_f32_16x16x32_bf16 a[12:15], v[164:167], v[128:131], a[12:15]
    ds_read_b64_tr_b16 v[162:163], v169 offset:24296
    s_waitcnt lgkmcnt(6)
    v_mfma_f32_16x16x32_bf16 a[16:19], v[144:147], v[56:59], a[16:19]
    ds_read_b64_tr_b16 v[164:165], v169 offset:16656
    v_mfma_f32_16x16x32_bf16 a[20:23], v[144:147], v[128:131], a[20:23]
    ds_read_b64_tr_b16 v[166:167], v169 offset:24336
    v_mfma_f32_16x16x32_bf16 a[24:27], v[148:151], v[56:59], a[24:27]
    ds_read_b64_tr_b16 v[144:145], v172 offset:16384
    v_mfma_f32_16x16x32_bf16 a[28:31], v[148:151], v[128:131], a[28:31]
    ds_read_b64_tr_b16 v[146:147], v172 offset:24064
    s_waitcnt lgkmcnt(6)
    v_mfma_f32_16x16x32_bf16 a[32:35], v[152:155], v[56:59], a[32:35]
    ds_read_b64_tr_b16 v[148:149], v169 offset:16704
    v_mfma_f32_16x16x32_bf16 a[36:39], v[152:155], v[128:131], a[36:39]
    ds_read_b64_tr_b16 v[150:151], v169 offset:24384
    v_mfma_f32_16x16x32_bf16 a[40:43], v[156:159], v[56:59], a[40:43]
    ds_read_b64_tr_b16 v[152:153], v169 offset:16736
    v_mfma_f32_16x16x32_bf16 a[44:47], v[156:159], v[128:131], a[44:47]
    ds_read_b64_tr_b16 v[154:155], v169 offset:24416
    s_waitcnt lgkmcnt(6)
    v_mfma_f32_16x16x32_bf16 a[48:51], v[160:163], v[56:59], a[48:51]
    ds_read_b64_tr_b16 v[156:157], v169 offset:16768
    v_mfma_f32_16x16x32_bf16 a[52:55], v[160:163], v[128:131], a[52:55]
    ds_read_b64_tr_b16 v[158:159], v169 offset:24448
    v_mfma_f32_16x16x32_bf16 a[56:59], v[164:167], v[56:59], a[56:59]
    ds_read_b64_tr_b16 v[160:161], v169 offset:16800
    v_mfma_f32_16x16x32_bf16 a[60:63], v[164:167], v[128:131], a[60:63]
    ds_read_b64_tr_b16 v[162:163], v169 offset:24480
    s_waitcnt lgkmcnt(6)
    v_mfma_f32_16x16x32_bf16 a[64:67], v[144:147], v[56:59], a[64:67]
    ds_read_b64_tr_b16 v[164:165], v169 offset:16832
    v_mfma_f32_16x16x32_bf16 a[68:71], v[144:147], v[128:131], a[68:71]
    ds_read_b64_tr_b16 v[166:167], v169 offset:24512
    s_waitcnt vmcnt(8)
    s_barrier
    v_mfma_f32_16x16x32_bf16 a[72:75], v[56:59], v[148:151], a[72:75]
    ds_read_b64_tr_b16 v[144:145], v169 offset:32768
    v_mfma_f32_16x16x32_bf16 a[76:79], v[128:131], v[148:151], a[76:79]
    ds_read_b64_tr_b16 v[146:147], v169 offset:40448
    s_waitcnt lgkmcnt(6)
    v_mfma_f32_16x16x32_bf16 a[80:83], v[56:59], v[152:155], a[80:83]
    ds_read_b64_tr_b16 v[148:149], v169 offset:32808
    v_mfma_f32_16x16x32_bf16 a[84:87], v[128:131], v[152:155], a[84:87]
    ds_read_b64_tr_b16 v[150:151], v169 offset:40488
    v_mfma_f32_16x16x32_bf16 a[88:91], v[56:59], v[156:159], a[88:91]
    ds_read_b64_tr_b16 v[152:153], v169 offset:32840
    v_mfma_f32_16x16x32_bf16 a[92:95], v[128:131], v[156:159], a[92:95]
    ds_read_b64_tr_b16 v[154:155], v169 offset:40520
    s_waitcnt lgkmcnt(6)
    v_mfma_f32_16x16x32_bf16 a[96:99], v[56:59], v[160:163], a[96:99]
    ds_read_b64_tr_b16 v[156:157], v169 offset:32880
    v_mfma_f32_16x16x32_bf16 a[100:103], v[128:131], v[160:163], a[100:103]
    ds_read_b64_tr_b16 v[158:159], v169 offset:40560
    v_mfma_f32_16x16x32_bf16 a[104:107], v[56:59], v[164:167], a[104:107]
    ds_read_b64_tr_b16 v[160:161], v169 offset:32928
    v_mfma_f32_16x16x32_bf16 a[108:111], v[128:131], v[164:167], a[108:111]
    ds_read_b64_tr_b16 v[162:163], v169 offset:40608
    s_waitcnt lgkmcnt(6)
    v_mfma_f32_16x16x32_bf16 a[0:3], v[144:147], v[60:63], a[0:3]
    ds_read_b64_tr_b16 v[164:165], v169 offset:32968
    v_mfma_f32_16x16x32_bf16 a[4:7], v[144:147], v[132:135], a[4:7]
    ds_read_b64_tr_b16 v[166:167], v169 offset:40648
    v_mfma_f32_16x16x32_bf16 a[8:11], v[148:151], v[60:63], a[8:11]
    ds_read_b64_tr_b16 v[144:145], v169 offset:33000
    v_mfma_f32_16x16x32_bf16 a[12:15], v[148:151], v[132:135], a[12:15]
    ds_read_b64_tr_b16 v[146:147], v169 offset:40680
    s_waitcnt lgkmcnt(6)
    v_mfma_f32_16x16x32_bf16 a[16:19], v[152:155], v[60:63], a[16:19]
    ds_read_b64_tr_b16 v[148:149], v169 offset:33040
    v_mfma_f32_16x16x32_bf16 a[20:23], v[152:155], v[132:135], a[20:23]
    ds_read_b64_tr_b16 v[150:151], v169 offset:40720
    v_mfma_f32_16x16x32_bf16 a[24:27], v[156:159], v[60:63], a[24:27]
    ds_read_b64_tr_b16 v[152:153], v172 offset:32768
    v_mfma_f32_16x16x32_bf16 a[28:31], v[156:159], v[132:135], a[28:31]
    ds_read_b64_tr_b16 v[154:155], v172 offset:40448
    s_waitcnt lgkmcnt(6)
    v_mfma_f32_16x16x32_bf16 a[32:35], v[160:163], v[60:63], a[32:35]
    ds_read_b64_tr_b16 v[156:157], v169 offset:33088
    v_mfma_f32_16x16x32_bf16 a[36:39], v[160:163], v[132:135], a[36:39]
    ds_read_b64_tr_b16 v[158:159], v169 offset:40768
    v_mfma_f32_16x16x32_bf16 a[40:43], v[164:167], v[60:63], a[40:43]
    ds_read_b64_tr_b16 v[160:161], v169 offset:33120
    v_mfma_f32_16x16x32_bf16 a[44:47], v[164:167], v[132:135], a[44:47]
    ds_read_b64_tr_b16 v[162:163], v169 offset:40800
    s_waitcnt lgkmcnt(6)
    v_mfma_f32_16x16x32_bf16 a[48:51], v[144:147], v[60:63], a[48:51]
    ds_read_b64_tr_b16 v[164:165], v169 offset:33152
    v_mfma_f32_16x16x32_bf16 a[52:55], v[144:147], v[132:135], a[52:55]
    ds_read_b64_tr_b16 v[166:167], v169 offset:40832
    v_mfma_f32_16x16x32_bf16 a[56:59], v[148:151], v[60:63], a[56:59]
    ds_read_b64_tr_b16 v[144:145], v169 offset:33184
    v_mfma_f32_16x16x32_bf16 a[60:63], v[148:151], v[132:135], a[60:63]
    ds_read_b64_tr_b16 v[146:147], v169 offset:40864
    s_waitcnt lgkmcnt(6)
    v_mfma_f32_16x16x32_bf16 a[64:67], v[152:155], v[60:63], a[64:67]
    ds_read_b64_tr_b16 v[148:149], v169 offset:33216
    v_mfma_f32_16x16x32_bf16 a[68:71], v[152:155], v[132:135], a[68:71]
    ds_read_b64_tr_b16 v[150:151], v169 offset:40896
    s_waitcnt vmcnt(4)
    s_barrier
    v_mfma_f32_16x16x32_bf16 a[72:75], v[60:63], v[156:159], a[72:75]
    ds_read_b64_tr_b16 v[152:153], v169 offset:49152
    v_mfma_f32_16x16x32_bf16 a[76:79], v[132:135], v[156:159], a[76:79]
    ds_read_b64_tr_b16 v[154:155], v169 offset:56832
    s_waitcnt lgkmcnt(6)
    v_mfma_f32_16x16x32_bf16 a[80:83], v[60:63], v[160:163], a[80:83]
    ds_read_b64_tr_b16 v[156:157], v169 offset:49192
    v_mfma_f32_16x16x32_bf16 a[84:87], v[132:135], v[160:163], a[84:87]
    ds_read_b64_tr_b16 v[158:159], v169 offset:56872
    v_mfma_f32_16x16x32_bf16 a[88:91], v[60:63], v[164:167], a[88:91]
    ds_read_b64_tr_b16 v[160:161], v169 offset:49224
    v_mfma_f32_16x16x32_bf16 a[92:95], v[132:135], v[164:167], a[92:95]
    ds_read_b64_tr_b16 v[162:163], v169 offset:56904
    s_waitcnt lgkmcnt(6)
    v_mfma_f32_16x16x32_bf16 a[96:99], v[60:63], v[144:147], a[96:99]
    ds_read_b64_tr_b16 v[164:165], v169 offset:49264
    v_mfma_f32_16x16x32_bf16 a[100:103], v[132:135], v[144:147], a[100:103]
    ds_read_b64_tr_b16 v[166:167], v169 offset:56944
    v_mfma_f32_16x16x32_bf16 a[104:107], v[60:63], v[148:151], a[104:107]
    ds_read_b64_tr_b16 v[144:145], v169 offset:49312
    v_mfma_f32_16x16x32_bf16 a[108:111], v[132:135], v[148:151], a[108:111]
    ds_read_b64_tr_b16 v[146:147], v169 offset:56992
    s_waitcnt lgkmcnt(6)
    v_mfma_f32_16x16x32_bf16 a[0:3], v[152:155], v[64:67], a[0:3]
    ds_read_b64_tr_b16 v[148:149], v169 offset:49352
    v_mfma_f32_16x16x32_bf16 a[4:7], v[152:155], v[136:139], a[4:7]
    ds_read_b64_tr_b16 v[150:151], v169 offset:57032
    v_mfma_f32_16x16x32_bf16 a[8:11], v[156:159], v[64:67], a[8:11]
    ds_read_b64_tr_b16 v[152:153], v169 offset:49384
    v_mfma_f32_16x16x32_bf16 a[12:15], v[156:159], v[136:139], a[12:15]
    ds_read_b64_tr_b16 v[154:155], v169 offset:57064
    s_waitcnt lgkmcnt(6)
    v_mfma_f32_16x16x32_bf16 a[16:19], v[160:163], v[64:67], a[16:19]
    ds_read_b64_tr_b16 v[156:157], v169 offset:49424
    v_mfma_f32_16x16x32_bf16 a[20:23], v[160:163], v[136:139], a[20:23]
    ds_read_b64_tr_b16 v[158:159], v169 offset:57104
    v_mfma_f32_16x16x32_bf16 a[24:27], v[164:167], v[64:67], a[24:27]
    ds_read_b64_tr_b16 v[160:161], v172 offset:49152
    v_mfma_f32_16x16x32_bf16 a[28:31], v[164:167], v[136:139], a[28:31]
    ds_read_b64_tr_b16 v[162:163], v172 offset:56832
    s_waitcnt lgkmcnt(6)
    v_mfma_f32_16x16x32_bf16 a[32:35], v[144:147], v[64:67], a[32:35]
    ds_read_b64_tr_b16 v[164:165], v169 offset:49472
    v_mfma_f32_16x16x32_bf16 a[36:39], v[144:147], v[136:139], a[36:39]
    ds_read_b64_tr_b16 v[166:167], v169 offset:57152
    v_mfma_f32_16x16x32_bf16 a[40:43], v[148:151], v[64:67], a[40:43]
    ds_read_b64_tr_b16 v[144:145], v169 offset:49504
    v_mfma_f32_16x16x32_bf16 a[44:47], v[148:151], v[136:139], a[44:47]
    ds_read_b64_tr_b16 v[146:147], v169 offset:57184
    s_waitcnt lgkmcnt(6)
    v_mfma_f32_16x16x32_bf16 a[48:51], v[152:155], v[64:67], a[48:51]
    ds_read_b64_tr_b16 v[148:149], v169 offset:49536
    v_mfma_f32_16x16x32_bf16 a[52:55], v[152:155], v[136:139], a[52:55]
    ds_read_b64_tr_b16 v[150:151], v169 offset:57216
    v_mfma_f32_16x16x32_bf16 a[56:59], v[156:159], v[64:67], a[56:59]
    ds_read_b64_tr_b16 v[152:153], v169 offset:49568
    v_mfma_f32_16x16x32_bf16 a[60:63], v[156:159], v[136:139], a[60:63]
    ds_read_b64_tr_b16 v[154:155], v169 offset:57248
    s_waitcnt lgkmcnt(6)
    v_mfma_f32_16x16x32_bf16 a[64:67], v[160:163], v[64:67], a[64:67]
    ds_read_b64_tr_b16 v[156:157], v169 offset:49600
    v_mfma_f32_16x16x32_bf16 a[68:71], v[160:163], v[136:139], a[68:71]
    ds_read_b64_tr_b16 v[158:159], v169 offset:57280
    s_waitcnt vmcnt(0)
    s_barrier
    v_mfma_f32_16x16x32_bf16 a[72:75], v[64:67], v[164:167], a[72:75]
    ds_read_b64_tr_b16 v[160:161], v170 offset:0
    v_mfma_f32_16x16x32_bf16 a[76:79], v[136:139], v[164:167], a[76:79]
    ds_read_b64_tr_b16 v[162:163], v170 offset:7680
    s_waitcnt lgkmcnt(6)
    v_mfma_f32_16x16x32_bf16 a[80:83], v[64:67], v[144:147], a[80:83]
    ds_read_b64_tr_b16 v[164:165], v170 offset:40
    v_mfma_f32_16x16x32_bf16 a[84:87], v[136:139], v[144:147], a[84:87]
    ds_read_b64_tr_b16 v[166:167], v170 offset:7720
    v_mfma_f32_16x16x32_bf16 a[88:91], v[64:67], v[148:151], a[88:91]
    ds_read_b64_tr_b16 v[144:145], v170 offset:72
    v_mfma_f32_16x16x32_bf16 a[92:95], v[136:139], v[148:151], a[92:95]
    ds_read_b64_tr_b16 v[146:147], v170 offset:7752
    s_waitcnt lgkmcnt(6)
    v_mfma_f32_16x16x32_bf16 a[96:99], v[64:67], v[152:155], a[96:99]
    ds_read_b64_tr_b16 v[148:149], v170 offset:112
    v_mfma_f32_16x16x32_bf16 a[100:103], v[136:139], v[152:155], a[100:103]
    ds_read_b64_tr_b16 v[150:151], v170 offset:7792
    v_mfma_f32_16x16x32_bf16 a[104:107], v[64:67], v[156:159], a[104:107]
    ds_read_b64_tr_b16 v[152:153], v170 offset:160
    v_mfma_f32_16x16x32_bf16 a[108:111], v[136:139], v[156:159], a[108:111]
    ds_read_b64_tr_b16 v[154:155], v170 offset:7840
    s_waitcnt lgkmcnt(6)
    v_mfma_f32_16x16x32_bf16 a[0:3], v[160:163], v[68:71], a[0:3]
    ds_read_b64_tr_b16 v[156:157], v170 offset:200
    v_mfma_f32_16x16x32_bf16 a[4:7], v[160:163], v[140:143], a[4:7]
    ds_read_b64_tr_b16 v[158:159], v170 offset:7880
    v_mfma_f32_16x16x32_bf16 a[8:11], v[164:167], v[68:71], a[8:11]
    ds_read_b64_tr_b16 v[160:161], v170 offset:232
    v_mfma_f32_16x16x32_bf16 a[12:15], v[164:167], v[140:143], a[12:15]
    ds_read_b64_tr_b16 v[162:163], v170 offset:7912
    s_waitcnt lgkmcnt(6)
    v_mfma_f32_16x16x32_bf16 a[16:19], v[144:147], v[68:71], a[16:19]
    ds_read_b64_tr_b16 v[164:165], v170 offset:272
    v_mfma_f32_16x16x32_bf16 a[20:23], v[144:147], v[140:143], a[20:23]
    ds_read_b64_tr_b16 v[166:167], v170 offset:7952
    v_mfma_f32_16x16x32_bf16 a[24:27], v[148:151], v[68:71], a[24:27]
    ds_read_b64_tr_b16 v[144:145], v173 offset:0
    v_mfma_f32_16x16x32_bf16 a[28:31], v[148:151], v[140:143], a[28:31]
    ds_read_b64_tr_b16 v[146:147], v173 offset:7680
    s_waitcnt lgkmcnt(6)
    v_mfma_f32_16x16x32_bf16 a[32:35], v[152:155], v[68:71], a[32:35]
    ds_read_b64_tr_b16 v[148:149], v170 offset:320
    v_mfma_f32_16x16x32_bf16 a[36:39], v[152:155], v[140:143], a[36:39]
    ds_read_b64_tr_b16 v[150:151], v170 offset:8000
    v_mfma_f32_16x16x32_bf16 a[40:43], v[156:159], v[68:71], a[40:43]
    ds_read_b64_tr_b16 v[152:153], v170 offset:352
    v_mfma_f32_16x16x32_bf16 a[44:47], v[156:159], v[140:143], a[44:47]
    ds_read_b64_tr_b16 v[154:155], v170 offset:8032
    s_waitcnt lgkmcnt(6)
    v_mfma_f32_16x16x32_bf16 a[48:51], v[160:163], v[68:71], a[48:51]
    ds_read_b64_tr_b16 v[156:157], v170 offset:384
    v_mfma_f32_16x16x32_bf16 a[52:55], v[160:163], v[140:143], a[52:55]
    ds_read_b64_tr_b16 v[158:159], v170 offset:8064
    v_mfma_f32_16x16x32_bf16 a[56:59], v[164:167], v[68:71], a[56:59]
    ds_read_b64_tr_b16 v[160:161], v170 offset:416
    v_mfma_f32_16x16x32_bf16 a[60:63], v[164:167], v[140:143], a[60:63]
    ds_read_b64_tr_b16 v[162:163], v170 offset:8096
    s_waitcnt lgkmcnt(6)
    v_mfma_f32_16x16x32_bf16 a[64:67], v[144:147], v[68:71], a[64:67]
    ds_read_b64_tr_b16 v[164:165], v170 offset:448
    v_mfma_f32_16x16x32_bf16 a[68:71], v[144:147], v[140:143], a[68:71]
    ds_read_b64_tr_b16 v[166:167], v170 offset:8128
    v_mfma_f32_16x16x32_bf16 a[72:75], v[68:71], v[148:151], a[72:75]
    v_mfma_f32_16x16x32_bf16 a[76:79], v[140:143], v[148:151], a[76:79]
    s_waitcnt lgkmcnt(4)
    v_mfma_f32_16x16x32_bf16 a[80:83], v[68:71], v[152:155], a[80:83]
    v_mfma_f32_16x16x32_bf16 a[84:87], v[140:143], v[152:155], a[84:87]
    v_mfma_f32_16x16x32_bf16 a[88:91], v[68:71], v[156:159], a[88:91]
    v_mfma_f32_16x16x32_bf16 a[92:95], v[140:143], v[156:159], a[92:95]
    s_waitcnt lgkmcnt(0)
    v_mfma_f32_16x16x32_bf16 a[96:99], v[68:71], v[160:163], a[96:99]
    v_mfma_f32_16x16x32_bf16 a[100:103], v[140:143], v[160:163], a[100:103]
    v_mfma_f32_16x16x32_bf16 a[104:107], v[68:71], v[164:167], a[104:107]
    v_mfma_f32_16x16x32_bf16 a[108:111], v[140:143], v[164:167], a[108:111]
    ds_bpermute_b32 v236, v228, v232
    ds_bpermute_b32 v237, v229, v232
    ds_bpermute_b32 v238, v230, v232
    ds_bpermute_b32 v239, v231, v232
    ds_bpermute_b32 v240, v228, v233
    ds_bpermute_b32 v241, v229, v233
    ds_bpermute_b32 v242, v230, v233
    ds_bpermute_b32 v243, v231, v233
    s_cmp_lg_u32 s45, 0
    s_cbranch_scc1 L_qkv_norho_1001
    v_mul_f32 v184, v232, v232
    v_mul_f32 v185, v233, v233
    v_lshlrev_b32 v186, 2, v182
    s_lshl_b32 s42, s44, 9
    s_lshl_b32 s40, s37, 7
    s_add_u32 s42, s42, s40
    s_add_u32 s42, s42, 10092544
    s_mov_b64 exec, 0xffff
    buffer_store_dword v184, v186, s[12:15], s42 offen sc1
    buffer_store_dword v185, v186, s[12:15], s42 offen offset:64 sc1
    s_mov_b64 exec, -1
L_qkv_norho_1001:
    v_mul_f32 v188, 0x3eae1a93, v232
    v_mul_f32 v189, 0x3eae1a93, v233
    v_cmp_gt_u32 vcc, 2, v245
    s_nop 1
    v_cndmask_b32 v190, v232, v188, vcc
    s_nop 0
    v_cndmask_b32 v191, v233, v189, vcc
    v_accvgpr_read_b32 v192, a0
    v_accvgpr_read_b32 v193, a1
    v_accvgpr_read_b32 v194, a2
    v_accvgpr_read_b32 v195, a3
    v_accvgpr_read_b32 v196, a4
    v_accvgpr_read_b32 v197, a5
    v_accvgpr_read_b32 v198, a6
    v_accvgpr_read_b32 v199, a7
    v_pk_mul_f32 v[192:193], v[188:189], v[192:193] op_sel_hi:[0,1]
    v_pk_mul_f32 v[194:195], v[188:189], v[194:195] op_sel_hi:[0,1]
    v_pk_mul_f32 v[196:197], v[188:189], v[196:197] op_sel:[1,0] op_sel_hi:[1,1]
    v_pk_mul_f32 v[198:199], v[188:189], v[198:199] op_sel:[1,0] op_sel_hi:[1,1]
    v_cvt_pk_bf16_f32 v200, v192, v193
    v_cvt_pk_bf16_f32 v201, v194, v195
    v_cvt_pk_bf16_f32 v202, v196, v197
    v_cvt_pk_bf16_f32 v203, v198, v199
    s_nop 0
    v_permlane16_swap_b32 v200, v202
    s_nop 0
    v_permlane16_swap_b32 v201, v203
    s_add_u32 s52, s48, 0
    buffer_store_dwordx4 v[200:203], v246, s[12:15], s52 offen sc1
    v_accvgpr_read_b32 v204, a8
    v_accvgpr_read_b32 v205, a9
    v_accvgpr_read_b32 v206, a10
    v_accvgpr_read_b32 v207, a11
    v_accvgpr_read_b32 v208, a12
    v_accvgpr_read_b32 v209, a13
    v_accvgpr_read_b32 v210, a14
    v_accvgpr_read_b32 v211, a15
    v_pk_mul_f32 v[204:205], v[188:189], v[204:205] op_sel_hi:[0,1]
    v_pk_mul_f32 v[206:207], v[188:189], v[206:207] op_sel_hi:[0,1]
    v_pk_mul_f32 v[208:209], v[188:189], v[208:209] op_sel:[1,0] op_sel_hi:[1,1]
    v_pk_mul_f32 v[210:211], v[188:189], v[210:211] op_sel:[1,0] op_sel_hi:[1,1]
    v_cvt_pk_bf16_f32 v212, v204, v205
    v_cvt_pk_bf16_f32 v213, v206, v207
    v_cvt_pk_bf16_f32 v214, v208, v209
    v_cvt_pk_bf16_f32 v215, v210, v211
    s_nop 0
    v_permlane16_swap_b32 v212, v214
    s_nop 0
    v_permlane16_swap_b32 v213, v215
    s_add_u32 s52, s48, 65536
    buffer_store_dwordx4 v[212:215], v246, s[12:15], s52 offen sc1
    v_accvgpr_read_b32 v216, a16
    v_accvgpr_read_b32 v217, a17
    v_accvgpr_read_b32 v218, a18
    v_accvgpr_read_b32 v219, a19
    v_accvgpr_read_b32 v220, a20
    v_accvgpr_read_b32 v221, a21
    v_accvgpr_read_b32 v222, a22
    v_accvgpr_read_b32 v223, a23
    v_pk_mul_f32 v[216:217], v[188:189], v[216:217] op_sel_hi:[0,1]
    v_pk_mul_f32 v[218:219], v[188:189], v[218:219] op_sel_hi:[0,1]
    v_pk_mul_f32 v[220:221], v[188:189], v[220:221] op_sel:[1,0] op_sel_hi:[1,1]
    v_pk_mul_f32 v[222:223], v[188:189], v[222:223] op_sel:[1,0] op_sel_hi:[1,1]
    v_cvt_pk_bf16_f32 v224, v216, v217
    v_cvt_pk_bf16_f32 v225, v218, v219
    v_cvt_pk_bf16_f32 v226, v220, v221
    v_cvt_pk_bf16_f32 v227, v222, v223
    s_nop 0
    v_permlane16_swap_b32 v224, v226
    s_nop 0
    v_permlane16_swap_b32 v225, v227
    s_add_u32 s52, s48, 131072
    buffer_store_dwordx4 v[224:227], v246, s[12:15], s52 offen sc1
    v_accvgpr_read_b32 v192, a24
    v_accvgpr_read_b32 v193, a25
    v_accvgpr_read_b32 v194, a26
    v_accvgpr_read_b32 v195, a27
    v_accvgpr_read_b32 v196, a28
    v_accvgpr_read_b32 v197, a29
    v_accvgpr_read_b32 v198, a30
    v_accvgpr_read_b32 v199, a31
    v_pk_mul_f32 v[192:193], v[188:189], v[192:193] op_sel_hi:[0,1]
    v_pk_mul_f32 v[194:195], v[188:189], v[194:195] op_sel_hi:[0,1]
    v_pk_mul_f32 v[196:197], v[188:189], v[196:197] op_sel:[1,0] op_sel_hi:[1,1]
    v_pk_mul_f32 v[198:199], v[188:189], v[198:199] op_sel:[1,0] op_sel_hi:[1,1]
    v_cvt_pk_bf16_f32 v200, v192, v193
    v_cvt_pk_bf16_f32 v201, v194, v195
    v_cvt_pk_bf16_f32 v202, v196, v197
    v_cvt_pk_bf16_f32 v203, v198, v199
    s_nop 0
    v_permlane16_swap_b32 v200, v202
    s_nop 0
    v_permlane16_swap_b32 v201, v203
    s_add_u32 s52, s48, 196608
    buffer_store_dwordx4 v[200:203], v246, s[12:15], s52 offen sc1
    v_accvgpr_read_b32 v204, a32
    v_accvgpr_read_b32 v205, a33
    v_accvgpr_read_b32 v206, a34
    v_accvgpr_read_b32 v207, a35
    v_accvgpr_read_b32 v208, a36
    v_accvgpr_read_b32 v209, a37
    v_accvgpr_read_b32 v210, a38
    v_accvgpr_read_b32 v211, a39
    v_pk_mul_f32 v[204:205], v[232:233], v[204:205] op_sel_hi:[0,1]
    v_pk_mul_f32 v[206:207], v[232:233], v[206:207] op_sel_hi:[0,1]
    v_pk_mul_f32 v[208:209], v[232:233], v[208:209] op_sel:[1,0] op_sel_hi:[1,1]
    v_pk_mul_f32 v[210:211], v[232:233], v[210:211] op_sel:[1,0] op_sel_hi:[1,1]
    v_cvt_pk_bf16_f32 v212, v204, v205
    v_cvt_pk_bf16_f32 v213, v206, v207
    v_cvt_pk_bf16_f32 v214, v208, v209
    v_cvt_pk_bf16_f32 v215, v210, v211
    s_nop 0
    v_permlane16_swap_b32 v212, v214
    s_nop 0
    v_permlane16_swap_b32 v213, v215
    s_add_u32 s52, s49, 0
    buffer_store_dwordx4 v[212:215], v246, s[12:15], s52 offen sc1
    v_accvgpr_read_b32 v216, a40
    v_accvgpr_read_b32 v217, a41
    v_accvgpr_read_b32 v218, a42
    v_accvgpr_read_b32 v219, a43
    v_accvgpr_read_b32 v220, a44
    v_accvgpr_read_b32 v221, a45
    v_accvgpr_read_b32 v222, a46
    v_accvgpr_read_b32 v223, a47
    v_pk_mul_f32 v[216:217], v[232:233], v[216:217] op_sel_hi:[0,1]
    v_pk_mul_f32 v[218:219], v[232:233], v[218:219] op_sel_hi:[0,1]
    v_pk_mul_f32 v[220:221], v[232:233], v[220:221] op_sel:[1,0] op_sel_hi:[1,1]
    v_pk_mul_f32 v[222:223], v[232:233], v[222:223] op_sel:[1,0] op_sel_hi:[1,1]
    v_cvt_pk_bf16_f32 v224, v216, v217
    v_cvt_pk_bf16_f32 v225, v218, v219
    v_cvt_pk_bf16_f32 v226, v220, v221
    v_cvt_pk_bf16_f32 v227, v222, v223
    s_nop 0
    v_permlane16_swap_b32 v224, v226
    s_nop 0
    v_permlane16_swap_b32 v225, v227
    s_add_u32 s52, s49, 65536
    buffer_store_dwordx4 v[224:227], v246, s[12:15], s52 offen sc1
    v_accvgpr_read_b32 v192, a48
    v_accvgpr_read_b32 v193, a49
    v_accvgpr_read_b32 v194, a50
    v_accvgpr_read_b32 v195, a51
    v_accvgpr_read_b32 v196, a52
    v_accvgpr_read_b32 v197, a53
    v_accvgpr_read_b32 v198, a54
    v_accvgpr_read_b32 v199, a55
    v_pk_mul_f32 v[192:193], v[232:233], v[192:193] op_sel_hi:[0,1]
    v_pk_mul_f32 v[194:195], v[232:233], v[194:195] op_sel_hi:[0,1]
    v_pk_mul_f32 v[196:197], v[232:233], v[196:197] op_sel:[1,0] op_sel_hi:[1,1]
    v_pk_mul_f32 v[198:199], v[232:233], v[198:199] op_sel:[1,0] op_sel_hi:[1,1]
    v_cvt_pk_bf16_f32 v200, v192, v193
    v_cvt_pk_bf16_f32 v201, v194, v195
    v_cvt_pk_bf16_f32 v202, v196, v197
    v_cvt_pk_bf16_f32 v203, v198, v199
    s_nop 0
    v_permlane16_swap_b32 v200, v202
    s_nop 0
    v_permlane16_swap_b32 v201, v203
    s_add_u32 s52, s49, 131072
    buffer_store_dwordx4 v[200:203], v246, s[12:15], s52 offen sc1
    v_accvgpr_read_b32 v204, a56
    v_accvgpr_read_b32 v205, a57
    v_accvgpr_read_b32 v206, a58
    v_accvgpr_read_b32 v207, a59
    v_accvgpr_read_b32 v208, a60
    v_accvgpr_read_b32 v209, a61
    v_accvgpr_read_b32 v210, a62
    v_accvgpr_read_b32 v211, a63
    v_pk_mul_f32 v[204:205], v[232:233], v[204:205] op_sel_hi:[0,1]
    v_pk_mul_f32 v[206:207], v[232:233], v[206:207] op_sel_hi:[0,1]
    v_pk_mul_f32 v[208:209], v[232:233], v[208:209] op_sel:[1,0] op_sel_hi:[1,1]
    v_pk_mul_f32 v[210:211], v[232:233], v[210:211] op_sel:[1,0] op_sel_hi:[1,1]
    v_cvt_pk_bf16_f32 v212, v204, v205
    v_cvt_pk_bf16_f32 v213, v206, v207
    v_cvt_pk_bf16_f32 v214, v208, v209
    v_cvt_pk_bf16_f32 v215, v210, v211
    s_nop 0
    v_permlane16_swap_b32 v212, v214
    s_nop 0
    v_permlane16_swap_b32 v213, v215
    s_add_u32 s52, s49, 196608
    buffer_store_dwordx4 v[212:215], v246, s[12:15], s52 offen sc1
    s_waitcnt lgkmcnt(0)
    v_accvgpr_read_b32 v216, a72
    v_accvgpr_read_b32 v217, a73
    v_accvgpr_read_b32 v218, a74
    v_accvgpr_read_b32 v219, a75
    v_accvgpr_read_b32 v220, a76
    v_accvgpr_read_b32 v221, a77
    v_accvgpr_read_b32 v222, a78
    v_accvgpr_read_b32 v223, a79
    v_pk_mul_f32 v[216:217], v[216:217], v[236:237]
    v_pk_mul_f32 v[218:219], v[218:219], v[238:239]
    v_pk_mul_f32 v[220:221], v[220:221], v[240:241]
    v_pk_mul_f32 v[222:223], v[222:223], v[242:243]
    v_cvt_pk_bf16_f32 v224, v216, v217
    v_cvt_pk_bf16_f32 v225, v218, v219
    v_cvt_pk_bf16_f32 v226, v220, v221
    v_cvt_pk_bf16_f32 v227, v222, v223
    s_nop 0
    v_permlane32_swap_b32 v224, v226
    s_nop 0
    v_permlane32_swap_b32 v225, v227
    buffer_store_dwordx4 v[224:227], v248, s[12:15], s51 offen sc1
    v_accvgpr_read_b32 v192, a80
    v_accvgpr_read_b32 v193, a81
    v_accvgpr_read_b32 v194, a82
    v_accvgpr_read_b32 v195, a83
    v_accvgpr_read_b32 v196, a84
    v_accvgpr_read_b32 v197, a85
    v_accvgpr_read_b32 v198, a86
    v_accvgpr_read_b32 v199, a87
    v_pk_mul_f32 v[192:193], v[192:193], v[236:237]
    v_pk_mul_f32 v[194:195], v[194:195], v[238:239]
    v_pk_mul_f32 v[196:197], v[196:197], v[240:241]
    v_pk_mul_f32 v[198:199], v[198:199], v[242:243]
    v_cvt_pk_bf16_f32 v200, v192, v193
    v_cvt_pk_bf16_f32 v201, v194, v195
    v_cvt_pk_bf16_f32 v202, v196, v197
    v_cvt_pk_bf16_f32 v203, v198, v199
    s_nop 0
    v_permlane32_swap_b32 v200, v202
    s_nop 0
    v_permlane32_swap_b32 v201, v203
    buffer_store_dwordx4 v[200:203], v249, s[12:15], s51 offen sc1
    v_accvgpr_read_b32 v204, a88
    v_accvgpr_read_b32 v205, a89
    v_accvgpr_read_b32 v206, a90
    v_accvgpr_read_b32 v207, a91
    v_accvgpr_read_b32 v208, a92
    v_accvgpr_read_b32 v209, a93
    v_accvgpr_read_b32 v210, a94
    v_accvgpr_read_b32 v211, a95
    v_pk_mul_f32 v[204:205], v[204:205], v[236:237]
    v_pk_mul_f32 v[206:207], v[206:207], v[238:239]
    v_pk_mul_f32 v[208:209], v[208:209], v[240:241]
    v_pk_mul_f32 v[210:211], v[210:211], v[242:243]
    v_cvt_pk_bf16_f32 v212, v204, v205
    v_cvt_pk_bf16_f32 v213, v206, v207
    v_cvt_pk_bf16_f32 v214, v208, v209
    v_cvt_pk_bf16_f32 v215, v210, v211
    s_nop 0
    v_permlane32_swap_b32 v212, v214
    s_nop 0
    v_permlane32_swap_b32 v213, v215
    buffer_store_dwordx4 v[212:215], v250, s[12:15], s51 offen sc1
    v_accvgpr_read_b32 v216, a96
    v_accvgpr_read_b32 v217, a97
    v_accvgpr_read_b32 v218, a98
    v_accvgpr_read_b32 v219, a99
    v_accvgpr_read_b32 v220, a100
    v_accvgpr_read_b32 v221, a101
    v_accvgpr_read_b32 v222, a102
    v_accvgpr_read_b32 v223, a103
    v_pk_mul_f32 v[216:217], v[216:217], v[236:237]
    v_pk_mul_f32 v[218:219], v[218:219], v[238:239]
    v_pk_mul_f32 v[220:221], v[220:221], v[240:241]
    v_pk_mul_f32 v[222:223], v[222:223], v[242:243]
    v_cvt_pk_bf16_f32 v224, v216, v217
    v_cvt_pk_bf16_f32 v225, v218, v219
    v_cvt_pk_bf16_f32 v226, v220, v221
    v_cvt_pk_bf16_f32 v227, v222, v223
    s_nop 0
    v_permlane32_swap_b32 v224, v226
    s_nop 0
    v_permlane32_swap_b32 v225, v227
    buffer_store_dwordx4 v[224:227], v251, s[12:15], s51 offen sc1
    v_accvgpr_read_b32 v192, a104
    v_accvgpr_read_b32 v193, a105
    v_accvgpr_read_b32 v194, a106
    v_accvgpr_read_b32 v195, a107
    v_accvgpr_read_b32 v196, a108
    v_accvgpr_read_b32 v197, a109
    v_accvgpr_read_b32 v198, a110
    v_accvgpr_read_b32 v199, a111
    v_pk_mul_f32 v[192:193], v[192:193], v[236:237]
    v_pk_mul_f32 v[194:195], v[194:195], v[238:239]
    v_pk_mul_f32 v[196:197], v[196:197], v[240:241]
    v_pk_mul_f32 v[198:199], v[198:199], v[242:243]
    v_cvt_pk_bf16_f32 v200, v192, v193
    v_cvt_pk_bf16_f32 v201, v194, v195
    v_cvt_pk_bf16_f32 v202, v196, v197
    v_cvt_pk_bf16_f32 v203, v198, v199
    v_cmp_gt_u32 vcc, 8, v244
    v_mov_b32 v184, s39
    s_nop 0
    v_cndmask_b32 v200, v184, v200, vcc
    v_cndmask_b32 v201, v184, v201, vcc
    v_cndmask_b32 v202, v184, v202, vcc
    v_cndmask_b32 v203, v184, v203, vcc
    s_nop 0
    v_permlane32_swap_b32 v200, v202
    s_nop 0
    v_permlane32_swap_b32 v201, v203
    buffer_store_dwordx4 v[200:203], v252, s[12:15], s51 offen sc1
    v_accvgpr_read_b32 v204, a64
    v_accvgpr_read_b32 v205, a65
    v_accvgpr_read_b32 v206, a66
    v_accvgpr_read_b32 v207, a67
    v_accvgpr_read_b32 v208, a68
    v_accvgpr_read_b32 v209, a69
    v_accvgpr_read_b32 v210, a70
    v_accvgpr_read_b32 v211, a71
    v_pk_mul_f32 v[204:205], v[190:191], v[204:205] op_sel_hi:[0,1]
    v_pk_mul_f32 v[206:207], v[190:191], v[206:207] op_sel_hi:[0,1]
    v_pk_mul_f32 v[208:209], v[190:191], v[208:209] op_sel:[1,0] op_sel_hi:[1,1]
    v_pk_mul_f32 v[210:211], v[190:191], v[210:211] op_sel:[1,0] op_sel_hi:[1,1]
    v_cvt_pk_bf16_f32 v212, v204, v205
    v_cvt_pk_bf16_f32 v213, v206, v207
    v_cvt_pk_bf16_f32 v214, v208, v209
    v_cvt_pk_bf16_f32 v215, v210, v211
    v_mov_b32 v228, v212
    v_mov_b32 v229, s39
    v_mov_b32 v230, v213
    v_mov_b32 v231, s39
    v_mov_b32 v232, v214
    v_mov_b32 v233, s39
    v_mov_b32 v234, v215
    v_mov_b32 v235, s39
    s_add_u32 s52, s50, 16384
    buffer_store_dwordx2 v[228:229], v247, s[12:15], s50 offen offset:0 sc1
    buffer_store_dwordx2 v[230:231], v247, s[12:15], s52 offen offset:0 sc1
    buffer_store_dwordx2 v[232:233], v247, s[12:15], s50 offen offset:128 sc1
    buffer_store_dwordx2 v[234:235], v247, s[12:15], s52 offen offset:128 sc1
    s_waitcnt vmcnt(0)
    s_and_b32 s58, s2, 7
    s_barrier
    v_lshrrev_b32 v1, 6, v255
    s_nop 1
    v_readfirstlane_b32 s3, v1
    s_cmp_lg_u32 s3, 0
    s_cbranch_scc1 L_syncskip_1003
    s_load_dwordx2 s[4:5], s[0:1], 64
    s_lshl_b32 s9, s45, 2
    v_mov_b32 v2, 1
    v_mov_b32 v5, 1
    s_waitcnt lgkmcnt(0)
    s_mov_b32 s6, 256
    s_mov_b32 s7, 0x00020000
    s_mov_b64 exec, 1
    buffer_atomic_add v2, off, s[4:7], s9 sc0 sc1
    s_lshl_b32 s10, s58, 2
    s_mov_b32 s8, 0x20000
    s_waitcnt vmcnt(0)
    v_readfirstlane_b32 s3, v2
    s_cmp_lg_u32 s3, 15
    s_cbranch_scc1 L_syncnl_1004
    buffer_atomic_add v5, off, s[4:7], s9 offset:128 sc1
L_syncnl_1004:
L_sync_1002:
    buffer_load_dword v3, off, s[4:7], s10 offset:128 sc1
    s_waitcnt vmcnt(0)
    v_readfirstlane_b32 s3, v3
    s_cmp_lg_u32 s3, 0
    s_cbranch_scc1 L_syncdone_1005
    s_sub_u32 s8, s8, 1
    s_cmp_eq_u32 s8, 0
    s_cbranch_scc1 L_syncdone_1005
    s_sleep 1
    s_branch L_sync_1002
L_syncdone_1005:
    s_mov_b64 exec, -1
L_syncskip_1003:
    s_barrier
    v_mov_b32 v0, v255
    s_and_b32 s50, s2, 7
    s_lshl_b32 s50, s50, 2
    s_bfe_u32 s51, s2, 0x20003
    s_add_u32 s44, s50, s51
    s_lshr_b32 s45, s2, 5
    s_load_dwordx2 s[12:13], s[0:1], 72
    s_mov_b32 s59, 0
    v_lshrrev_b32 v168, 6, v0
    v_and_b32 v167, 63, v0
    s_nop 0
    v_readfirstlane_b32 s37, v168
    v_lshlrev_b32 v164, 4, v167
    v_and_b32 v168, 31, v167
    v_lshlrev_b32 v169, 3, v168
    v_add_u32 v165, 65536, v169
    v_min_u32 v170, 18, v168
    v_lshlrev_b32 v170, 4, v170
    v_lshrrev_b32 v171, 5, v167
    v_mul_u32_u24 v171, 304, v171
    v_add_u32 v166, v170, v171
    v_add_u32 v166, 81920, v166
    s_lshl_b32 s50, s37, 10
    s_add_u32 s51, s37, 16
    s_min_u32 s51, s51, 18
    s_lshl_b32 s51, s51, 10
    s_lshl_b32 s42, s44, 16
    s_add_u32 s46, s42, s50
    s_add_u32 s46, s46, 2097152
    s_lshl_b32 s47, s44, 14
    s_add_u32 s47, s47, s50
    s_add_u32 s47, s47, 4718592
    s_mul_i32 s48, s44, 77824
    s_add_u32 s48, s48, 5242880
    s_add_u32 s49, s48, s51
    s_add_u32 s48, s48, s50
    s_lshl_b32 s40, s45, 4
    s_lshl_b32 s41, s37, 2
    s_add_u32 s40, s40, s41
    s_mov_b32 s58, s40
    s_lshl_b32 s41, s40, 10
    s_add_u32 s41, s41, s42
    s_lshl_b32 s40, s40, 8
    s_lshl_b32 s42, s44, 14
    s_add_u32 s40, s40, s42
    s_add_u32 s40, s40, 4194304
    s_waitcnt lgkmcnt(0)
    s_mov_b32 s14, 0x10000000
    s_mov_b32 s15, 0x00020000
    buffer_load_dwordx4 v[0:3], v164, s[12:15], s41 offen offset:0 sc1
    buffer_load_dwordx4 v[4:7], v164, s[12:15], s41 offen offset:1024 sc1
    buffer_load_dwordx4 v[8:11], v164, s[12:15], s41 offen offset:2048 sc1
    buffer_load_dwordx4 v[12:15], v164, s[12:15], s41 offen offset:3072 sc1
    buffer_load_dword v244, v169, s[12:15], s40 offen offset:0 sc1
    buffer_load_dword v245, v169, s[12:15], s40 offen offset:256 sc1
    buffer_load_dword v246, v169, s[12:15], s40 offen offset:512 sc1
    buffer_load_dword v247, v169, s[12:15], s40 offen offset:768 sc1
    s_add_u32 m0, s50, 0
    s_add_u32 s42, s46, 0
    buffer_load_dwordx4 v164, s[12:15], s42 offen sc1 lds
    s_add_u32 m0, s50, 4096
    s_add_u32 s42, s46, 4096
    buffer_load_dwordx4 v164, s[12:15], s42 offen sc1 lds
    s_add_u32 m0, s50, 8192
    s_add_u32 s42, s46, 8192
    buffer_load_dwordx4 v164, s[12:15], s42 offen sc1 lds
    s_add_u32 m0, s50, 12288
    s_add_u32 s42, s46, 12288
    buffer_load_dwordx4 v164, s[12:15], s42 offen sc1 lds
    s_add_u32 m0, s50, 65536
    s_add_u32 s42, s47, 0
    buffer_load_dwordx4 v164, s[12:15], s42 offen sc1 lds
    s_add_u32 m0, s50, 81920
    s_add_u32 s42, s48, 0
    buffer_load_dwordx4 v164, s[12:15], s42 offen sc1 lds
    s_add_u32 m0, s50, 86016
    s_add_u32 s42, s48, 4096
    buffer_load_dwordx4 v164, s[12:15], s42 offen sc1 lds
    s_add_u32 m0, s50, 90112
    s_add_u32 s42, s48, 8192
    buffer_load_dwordx4 v164, s[12:15], s42 offen sc1 lds
    s_add_u32 m0, s50, 94208
    s_add_u32 s42, s48, 12288
    buffer_load_dwordx4 v164, s[12:15], s42 offen sc1 lds
    s_add_u32 m0, s51, 81920
    s_add_u32 s42, s49, 0
    buffer_load_dwordx4 v164, s[12:15], s42 offen sc1 lds
    s_add_u32 m0, s50, 16384
    s_add_u32 s42, s46, 16384
    buffer_load_dwordx4 v164, s[12:15], s42 offen sc1 lds
    s_add_u32 m0, s50, 20480
    s_add_u32 s42, s46, 20480
    buffer_load_dwordx4 v164, s[12:15], s42 offen sc1 lds
    s_add_u32 m0, s50, 24576
    s_add_u32 s42, s46, 24576
    buffer_load_dwordx4 v164, s[12:15], s42 offen sc1 lds
    s_add_u32 m0, s50, 28672
    s_add_u32 s42, s46, 28672
    buffer_load_dwordx4 v164, s[12:15], s42 offen sc1 lds
    s_add_u32 m0, s50, 69632
    s_add_u32 s42, s47, 4096
    buffer_load_dwordx4 v164, s[12:15], s42 offen sc1 lds
    s_add_u32 m0, s50, 101376
    s_add_u32 s42, s48, 19456
    buffer_load_dwordx4 v164, s[12:15], s42 offen sc1 lds
    s_add_u32 m0, s50, 105472
    s_add_u32 s42, s48, 23552
    buffer_load_dwordx4 v164, s[12:15], s42 offen sc1 lds
    s_add_u32 m0, s50, 109568
    s_add_u32 s42, s48, 27648
    buffer_load_dwordx4 v164, s[12:15], s42 offen sc1 lds
    s_add_u32 m0, s50, 113664
    s_add_u32 s42, s48, 31744
    buffer_load_dwordx4 v164, s[12:15], s42 offen sc1 lds
    s_add_u32 m0, s51, 101376
    s_add_u32 s42, s49, 19456
    buffer_load_dwordx4 v164, s[12:15], s42 offen sc1 lds
    s_add_u32 m0, s50, 32768
    s_add_u32 s42, s46, 32768
    buffer_load_dwordx4 v164, s[12:15], s42 offen sc1 lds
    s_add_u32 m0, s50, 36864
    s_add_u32 s42, s46, 36864
    buffer_load_dwordx4 v164, s[12:15], s42 offen sc1 lds
    s_add_u32 m0, s50, 40960
    s_add_u32 s42, s46, 40960
    buffer_load_dwordx4 v164, s[12:15], s42 offen sc1 lds
    s_add_u32 m0, s50, 45056
    s_add_u32 s42, s46, 45056
    buffer_load_dwordx4 v164, s[12:15], s42 offen sc1 lds
    s_add_u32 m0, s50, 73728
    s_add_u32 s42, s47, 8192
    buffer_load_dwordx4 v164, s[12:15], s42 offen sc1 lds
    s_add_u32 m0, s50, 120832
    s_add_u32 s42, s48, 38912
    buffer_load_dwordx4 v164, s[12:15], s42 offen sc1 lds
    s_add_u32 m0, s50, 124928
    s_add_u32 s42, s48, 43008
    buffer_load_dwordx4 v164, s[12:15], s42 offen sc1 lds
    s_add_u32 m0, s50, 129024
    s_add_u32 s42, s48, 47104
    buffer_load_dwordx4 v164, s[12:15], s42 offen sc1 lds
    s_add_u32 m0, s50, 133120
    s_add_u32 s42, s48, 51200
    buffer_load_dwordx4 v164, s[12:15], s42 offen sc1 lds
    s_add_u32 m0, s51, 120832
    s_add_u32 s42, s49, 38912
    buffer_load_dwordx4 v164, s[12:15], s42 offen sc1 lds
    s_add_u32 m0, s50, 49152
    s_add_u32 s42, s46, 49152
    buffer_load_dwordx4 v164, s[12:15], s42 offen sc1 lds
    s_add_u32 m0, s50, 53248
    s_add_u32 s42, s46, 53248
    buffer_load_dwordx4 v164, s[12:15], s42 offen sc1 lds
    s_add_u32 m0, s50, 57344
    s_add_u32 s42, s46, 57344
    buffer_load_dwordx4 v164, s[12:15], s42 offen sc1 lds
    s_add_u32 m0, s50, 61440
    s_add_u32 s42, s46, 61440
    buffer_load_dwordx4 v164, s[12:15], s42 offen sc1 lds
    s_add_u32 m0, s50, 77824
    s_add_u32 s42, s47, 12288
    buffer_load_dwordx4 v164, s[12:15], s42 offen sc1 lds
    s_add_u32 m0, s50, 140288
    s_add_u32 s42, s48, 58368
    buffer_load_dwordx4 v164, s[12:15], s42 offen sc1 lds
    s_add_u32 m0, s50, 144384
    s_add_u32 s42, s48, 62464
    buffer_load_dwordx4 v164, s[12:15], s42 offen sc1 lds
    s_add_u32 m0, s50, 148480
    s_add_u32 s42, s48, 66560
    buffer_load_dwordx4 v164, s[12:15], s42 offen sc1 lds
    s_add_u32 m0, s50, 152576
    s_add_u32 s42, s48, 70656
    buffer_load_dwordx4 v164, s[12:15], s42 offen sc1 lds
    s_add_u32 m0, s51, 140288
    s_add_u32 s42, s49, 58368
    buffer_load_dwordx4 v164, s[12:15], s42 offen sc1 lds
    v_bfe_u32 v168, v167, 4, 1
    v_mul_u32_u24 v168, 18432, v168
    v_and_b32 v170, 15, v167
    v_lshlrev_b32 v170, 4, v170
    v_add_u32 v241, v168, v170
    v_lshrrev_b32 v171, 5, v167
    v_lshlrev_b32 v171, 8, v171
    v_add_u32 v240, v241, v171
    v_mov_b32 v168, 0x80000000
    v_cmp_gt_u32 vcc, 32, v167
    s_nop 1
    v_cndmask_b32 v241, v168, v241, vcc
    s_mov_b32 s52, 1
    s_mov_b32 s53, 0x428c0000
    s_mov_b32 s54, 1
    s_mov_b32 s56, 0
    v_mov_b32 v100, 0
    v_mov_b32 v101, 0
    v_mov_b32 v102, 0
    v_mov_b32 v103, 0
    v_mov_b32 v104, 0
    v_mov_b32 v105, 0
    v_mov_b32 v106, 0
    v_mov_b32 v107, 0
    v_mov_b32 v108, 0
    v_mov_b32 v109, 0
    v_mov_b32 v110, 0
    v_mov_b32 v111, 0
    v_mov_b32 v112, 0
    v_mov_b32 v113, 0
    v_mov_b32 v114, 0
    v_mov_b32 v115, 0
    v_mov_b32 v116, 0
    v_mov_b32 v117, 0
    v_mov_b32 v118, 0
    v_mov_b32 v119, 0
    v_mov_b32 v120, 0
    v_mov_b32 v121, 0
    v_mov_b32 v122, 0
    v_mov_b32 v123, 0
    v_mov_b32 v124, 0
    v_mov_b32 v125, 0
    v_mov_b32 v126, 0
    v_mov_b32 v127, 0
    v_mov_b32 v128, 0
    v_mov_b32 v129, 0
    v_mov_b32 v130, 0
    v_mov_b32 v131, 0
    v_mov_b32 v132, 0
    v_mov_b32 v133, 0
    v_mov_b32 v134, 0
    v_mov_b32 v135, 0
    v_mov_b32 v136, 0
    v_mov_b32 v137, 0
    v_mov_b32 v138, 0
    v_mov_b32 v139, 0
    v_mov_b32 v140, 0
    v_mov_b32 v141, 0
    v_mov_b32 v142, 0
    v_mov_b32 v143, 0
    v_mov_b32 v144, 0
    v_mov_b32 v145, 0
    v_mov_b32 v146, 0
    v_mov_b32 v147, 0
    v_mov_b32 v148, 0
    v_mov_b32 v149, 0
    v_mov_b32 v150, 0
    v_mov_b32 v151, 0
    v_mov_b32 v152, 0
    v_mov_b32 v153, 0
    v_mov_b32 v154, 0
    v_mov_b32 v155, 0
    v_mov_b32 v156, 0
    v_mov_b32 v157, 0
    v_mov_b32 v158, 0
    v_mov_b32 v159, 0
    v_mov_b32 v160, 0
    v_mov_b32 v161, 0
    v_mov_b32 v162, 0
    v_mov_b32 v163, 0
    v_mov_b32 v64, 0
    v_mov_b32 v65, 0
    v_mov_b32 v66, 0
    v_mov_b32 v67, 0
    v_mov_b32 v68, 0
    v_mov_b32 v69, 0
    v_mov_b32 v70, 0
    v_mov_b32 v71, 0
    v_mov_b32 v96, 0
    v_mov_b32 v97, 0
    v_mov_b32 v98, 0
    v_mov_b32 v99, 0
    s_waitcnt vmcnt(30)
    s_barrier
    v_cmp_gt_u32 vcc, 32, v167
    s_nop 1
    v_cndmask_b32 v244, 0, v244, vcc
    s_nop 0
    v_cndmask_b32 v245, 0, v245, vcc
    v_cndmask_b32 v246, 0, v246, vcc
    v_cndmask_b32 v247, 0, v247, vcc
L_att_max_1006:
    s_mul_i32 s40, s58, 36864
    s_add_u32 s40, s40, 7733248
    s_lshr_b32 s41, s44, 1
    s_lshl_b32 s41, s41, 10
    s_and_b32 s42, s44, 1
    s_lshl_b32 s42, s42, 9
    s_add_u32 s41, s41, s42
    s_add_u32 s41, s41, s40
    s_lshr_b32 s42, s44, 2
    s_lshl_b32 s42, s42, 8
    s_add_u32 s40, s40, s42
    s_and_b32 s42, s44, 3
    s_lshl_b32 s42, s42, 2
    s_add_u32 s40, s40, s42
    s_add_u32 s40, s40, 16384
    v_mov_b32 v16, v244
    v_mov_b32 v17, 0
    v_mov_b32 v236, 0xff800000
    v_mov_b32 v18, v245
    v_mov_b32 v19, 0
    v_mov_b32 v237, 0xff800000
    v_mov_b32 v20, v246
    v_mov_b32 v21, 0
    v_mov_b32 v238, 0xff800000
    v_mov_b32 v22, v247
    v_mov_b32 v23, 0
    v_mov_b32 v239, 0xff800000
    v_mov_b32 v56, v164
    v_mov_b32 v57, v165
    s_mov_b32 s55, 0
L_att_maxloop_1007:
    ds_read_b128 v[72:75], v56
    ds_read_b64 v[80:81], v57
    v_add_u32 v56, 1024, v56
    v_add_u32 v57, 256, v57
    s_waitcnt lgkmcnt(0)
    v_mfma_f32_32x32x16_bf16 v[168:183], v[72:75], v[0:3], 0
    v_mfma_f32_32x32x8_bf16 v[168:183], v[80:81], v[16:17], v[168:183]
    v_mfma_f32_32x32x16_bf16 v[184:199], v[72:75], v[4:7], 0
    v_mfma_f32_32x32x8_bf16 v[184:199], v[80:81], v[18:19], v[184:199]
    v_mfma_f32_32x32x16_bf16 v[200:215], v[72:75], v[8:11], 0
    v_mfma_f32_32x32x8_bf16 v[200:215], v[80:81], v[20:21], v[200:215]
    v_mfma_f32_32x32x16_bf16 v[216:231], v[72:75], v[12:15], 0
    v_mfma_f32_32x32x8_bf16 v[216:231], v[80:81], v[22:23], v[216:231]
    s_nop 5
    v_max3_f32 v236, v236, v168, v169
    s_nop 4
    v_max3_f32 v236, v236, v170, v171
    s_nop 3
    v_max3_f32 v236, v236, v172, v173
    s_nop 2
    v_max3_f32 v236, v236, v174, v175
    s_nop 1
    v_max3_f32 v236, v236, v176, v177
    s_nop 0
    v_max3_f32 v236, v236, v178, v179
    v_max3_f32 v236, v236, v180, v181
    v_max3_f32 v236, v236, v182, v183
    v_max3_f32 v237, v237, v184, v185
    v_max3_f32 v237, v237, v186, v187
    v_max3_f32 v237, v237, v188, v189
    v_max3_f32 v237, v237, v190, v191
    v_max3_f32 v237, v237, v192, v193
    v_max3_f32 v237, v237, v194, v195
    v_max3_f32 v237, v237, v196, v197
    v_max3_f32 v237, v237, v198, v199
    v_max3_f32 v238, v238, v200, v201
    v_max3_f32 v238, v238, v202, v203
    v_max3_f32 v238, v238, v204, v205
    v_max3_f32 v238, v238, v206, v207
    v_max3_f32 v238, v238, v208, v209
    v_max3_f32 v238, v238, v210, v211
    v_max3_f32 v238, v238, v212, v213
    v_max3_f32 v238, v238, v214, v215
    s_nop 11
    v_max3_f32 v239, v239, v216, v217
    v_max3_f32 v239, v239, v218, v219
    v_max3_f32 v239, v239, v220, v221
    v_max3_f32 v239, v239, v222, v223
    v_max3_f32 v239, v239, v224, v225
    v_max3_f32 v239, v239, v226, v227
    v_max3_f32 v239, v239, v228, v229
    v_max3_f32 v239, v239, v230, v231
    s_add_u32 s55, s55, 1
    s_cmp_lt_u32 s55, s52
    s_cbranch_scc1 L_att_maxloop_1007
    v_cmp_gt_u32 vcc, 32, v167
    v_mov_b32 v168, v236
    s_nop 1
    v_permlane32_swap_b32 v236, v168
    s_nop 1
    v_max_f32 v236, v236, v168
    v_add_f32 v236, s53, v236
    v_sub_f32 v236, 0, v236
    v_cvt_pk_bf16_f32 v168, v236, v236
    v_and_b32 v169, 0xffff0000, v168
    v_sub_f32 v170, v236, v169
    v_cvt_pk_bf16_f32 v171, v170, v170
    v_and_b32 v172, 0xffff0000, v171
    v_sub_f32 v173, v170, v172
    v_cvt_pk_bf16_f32 v173, v173, v173
    v_and_b32 v173, 0xffff, v173
    v_and_b32 v168, 0xffff, v168
    v_or_b32 v168, v168, v172
    v_cndmask_b32 v17, v173, v168, vcc
    v_mov_b32 v168, v237
    s_nop 1
    v_permlane32_swap_b32 v237, v168
    s_nop 1
    v_max_f32 v237, v237, v168
    v_add_f32 v237, s53, v237
    v_sub_f32 v237, 0, v237
    v_cvt_pk_bf16_f32 v168, v237, v237
    v_and_b32 v169, 0xffff0000, v168
    v_sub_f32 v170, v237, v169
    v_cvt_pk_bf16_f32 v171, v170, v170
    v_and_b32 v172, 0xffff0000, v171
    v_sub_f32 v173, v170, v172
    v_cvt_pk_bf16_f32 v173, v173, v173
    v_and_b32 v173, 0xffff, v173
    v_and_b32 v168, 0xffff, v168
    v_or_b32 v168, v168, v172
    v_cndmask_b32 v19, v173, v168, vcc
    v_mov_b32 v168, v238
    s_nop 1
    v_permlane32_swap_b32 v238, v168
    s_nop 1
    v_max_f32 v238, v238, v168
    v_add_f32 v238, s53, v238
    v_sub_f32 v238, 0, v238
    v_cvt_pk_bf16_f32 v168, v238, v238
    v_and_b32 v169, 0xffff0000, v168
    v_sub_f32 v170, v238, v169
    v_cvt_pk_bf16_f32 v171, v170, v170
    v_and_b32 v172, 0xffff0000, v171
    v_sub_f32 v173, v170, v172
    v_cvt_pk_bf16_f32 v173, v173, v173
    v_and_b32 v173, 0xffff, v173
    v_and_b32 v168, 0xffff, v168
    v_or_b32 v168, v168, v172
    v_cndmask_b32 v21, v173, v168, vcc
    v_mov_b32 v168, v239
    s_nop 1
    v_permlane32_swap_b32 v239, v168
    s_nop 1
    v_max_f32 v239, v239, v168
    v_add_f32 v239, s53, v239
    v_sub_f32 v239, 0, v239
    v_cvt_pk_bf16_f32 v168, v239, v239
    v_and_b32 v169, 0xffff0000, v168
    v_sub_f32 v170, v239, v169
    v_cvt_pk_bf16_f32 v171, v170, v170
    v_and_b32 v172, 0xffff0000, v171
    v_sub_f32 v173, v170, v172
    v_cvt_pk_bf16_f32 v173, v173, v173
    v_and_b32 v173, 0xffff, v173
    v_and_b32 v168, 0xffff, v168
    v_or_b32 v168, v168, v172
    v_cndmask_b32 v23, v173, v168, vcc
    v_mov_b32 v168, v164
    v_mov_b32 v169, v165
    v_mov_b32 v170, v166
    ds_read_b128 v[72:75], v168 offset:0
    ds_read_b64 v[80:81], v169 offset:0
    ds_read_b128 v[84:87], v170 offset:0
    ds_read_b128 v[92:95], v170 offset:608
    s_waitcnt lgkmcnt(0)
    v_mfma_f32_32x32x16_bf16 v[24:39], v[72:75], v[0:3], 0
    v_mfma_f32_32x32x8_bf16 v[24:39], v[80:81], v[16:17], v[24:39]
    s_nop 7
    s_nop 3
    s_mov_b32 s55, 0
.p2align 6
L_att_loop_1008:
    s_cmp_lg_u32 s55, s54
    s_cbranch_scc0 L_att_event_1010
L_att_nobar_1009:
    v_mfma_f32_32x32x16_bf16 v[40:55], v[72:75], v[4:7], 0
    ds_read_b128 v[76:79], v168 offset:1024
    ds_read_b64 v[82:83], v169 offset:256
    v_exp_f32 v24, v24
    v_exp_f32 v25, v25
    v_exp_f32 v26, v26
    v_exp_f32 v27, v27
    v_cvt_pk_bf16_f32 v56, v24, v25
    v_cvt_pk_bf16_f32 v57, v26, v27
    v_mfma_f32_32x32x8_bf16 v[40:55], v[80:81], v[18:19], v[40:55]
    v_exp_f32 v28, v28
    v_exp_f32 v29, v29
    v_exp_f32 v30, v30
    v_exp_f32 v31, v31
    v_cvt_pk_bf16_f32 v58, v28, v29
    v_cvt_pk_bf16_f32 v59, v30, v31
    v_mfma_f32_32x32x16_bf16 v[148:163], v[96:99], v[68:71], v[148:163]
    v_exp_f32 v32, v32
    v_exp_f32 v33, v33
    v_exp_f32 v34, v34
    v_exp_f32 v35, v35
    v_cvt_pk_bf16_f32 v60, v32, v33
    v_cvt_pk_bf16_f32 v61, v34, v35
    v_mfma_f32_32x32x16_bf16 v[100:115], v[84:87], v[56:59], v[100:115]
    v_exp_f32 v36, v36
    v_exp_f32 v37, v37
    v_exp_f32 v38, v38
    v_exp_f32 v39, v39
    v_cvt_pk_bf16_f32 v62, v36, v37
    v_cvt_pk_bf16_f32 v63, v38, v39
    v_mfma_f32_32x32x16_bf16 v[24:39], v[72:75], v[8:11], 0
    ds_read_b128 v[88:91], v170 offset:1216
    ds_read_b128 v[96:99], v170 offset:1824
    v_exp_f32 v40, v40
    v_exp_f32 v41, v41
    v_exp_f32 v42, v42
    v_exp_f32 v43, v43
    v_cvt_pk_bf16_f32 v64, v40, v41
    v_cvt_pk_bf16_f32 v65, v42, v43
    v_mfma_f32_32x32x8_bf16 v[24:39], v[80:81], v[20:21], v[24:39]
    v_exp_f32 v44, v44
    v_exp_f32 v45, v45
    v_exp_f32 v46, v46
    v_exp_f32 v47, v47
    v_cvt_pk_bf16_f32 v66, v44, v45
    v_cvt_pk_bf16_f32 v67, v46, v47
    v_mfma_f32_32x32x16_bf16 v[100:115], v[92:95], v[60:63], v[100:115]
    v_exp_f32 v48, v48
    v_exp_f32 v49, v49
    v_exp_f32 v50, v50
    v_exp_f32 v51, v51
    v_cvt_pk_bf16_f32 v68, v48, v49
    v_cvt_pk_bf16_f32 v69, v50, v51
    v_mfma_f32_32x32x16_bf16 v[116:131], v[84:87], v[64:67], v[116:131]
    v_exp_f32 v52, v52
    v_exp_f32 v53, v53
    v_exp_f32 v54, v54
    v_exp_f32 v55, v55
    v_cvt_pk_bf16_f32 v70, v52, v53
    v_cvt_pk_bf16_f32 v71, v54, v55
    v_mfma_f32_32x32x16_bf16 v[40:55], v[72:75], v[12:15], 0
    v_exp_f32 v24, v24
    v_exp_f32 v25, v25
    v_exp_f32 v26, v26
    v_exp_f32 v27, v27
    v_cvt_pk_bf16_f32 v56, v24, v25
    v_cvt_pk_bf16_f32 v57, v26, v27
    v_mfma_f32_32x32x8_bf16 v[40:55], v[80:81], v[22:23], v[40:55]
    v_exp_f32 v28, v28
    v_exp_f32 v29, v29
    v_exp_f32 v30, v30
    v_exp_f32 v31, v31
    v_cvt_pk_bf16_f32 v58, v28, v29
    v_cvt_pk_bf16_f32 v59, v30, v31
    v_mfma_f32_32x32x16_bf16 v[116:131], v[92:95], v[68:71], v[116:131]
    v_exp_f32 v32, v32
    v_exp_f32 v33, v33
    v_exp_f32 v34, v34
    v_exp_f32 v35, v35
    v_cvt_pk_bf16_f32 v60, v32, v33
    v_cvt_pk_bf16_f32 v61, v34, v35
    v_mfma_f32_32x32x16_bf16 v[132:147], v[84:87], v[56:59], v[132:147]
    v_exp_f32 v36, v36
    v_exp_f32 v37, v37
    v_exp_f32 v38, v38
    v_exp_f32 v39, v39
    v_cvt_pk_bf16_f32 v62, v36, v37
    v_cvt_pk_bf16_f32 v63, v38, v39
    s_waitcnt lgkmcnt(0)
    v_mfma_f32_32x32x16_bf16 v[24:39], v[76:79], v[0:3], 0
    v_exp_f32 v40, v40
    v_exp_f32 v41, v41
    v_exp_f32 v42, v42
    v_exp_f32 v43, v43
    v_cvt_pk_bf16_f32 v64, v40, v41
    v_cvt_pk_bf16_f32 v65, v42, v43
    v_mfma_f32_32x32x8_bf16 v[24:39], v[82:83], v[16:17], v[24:39]
    v_exp_f32 v44, v44
    v_exp_f32 v45, v45
    v_exp_f32 v46, v46
    v_exp_f32 v47, v47
    v_cvt_pk_bf16_f32 v66, v44, v45
    v_cvt_pk_bf16_f32 v67, v46, v47
    v_mfma_f32_32x32x16_bf16 v[132:147], v[92:95], v[60:63], v[132:147]
    v_exp_f32 v48, v48
    v_exp_f32 v49, v49
    v_exp_f32 v50, v50
    v_exp_f32 v51, v51
    v_cvt_pk_bf16_f32 v68, v48, v49
    v_cvt_pk_bf16_f32 v69, v50, v51
    v_mfma_f32_32x32x16_bf16 v[148:163], v[84:87], v[64:67], v[148:163]
    v_exp_f32 v52, v52
    v_exp_f32 v53, v53
    v_exp_f32 v54, v54
    v_exp_f32 v55, v55
    v_cvt_pk_bf16_f32 v70, v52, v53
    v_cvt_pk_bf16_f32 v71, v54, v55
    v_mfma_f32_32x32x16_bf16 v[40:55], v[76:79], v[4:7], 0
    ds_read_b128 v[72:75], v168 offset:2048
    ds_read_b64 v[80:81], v169 offset:512
    v_exp_f32 v24, v24
    v_exp_f32 v25, v25
    v_exp_f32 v26, v26
    v_exp_f32 v27, v27
    v_cvt_pk_bf16_f32 v56, v24, v25
    v_cvt_pk_bf16_f32 v57, v26, v27
    v_mfma_f32_32x32x8_bf16 v[40:55], v[82:83], v[18:19], v[40:55]
    v_exp_f32 v28, v28
    v_exp_f32 v29, v29
    v_exp_f32 v30, v30
    v_exp_f32 v31, v31
    v_cvt_pk_bf16_f32 v58, v28, v29
    v_cvt_pk_bf16_f32 v59, v30, v31
    v_mfma_f32_32x32x16_bf16 v[148:163], v[92:95], v[68:71], v[148:163]
    v_exp_f32 v32, v32
    v_exp_f32 v33, v33
    v_exp_f32 v34, v34
    v_exp_f32 v35, v35
    v_cvt_pk_bf16_f32 v60, v32, v33
    v_cvt_pk_bf16_f32 v61, v34, v35
    v_mfma_f32_32x32x16_bf16 v[100:115], v[88:91], v[56:59], v[100:115]
    v_exp_f32 v36, v36
    v_exp_f32 v37, v37
    v_exp_f32 v38, v38
    v_exp_f32 v39, v39
    v_cvt_pk_bf16_f32 v62, v36, v37
    v_cvt_pk_bf16_f32 v63, v38, v39
    v_mfma_f32_32x32x16_bf16 v[24:39], v[76:79], v[8:11], 0
    ds_read_b128 v[84:87], v170 offset:2432
    ds_read_b128 v[92:95], v170 offset:3040
    v_exp_f32 v40, v40
    v_exp_f32 v41, v41
    v_exp_f32 v42, v42
    v_exp_f32 v43, v43
    v_cvt_pk_bf16_f32 v64, v40, v41
    v_cvt_pk_bf16_f32 v65, v42, v43
    v_mfma_f32_32x32x8_bf16 v[24:39], v[82:83], v[20:21], v[24:39]
    v_exp_f32 v44, v44
    v_exp_f32 v45, v45
    v_exp_f32 v46, v46
    v_exp_f32 v47, v47
    v_cvt_pk_bf16_f32 v66, v44, v45
    v_cvt_pk_bf16_f32 v67, v46, v47
    v_mfma_f32_32x32x16_bf16 v[100:115], v[96:99], v[60:63], v[100:115]
    v_exp_f32 v48, v48
    v_exp_f32 v49, v49
    v_exp_f32 v50, v50
    v_exp_f32 v51, v51
    v_cvt_pk_bf16_f32 v68, v48, v49
    v_cvt_pk_bf16_f32 v69, v50, v51
    v_mfma_f32_32x32x16_bf16 v[116:131], v[88:91], v[64:67], v[116:131]
    v_exp_f32 v52, v52
    v_exp_f32 v53, v53
    v_exp_f32 v54, v54
    v_exp_f32 v55, v55
    v_cvt_pk_bf16_f32 v70, v52, v53
    v_cvt_pk_bf16_f32 v71, v54, v55
    v_mfma_f32_32x32x16_bf16 v[40:55], v[76:79], v[12:15], 0
    v_add_u32 v168, 2048, v168
    v_add_u32 v169, 512, v169
    v_exp_f32 v24, v24
    v_exp_f32 v25, v25
    v_exp_f32 v26, v26
    v_exp_f32 v27, v27
    v_cvt_pk_bf16_f32 v56, v24, v25
    v_cvt_pk_bf16_f32 v57, v26, v27
    v_mfma_f32_32x32x8_bf16 v[40:55], v[82:83], v[22:23], v[40:55]
    v_exp_f32 v28, v28
    v_exp_f32 v29, v29
    v_exp_f32 v30, v30
    v_exp_f32 v31, v31
    v_cvt_pk_bf16_f32 v58, v28, v29
    v_cvt_pk_bf16_f32 v59, v30, v31
    v_mfma_f32_32x32x16_bf16 v[116:131], v[96:99], v[68:71], v[116:131]
    v_exp_f32 v32, v32
    v_exp_f32 v33, v33
    v_exp_f32 v34, v34
    v_exp_f32 v35, v35
    v_cvt_pk_bf16_f32 v60, v32, v33
    v_cvt_pk_bf16_f32 v61, v34, v35
    v_mfma_f32_32x32x16_bf16 v[132:147], v[88:91], v[56:59], v[132:147]
    v_exp_f32 v36, v36
    v_exp_f32 v37, v37
    v_exp_f32 v38, v38
    v_exp_f32 v39, v39
    v_cvt_pk_bf16_f32 v62, v36, v37
    v_cvt_pk_bf16_f32 v63, v38, v39
    s_waitcnt lgkmcnt(0)
    v_mfma_f32_32x32x16_bf16 v[24:39], v[72:75], v[0:3], 0
    v_exp_f32 v40, v40
    v_exp_f32 v41, v41
    v_exp_f32 v42, v42
    v_exp_f32 v43, v43
    v_cvt_pk_bf16_f32 v64, v40, v41
    v_cvt_pk_bf16_f32 v65, v42, v43
    v_mfma_f32_32x32x8_bf16 v[24:39], v[80:81], v[16:17], v[24:39]
    v_add_u32 v170, 2432, v170
    v_exp_f32 v44, v44
    v_exp_f32 v45, v45
    v_exp_f32 v46, v46
    v_exp_f32 v47, v47
    v_cvt_pk_bf16_f32 v66, v44, v45
    v_cvt_pk_bf16_f32 v67, v46, v47
    v_mfma_f32_32x32x16_bf16 v[132:147], v[96:99], v[60:63], v[132:147]
    v_exp_f32 v48, v48
    v_exp_f32 v49, v49
    v_exp_f32 v50, v50
    v_exp_f32 v51, v51
    v_cvt_pk_bf16_f32 v68, v48, v49
    v_cvt_pk_bf16_f32 v69, v50, v51
    v_mfma_f32_32x32x16_bf16 v[148:163], v[88:91], v[64:67], v[148:163]
    v_exp_f32 v52, v52
    v_exp_f32 v53, v53
    v_exp_f32 v54, v54
    v_exp_f32 v55, v55
    v_cvt_pk_bf16_f32 v70, v52, v53
    v_cvt_pk_bf16_f32 v71, v54, v55
    s_add_u32 s55, s55, 1
    s_cmp_lt_u32 s55, 32
    s_cbranch_scc1 L_att_loop_1008
    s_branch L_att_pastev_1011
L_att_event_1010:
    s_cmp_lg_u32 s54, 1
    s_cbranch_scc1 L_att_ev_1012
    s_load_dwordx2 s[32:33], s[0:1], 32
    s_load_dwordx2 s[24:25], s[0:1], 40
    s_bfe_u32 s28, s2, 0x40003
    s_lshl_b32 s28, s28, 2
    s_add_u32 s28, s28, s37
    s_mul_i32 s28, s28, 3
    v_mul_u32_u24 v176, 9216, v167
    s_and_b32 s29, s2, 6
    s_mul_i32 s29, s29, 1152
    s_mov_b32 s35, 0x00020000
    s_waitcnt lgkmcnt(0)
    s_mov_b32 s26, s32
    s_mov_b32 s27, s33
    s_mul_i32 s30, s28, 8193
    s_lshr_b32 s30, s30, 16
    s_mul_i32 s31, s30, 8
    s_sub_u32 s31, s28, s31
    s_cmp_ge_u32 s31, 4
    s_cselect_b32 s34, 10, 5
    s_add_u32 s31, s31, s34
    s_lshl_b32 s31, s31, 7
    s_add_u32 s31, s31, s29
    s_cmp_ge_u32 s30, 9
    s_cselect_b32 s32, s24, s26
    s_cselect_b32 s33, s25, s27
    s_cselect_b32 s34, 9, 0
    s_sub_u32 s34, s30, s34
    s_mul_i32 s34, s34, 589824
    s_add_u32 s31, s31, s34
    s_cmp_ge_u32 s30, 18
    s_cselect_b32 s34, 0, 5308416
    buffer_load_dword v177, v176, s[32:35], s31 offen
    s_add_u32 s28, s28, 1
    s_mul_i32 s30, s28, 8193
    s_lshr_b32 s30, s30, 16
    s_mul_i32 s31, s30, 8
    s_sub_u32 s31, s28, s31
    s_cmp_ge_u32 s31, 4
    s_cselect_b32 s34, 10, 5
    s_add_u32 s31, s31, s34
    s_lshl_b32 s31, s31, 7
    s_add_u32 s31, s31, s29
    s_cmp_ge_u32 s30, 9
    s_cselect_b32 s32, s24, s26
    s_cselect_b32 s33, s25, s27
    s_cselect_b32 s34, 9, 0
    s_sub_u32 s34, s30, s34
    s_mul_i32 s34, s34, 589824
    s_add_u32 s31, s31, s34
    s_cmp_ge_u32 s30, 18
    s_cselect_b32 s34, 0, 5308416
    buffer_load_dword v178, v176, s[32:35], s31 offen
    s_add_u32 s28, s28, 1
    s_mul_i32 s30, s28, 8193
    s_lshr_b32 s30, s30, 16
    s_mul_i32 s31, s30, 8
    s_sub_u32 s31, s28, s31
    s_cmp_ge_u32 s31, 4
    s_cselect_b32 s34, 10, 5
    s_add_u32 s31, s31, s34
    s_lshl_b32 s31, s31, 7
    s_add_u32 s31, s31, s29
    s_cmp_ge_u32 s30, 9
    s_cselect_b32 s32, s24, s26
    s_cselect_b32 s33, s25, s27
    s_cselect_b32 s34, 9, 0
    s_sub_u32 s34, s30, s34
    s_mul_i32 s34, s34, 589824
    s_add_u32 s31, s31, s34
    s_cmp_ge_u32 s30, 18
    s_cselect_b32 s34, 0, 5308416
    buffer_load_dword v179, v176, s[32:35], s31 offen
    s_add_u32 s28, s28, 1
    s_mov_b32 s54, 7
    s_branch L_att_nobar_1009
L_att_ev_1012:
    s_cmp_lg_u32 s54, 7
    s_cbranch_scc1 L_att_ev_1013
    s_waitcnt vmcnt(0)
    s_barrier
    s_mov_b32 s54, 10
    s_branch L_att_nobar_1009
L_att_ev_1013:
    s_cmp_lg_u32 s54, 10
    s_cbranch_scc1 L_att_ev_1014
    s_load_dwordx2 s[32:33], s[0:1], 48
    s_bfe_u32 s28, s2, 0x40003
    s_lshl_b32 s28, s28, 2
    s_add_u32 s28, s28, s37
    s_mul_i32 s28, s28, 20736
    s_and_b32 s29, s2, 6
    s_mul_i32 s29, s29, 663552
    s_add_u32 s28, s28, s29
    v_lshlrev_b32 v176, 7, v167
    s_mov_b32 s34, 5308416
    s_mov_b32 s35, 0x00020000
    s_waitcnt lgkmcnt(0)
    buffer_load_dword v177, v176, s[32:35], s28 offen
    s_add_u32 s28, s28, 8192
    buffer_load_dword v178, v176, s[32:35], s28 offen
    s_add_u32 s28, s28, 8192
    v_mov_b32 v180, 0x80000000
    v_cmp_gt_u32 vcc, 34, v167
    s_nop 1
    v_cndmask_b32 v176, v180, v176, vcc
    buffer_load_dword v179, v176, s[32:35], s28 offen
    s_add_u32 s28, s28, 8192
    s_mov_b32 s54, 26
    s_branch L_att_nobar_1009
L_att_ev_1014:
    s_cmp_lg_u32 s54, 26
    s_cbranch_scc1 L_att_ev_1015
    s_load_dwordx2 s[24:25], s[0:1], 16
    s_bfe_u32 s28, s2, 0x40003
    s_lshl_b32 s28, s28, 2
    s_add_u32 s28, s28, s37
    s_mul_i32 s28, s28, 10368
    v_lshlrev_b32 v176, 7, v167
    s_mov_b32 s26, 663552
    s_mov_b32 s27, 0x00020000
    s_waitcnt lgkmcnt(0)
    buffer_load_dword v177, v176, s[24:27], s28 offen
    s_add_u32 s28, s28, 8192
    buffer_load_dword v178, v176, s[24:27], s28 offen
    s_mov_b32 s54, 30
    s_branch L_att_nobar_1009
L_att_ev_1015:
    s_cmp_lg_u32 s54, 30
    s_cbranch_scc1 L_att_ev_1016
    s_load_dwordx2 s[24:25], s[0:1], 64
    s_and_b32 s28, s2, 7
    s_lshl_b32 s28, s28, 2
    s_bfe_u32 s29, s2, 0x20003
    s_add_u32 s28, s28, s29
    s_lshr_b32 s29, s28, 1
    s_lshl_b32 s29, s29, 2
    s_add_u32 s29, s29, 192
    s_mov_b32 s26, 256
    s_mov_b32 s27, 0x00020000
    s_waitcnt vmcnt(0) lgkmcnt(0)
    s_cmp_lg_u32 s37, 0
    s_cbranch_scc1 L_att_np_1017
    s_mov_b64 exec, 1
    buffer_load_dword v177, off, s[24:27], s29 sc1
    s_mov_b64 exec, -1
L_att_np_1017:
    s_mov_b32 s54, 31
    s_branch L_att_nobar_1009
L_att_ev_1016:
    v_mov_b32 v178, 163776
    s_cmp_lg_u32 s37, 0
    s_cbranch_scc1 L_att_nw_1019
    s_waitcnt vmcnt(0)
    v_readfirstlane_b32 s30, v177
    s_nop 1
    v_mov_b32 v179, s30
    ds_write_b32 v178, v179
L_att_nw_1019:
    s_waitcnt lgkmcnt(0)
    s_barrier
    ds_read_b32 v179, v178
    s_lshr_b32 s29, s2, 6
    s_lshl_b32 s29, s29, 3
    s_lshl_b32 s30, s28, 2
    s_add_u32 s30, s30, s37
    s_mul_i32 s30, s30, 18432
    s_lshr_b32 s31, s2, 5
    s_mul_i32 s31, s31, 3072
    s_add_u32 s30, s30, s31
    s_add_u32 s30, s30, 10100736
    s_waitcnt lgkmcnt(0)
    v_readfirstlane_b32 s31, v179
    s_lshr_b32 s31, s31, s29
    s_and_b32 s31, s31, 0xff
    s_cbranch_scc0 L_att_nop_1020
    buffer_load_dwordx4 a[64:67], v164, s[12:15], s30 offen offset:0 sc1
    buffer_load_dwordx4 a[68:71], v164, s[12:15], s30 offen offset:1024 sc1
    buffer_load_dwordx4 a[72:75], v164, s[12:15], s30 offen offset:2048 sc1
    s_add_u32 s30, s30, 2359296
    buffer_load_dwordx4 a[76:79], v164, s[12:15], s30 offen offset:0 sc1
    buffer_load_dwordx4 a[80:83], v164, s[12:15], s30 offen offset:1024 sc1
    buffer_load_dwordx4 a[84:87], v164, s[12:15], s30 offen offset:2048 sc1
    s_add_u32 s30, s30, 2359296
    buffer_load_dwordx4 a[88:91], v164, s[12:15], s30 offen offset:0 sc1
    buffer_load_dwordx4 a[92:95], v164, s[12:15], s30 offen offset:1024 sc1
    buffer_load_dwordx4 a[96:99], v164, s[12:15], s30 offen offset:2048 sc1
    s_add_u32 s30, s30, 2359296
    buffer_load_dwordx4 a[100:103], v164, s[12:15], s30 offen offset:0 sc1
    buffer_load_dwordx4 a[104:107], v164, s[12:15], s30 offen offset:1024 sc1
    buffer_load_dwordx4 a[108:111], v164, s[12:15], s30 offen offset:2048 sc1
    s_add_u32 s30, s30, 2359296
    buffer_load_dwordx4 a[112:115], v164, s[12:15], s30 offen offset:0 sc1
    buffer_load_dwordx4 a[116:119], v164, s[12:15], s30 offen offset:1024 sc1
    buffer_load_dwordx4 a[120:123], v164, s[12:15], s30 offen offset:2048 sc1
    s_add_u32 s30, s30, 2359296
    buffer_load_dwordx4 a[124:127], v164, s[12:15], s30 offen offset:0 sc1
    buffer_load_dwordx4 a[128:131], v164, s[12:15], s30 offen offset:1024 sc1
    buffer_load_dwordx4 a[132:135], v164, s[12:15], s30 offen offset:2048 sc1
    s_add_u32 s30, s30, 2359296
    buffer_load_dwordx4 a[136:139], v164, s[12:15], s30 offen offset:0 sc1
    buffer_load_dwordx4 a[140:143], v164, s[12:15], s30 offen offset:1024 sc1
    buffer_load_dwordx4 a[144:147], v164, s[12:15], s30 offen offset:2048 sc1
    s_add_u32 s30, s30, 2359296
    buffer_load_dwordx4 a[148:151], v164, s[12:15], s30 offen offset:0 sc1
    buffer_load_dwordx4 a[152:155], v164, s[12:15], s30 offen offset:1024 sc1
    buffer_load_dwordx4 a[156:159], v164, s[12:15], s30 offen offset:2048 sc1
    s_mov_b32 s59, 1
L_att_nop_1020:
    s_mov_b32 s54, 99
    s_branch L_att_nobar_1009
L_att_ev_1018:
L_att_pastev_1011:
    s_nop 1
    v_mfma_f32_32x32x16_bf16 v[148:163], v[96:99], v[68:71], v[148:163]
    s_nop 7
    s_nop 3
    s_waitcnt lgkmcnt(0)
    v_rcp_f32 v168, v110
    v_rcp_f32 v176, v126
    v_rcp_f32 v184, v142
    v_rcp_f32 v192, v158
    v_mov_b32 v200, 0
    v_mov_b32 v201, 0
    v_mov_b32 v202, 0
    v_mov_b32 v203, 0
    v_mov_b32 v204, 0
    v_mov_b32 v205, 0
    v_pk_mul_f32 v[100:101], v[168:169], v[100:101] op_sel_hi:[0,1]
    v_pk_mul_f32 v[102:103], v[168:169], v[102:103] op_sel_hi:[0,1]
    v_pk_mul_f32 v[104:105], v[168:169], v[104:105] op_sel_hi:[0,1]
    v_pk_mul_f32 v[106:107], v[168:169], v[106:107] op_sel_hi:[0,1]
    v_pk_mul_f32 v[108:109], v[168:169], v[108:109] op_sel_hi:[0,1]
    v_cvt_pk_bf16_f32 v208, v100, v101
    v_cvt_pk_bf16_f32 v209, v102, v103
    v_cvt_pk_bf16_f32 v210, v104, v105
    v_cvt_pk_bf16_f32 v211, v106, v107
    v_cvt_pk_bf16_f32 v212, v108, v109
    buffer_store_dwordx4 v[208:211], v240, s[12:15], s41 offen sc1
    buffer_store_dword v212, v241, s[12:15], s40 offen sc1
    s_add_u32 s40, s40, 36864
    s_add_u32 s41, s41, 36864
    v_pk_mul_f32 v[116:117], v[176:177], v[116:117] op_sel_hi:[0,1]
    v_pk_mul_f32 v[118:119], v[176:177], v[118:119] op_sel_hi:[0,1]
    v_pk_mul_f32 v[120:121], v[176:177], v[120:121] op_sel_hi:[0,1]
    v_pk_mul_f32 v[122:123], v[176:177], v[122:123] op_sel_hi:[0,1]
    v_pk_mul_f32 v[124:125], v[176:177], v[124:125] op_sel_hi:[0,1]
    v_cvt_pk_bf16_f32 v216, v116, v117
    v_cvt_pk_bf16_f32 v217, v118, v119
    v_cvt_pk_bf16_f32 v218, v120, v121
    v_cvt_pk_bf16_f32 v219, v122, v123
    v_cvt_pk_bf16_f32 v220, v124, v125
    buffer_store_dwordx4 v[216:219], v240, s[12:15], s41 offen sc1
    buffer_store_dword v220, v241, s[12:15], s40 offen sc1
    s_add_u32 s40, s40, 36864
    s_add_u32 s41, s41, 36864
    v_pk_mul_f32 v[132:133], v[184:185], v[132:133] op_sel_hi:[0,1]
    v_pk_mul_f32 v[134:135], v[184:185], v[134:135] op_sel_hi:[0,1]
    v_pk_mul_f32 v[136:137], v[184:185], v[136:137] op_sel_hi:[0,1]
    v_pk_mul_f32 v[138:139], v[184:185], v[138:139] op_sel_hi:[0,1]
    v_pk_mul_f32 v[140:141], v[184:185], v[140:141] op_sel_hi:[0,1]
    v_cvt_pk_bf16_f32 v224, v132, v133
    v_cvt_pk_bf16_f32 v225, v134, v135
    v_cvt_pk_bf16_f32 v226, v136, v137
    v_cvt_pk_bf16_f32 v227, v138, v139
    v_cvt_pk_bf16_f32 v228, v140, v141
    buffer_store_dwordx4 v[224:227], v240, s[12:15], s41 offen sc1
    buffer_store_dword v228, v241, s[12:15], s40 offen sc1
    s_add_u32 s40, s40, 36864
    s_add_u32 s41, s41, 36864
    v_pk_mul_f32 v[148:149], v[192:193], v[148:149] op_sel_hi:[0,1]
    v_pk_mul_f32 v[150:151], v[192:193], v[150:151] op_sel_hi:[0,1]
    v_pk_mul_f32 v[152:153], v[192:193], v[152:153] op_sel_hi:[0,1]
    v_pk_mul_f32 v[154:155], v[192:193], v[154:155] op_sel_hi:[0,1]
    v_pk_mul_f32 v[156:157], v[192:193], v[156:157] op_sel_hi:[0,1]
    v_cvt_pk_bf16_f32 v232, v148, v149
    v_cvt_pk_bf16_f32 v233, v150, v151
    v_cvt_pk_bf16_f32 v234, v152, v153
    v_cvt_pk_bf16_f32 v235, v154, v155
    v_cvt_pk_bf16_f32 v236, v156, v157
    buffer_store_dwordx4 v[232:235], v240, s[12:15], s41 offen sc1
    buffer_store_dword v236, v241, s[12:15], s40 offen sc1
    s_cmp_lg_u32 s56, 0
    s_cbranch_scc1 L_att_ok_1021
    v_pk_fma_f32 v[202:203], v[100:101], v[200:201], v[202:203]
    v_pk_fma_f32 v[204:205], v[116:117], v[200:201], v[204:205]
    v_pk_fma_f32 v[202:203], v[132:133], v[200:201], v[202:203]
    v_pk_fma_f32 v[204:205], v[148:149], v[200:201], v[204:205]
    v_pk_fma_f32 v[202:203], v[102:103], v[200:201], v[202:203]
    v_pk_fma_f32 v[204:205], v[118:119], v[200:201], v[204:205]
    v_pk_fma_f32 v[202:203], v[134:135], v[200:201], v[202:203]
    v_pk_fma_f32 v[204:205], v[150:151], v[200:201], v[204:205]
    v_pk_fma_f32 v[202:203], v[104:105], v[200:201], v[202:203]
    v_pk_fma_f32 v[204:205], v[120:121], v[200:201], v[204:205]
    v_pk_fma_f32 v[202:203], v[136:137], v[200:201], v[202:203]
    v_pk_fma_f32 v[204:205], v[152:153], v[200:201], v[204:205]
    v_pk_fma_f32 v[202:203], v[106:107], v[200:201], v[202:203]
    v_pk_fma_f32 v[204:205], v[122:123], v[200:201], v[204:205]
    v_pk_fma_f32 v[202:203], v[138:139], v[200:201], v[202:203]
    v_pk_fma_f32 v[204:205], v[154:155], v[200:201], v[204:205]
    v_pk_fma_f32 v[202:203], v[108:109], v[200:201], v[202:203]
    v_pk_fma_f32 v[204:205], v[124:125], v[200:201], v[204:205]
    v_pk_fma_f32 v[202:203], v[140:141], v[200:201], v[202:203]
    v_pk_fma_f32 v[204:205], v[156:157], v[200:201], v[204:205]
    v_fma_f32 v202, v110, v200, v202
    v_fma_f32 v204, v126, v200, v204
    v_fma_f32 v203, v142, v200, v203
    v_fma_f32 v205, v158, v200, v205
    v_min3_f32 v206, v110, v126, v142
    v_max3_f32 v207, v110, v126, v142
    v_pk_add_f32 v[202:203], v[202:203], v[204:205]
    v_min_f32 v206, v206, v158
    v_max_f32 v207, v207, v158
    v_cmp_u_f32 s[68:69], v202, v203
    v_cmp_nlt_f32 vcc, 0x12800000, v206
    s_or_b64 s[68:69], s[68:69], vcc
    v_cmp_ngt_f32 vcc, 0x76800000, v207
    s_or_b64 s[68:69], s[68:69], vcc
    s_cmp_eq_u64 s[68:69], 0
    s_cbranch_scc1 L_att_ok_1021
    s_mov_b32 s56, 1
    s_mov_b32 s52, 64
    s_mov_b32 s53, 0
    s_mov_b32 s54, 99
    s_waitcnt vmcnt(0)
    v_mov_b32 v100, 0
    v_mov_b32 v101, 0
    v_mov_b32 v102, 0
    v_mov_b32 v103, 0
    v_mov_b32 v104, 0
    v_mov_b32 v105, 0
    v_mov_b32 v106, 0
    v_mov_b32 v107, 0
    v_mov_b32 v108, 0
    v_mov_b32 v109, 0
    v_mov_b32 v110, 0
    v_mov_b32 v111, 0
    v_mov_b32 v112, 0
    v_mov_b32 v113, 0
    v_mov_b32 v114, 0
    v_mov_b32 v115, 0
    v_mov_b32 v116, 0
    v_mov_b32 v117, 0
    v_mov_b32 v118, 0
    v_mov_b32 v119, 0
    v_mov_b32 v120, 0
    v_mov_b32 v121, 0
    v_mov_b32 v122, 0
    v_mov_b32 v123, 0
    v_mov_b32 v124, 0
    v_mov_b32 v125, 0
    v_mov_b32 v126, 0
    v_mov_b32 v127, 0
    v_mov_b32 v128, 0
    v_mov_b32 v129, 0
    v_mov_b32 v130, 0
    v_mov_b32 v131, 0
    v_mov_b32 v132, 0
    v_mov_b32 v133, 0
    v_mov_b32 v134, 0
    v_mov_b32 v135, 0
    v_mov_b32 v136, 0
    v_mov_b32 v137, 0
    v_mov_b32 v138, 0
    v_mov_b32 v139, 0
    v_mov_b32 v140, 0
    v_mov_b32 v141, 0
    v_mov_b32 v142, 0
    v_mov_b32 v143, 0
    v_mov_b32 v144, 0
    v_mov_b32 v145, 0
    v_mov_b32 v146, 0
    v_mov_b32 v147, 0
    v_mov_b32 v148, 0
    v_mov_b32 v149, 0
    v_mov_b32 v150, 0
    v_mov_b32 v151, 0
    v_mov_b32 v152, 0
    v_mov_b32 v153, 0
    v_mov_b32 v154, 0
    v_mov_b32 v155, 0
    v_mov_b32 v156, 0
    v_mov_b32 v157, 0
    v_mov_b32 v158, 0
    v_mov_b32 v159, 0
    v_mov_b32 v160, 0
    v_mov_b32 v161, 0
    v_mov_b32 v162, 0
    v_mov_b32 v163, 0
    v_mov_b32 v64, 0
    v_mov_b32 v65, 0
    v_mov_b32 v66, 0
    v_mov_b32 v67, 0
    v_mov_b32 v68, 0
    v_mov_b32 v69, 0
    v_mov_b32 v70, 0
    v_mov_b32 v71, 0
    v_mov_b32 v96, 0
    v_mov_b32 v97, 0
    v_mov_b32 v98, 0
    v_mov_b32 v99, 0
    s_branch L_att_max_1006
L_att_ok_1021:
    s_load_dwordx2 s[20:21], s[0:1], 64
    s_lshl_b32 s52, s45, 2
    s_add_u32 s52, s52, 32
    s_mov_b32 s58, 0
L_fin_uni:
    s_and_b32 s50, s2, 7
    s_lshl_b32 s50, s50, 2
    s_bfe_u32 s51, s2, 0x20003
    s_add_u32 s44, s50, s51
    s_lshr_b32 s45, s2, 5
    s_lshr_b32 s57, s44, 3
    s_lshl_b32 s57, s57, 2
    s_add_u32 s57, s57, 32
    s_lshr_b32 s53, s44, 1
    s_lshl_b32 s53, s53, 2
    s_add_u32 s53, s53, 64
    s_lshr_b32 s51, s45, 1
    s_lshl_b32 s51, s51, 3
    s_lshl_b32 s61, 0xff, s51
    s_lshl_b32 s62, s58, 4
    s_cmp_eq_u32 s58, 0
    s_cselect_b32 s63, 31, 7
    s_load_dwordx2 s[4:5], s[0:1], 0
    s_load_dwordx2 s[8:9], s[0:1], 16
    s_load_dwordx2 s[12:13], s[0:1], 72
    s_load_dwordx2 s[16:17], s[0:1], 56
    v_mbcnt_lo_u32_b32 v222, -1, 0
    v_mbcnt_hi_u32_b32 v222, -1, v222
    v_lshlrev_b32 v223, 4, v222
    s_lshl_b32 s46, s44, 2
    s_add_u32 s46, s46, s37
    s_mul_i32 s40, s46, 18432
    s_mul_i32 s41, s45, 3072
    s_add_u32 s49, s40, s41
    s_add_u32 s49, s49, 10100736
    s_add_u32 s40, s40, 7733248
    s_lshl_b32 s42, s37, 6
    v_add_u32 v226, s42, v222
    v_mul_u32_u24 v227, 683, v226
    v_lshrrev_b32 v227, 13, v227
    v_mul_u32_u24 v228, 12, v227
    v_sub_u32 v228, v226, v228
    v_bfe_u32 v229, v227, 2, 1
    v_lshlrev_b32 v229, 1, v229
    v_xor_b32 v228, v228, v229
    v_lshlrev_b32 v228, 4, v228
    v_lshrrev_b32 v229, 5, v227
    v_bfe_u32 v230, v227, 4, 1
    v_bfe_u32 v231, v227, 2, 2
    v_mul_u32_u24 v232, 36, v229
    v_lshrrev_b32 v233, 1, v231
    v_mul_u32_u24 v233, 18, v233
    v_add_u32 v232, v232, v233
    v_and_b32 v233, 1, v231
    v_lshlrev_b32 v233, 2, v233
    v_add_u32 v232, v232, v233
    v_lshlrev_b32 v233, 3, v230
    v_add_u32 v232, v232, v233
    v_and_b32 v233, 3, v227
    v_add_u32 v232, v232, v233
    v_mul_u32_u24 v232, 1152, v232
    v_add_u32 v216, v232, v228
    v_lshlrev_b32 v232, 4, v229
    v_lshlrev_b32 v233, 2, v231
    v_add_u32 v232, v232, v233
    v_lshlrev_b32 v233, 1, v230
    v_add_u32 v232, v232, v233
    v_bfe_u32 v233, v227, 1, 1
    v_add_u32 v232, v232, v233
    v_mul_u32_u24 v232, 18, v232
    v_and_b32 v233, 1, v227
    v_add3_u32 v232, v232, v233, 16
    v_mul_u32_u24 v232, 1152, v232
    v_add_u32 v219, v232, v228
    v_add_u32 v226, s42, v222
    v_add_u32 v226, 256, v226
    v_mul_u32_u24 v227, 683, v226
    v_lshrrev_b32 v227, 13, v227
    v_mul_u32_u24 v228, 12, v227
    v_sub_u32 v228, v226, v228
    v_bfe_u32 v229, v227, 2, 1
    v_lshlrev_b32 v229, 1, v229
    v_xor_b32 v228, v228, v229
    v_lshlrev_b32 v228, 4, v228
    v_lshrrev_b32 v229, 5, v227
    v_bfe_u32 v230, v227, 4, 1
    v_bfe_u32 v231, v227, 2, 2
    v_mul_u32_u24 v232, 36, v229
    v_lshrrev_b32 v233, 1, v231
    v_mul_u32_u24 v233, 18, v233
    v_add_u32 v232, v232, v233
    v_and_b32 v233, 1, v231
    v_lshlrev_b32 v233, 2, v233
    v_add_u32 v232, v232, v233
    v_lshlrev_b32 v233, 3, v230
    v_add_u32 v232, v232, v233
    v_and_b32 v233, 3, v227
    v_add_u32 v232, v232, v233
    v_mul_u32_u24 v232, 1152, v232
    v_add_u32 v217, v232, v228
    v_lshlrev_b32 v232, 4, v229
    v_lshlrev_b32 v233, 2, v231
    v_add_u32 v232, v232, v233
    v_lshlrev_b32 v233, 1, v230
    v_add_u32 v232, v232, v233
    v_bfe_u32 v233, v227, 1, 1
    v_add_u32 v232, v232, v233
    v_mul_u32_u24 v232, 18, v232
    v_and_b32 v233, 1, v227
    v_add3_u32 v232, v232, v233, 16
    v_mul_u32_u24 v232, 1152, v232
    v_add_u32 v220, v232, v228
    v_add_u32 v226, s42, v222
    v_add_u32 v226, 512, v226
    v_mul_u32_u24 v227, 683, v226
    v_lshrrev_b32 v227, 13, v227
    v_mul_u32_u24 v228, 12, v227
    v_sub_u32 v228, v226, v228
    v_bfe_u32 v229, v227, 2, 1
    v_lshlrev_b32 v229, 1, v229
    v_xor_b32 v228, v228, v229
    v_lshlrev_b32 v228, 4, v228
    v_lshrrev_b32 v229, 5, v227
    v_bfe_u32 v230, v227, 4, 1
    v_bfe_u32 v231, v227, 2, 2
    v_mul_u32_u24 v232, 36, v229
    v_lshrrev_b32 v233, 1, v231
    v_mul_u32_u24 v233, 18, v233
    v_add_u32 v232, v232, v233
    v_and_b32 v233, 1, v231
    v_lshlrev_b32 v233, 2, v233
    v_add_u32 v232, v232, v233
    v_lshlrev_b32 v233, 3, v230
    v_add_u32 v232, v232, v233
    v_and_b32 v233, 3, v227
    v_add_u32 v232, v232, v233
    v_mul_u32_u24 v232, 1152, v232
    v_add_u32 v218, v232, v228
    v_lshlrev_b32 v232, 4, v229
    v_lshlrev_b32 v233, 2, v231
    v_add_u32 v232, v232, v233
    v_lshlrev_b32 v233, 1, v230
    v_add_u32 v232, v232, v233
    v_bfe_u32 v233, v227, 1, 1
    v_add_u32 v232, v232, v233
    v_mul_u32_u24 v232, 18, v232
    v_and_b32 v233, 1, v227
    v_add3_u32 v232, v232, v233, 16
    v_mul_u32_u24 v232, 1152, v232
    v_add_u32 v221, v232, v228
    s_waitcnt vmcnt(0)
    s_waitcnt lgkmcnt(0)
    s_mov_b32 s22, 256
    s_mov_b32 s23, 0x00020000
    s_barrier
    s_cmp_lg_u32 s37, 0
    s_cbranch_scc1 L_sig_1022
    s_lshl_b32 s56, 1, s62
    v_mov_b32 v251, s56
    v_mov_b32 v252, s56
    s_mov_b64 exec, 1
    buffer_atomic_add v251, off, s[20:23], s52 sc0 sc1
    s_waitcnt vmcnt(0)
    v_readfirstlane_b32 s56, v251
    s_lshr_b32 s56, s56, s62
    s_and_b32 s56, s56, 0xff
    s_cmp_lg_u32 s56, s63
    s_cbranch_scc1 L_sig2_1023
    buffer_atomic_add v252, off, s[20:23], s52 offset:128 sc1
L_sig2_1023:
    s_mov_b64 exec, -1
L_sig_1022:
    s_mov_b32 s6, 2359296
    s_mov_b32 s7, 0x00020000
    s_mov_b32 s10, 663552
    s_mov_b32 s11, 0x00020000
    s_mov_b32 s14, 268435456
    s_mov_b32 s15, 0x00020000
    s_mov_b32 s18, 2359296
    s_mov_b32 s19, 0x00020000
    s_mul_i32 s48, s45, 192
    s_lshl_b32 s47, s37, 10
    s_mov_b32 s33, 24576
    s_mov_b32 s35, 86016
    s_mov_b32 s26, 98304
    s_cmp_lg_u32 s58, 0
    s_cselect_b32 s33, 73728, s33
    s_cselect_b32 s35, 135168, s35
    s_cselect_b32 s26, 147456, s26
    s_add_u32 s26, s26, s47
    s_lshl_b32 s54, s46, 6
    s_add_u32 s54, s54, 10092544
    s_mul_i32 s41, s46, 18432
    s_mul_i32 s42, s45, 192
    s_add_u32 s41, s41, s42
    v_mov_b32 v249, s57
    v_writelane_b32 v249, s53, 1
    v_mov_b32 v248, 163784
    s_mov_b32 s24, s12
    s_mov_b32 s25, s13
    s_mov_b32 s27, 0x00020000
    s_mov_b32 s34, s49
    s_cmp_lg_u32 s58, 0
    s_cbranch_scc1 L_fin_wm_1034
    s_add_u32 m0, s47, 0
    s_nop 0
    buffer_load_dwordx4 v216, s[8:11], s48 offen  lds
    v_and_b32 v234, 15, v222
    v_lshrrev_b32 v235, 4, v222
    s_add_u32 m0, s47, 4096
    s_nop 0
    buffer_load_dwordx4 v217, s[8:11], s48 offen  lds
    v_mul_u32_u24 v224, 1152, v234
    v_lshlrev_b32 v236, 3, v235
    s_add_u32 m0, s47, 8192
    s_nop 0
    buffer_load_dwordx4 v218, s[8:11], s48 offen  lds
    v_add_u32 v224, v224, v236
    v_lshrrev_b32 v236, 2, v234
    s_add_u32 s48, s48, 82944
    s_add_u32 m0, s47, 12288
    s_nop 0
    buffer_load_dwordx4 v216, s[8:11], s48 offen  lds
    v_and_b32 v237, 3, v234
    v_mov_b32 v238, 0x3f80
    s_add_u32 m0, s47, 16384
    s_nop 0
    buffer_load_dwordx4 v217, s[8:11], s48 offen  lds
    v_and_b32 v239, 1, v237
    v_lshlrev_b32 v239, 4, v239
    s_add_u32 m0, s47, 20480
    s_nop 0
    buffer_load_dwordx4 v218, s[8:11], s48 offen  lds
    v_lshlrev_b32 v238, v239, v238
    v_cmp_eq_u32 vcc, v236, v235
    s_add_u32 s48, s48, 82944
    s_add_u32 m0, s47, 24576
    s_nop 0
    buffer_load_dwordx4 v216, s[8:11], s48 offen  lds
    v_cndmask_b32 v238, 0, v238, vcc
    v_cmp_gt_u32 vcc, 2, v237
    s_add_u32 m0, s47, 28672
    s_nop 0
    buffer_load_dwordx4 v217, s[8:11], s48 offen  lds
    v_cndmask_b32 v182, 0, v238, vcc
    v_sub_u32 v183, v238, v182
    s_add_u32 m0, s47, 32768
    s_nop 0
    buffer_load_dwordx4 v218, s[8:11], s48 offen  lds
    v_mov_b32 v180, 0
    v_mov_b32 v181, 0
    s_add_u32 s48, s48, 82944
    s_add_u32 m0, s47, 36864
    s_nop 0
    buffer_load_dwordx4 v216, s[8:11], s48 offen  lds
    v_mov_b32 v184, 0
    v_mov_b32 v185, 0
    s_add_u32 m0, s47, 40960
    s_nop 0
    buffer_load_dwordx4 v217, s[8:11], s48 offen  lds
    v_lshrrev_b32 v236, 2, v222
    v_mul_u32_u24 v236, 192, v236
    s_add_u32 m0, s47, 45056
    s_nop 0
    buffer_load_dwordx4 v218, s[8:11], s48 offen  lds
    v_and_b32 v237, 3, v222
    v_lshlrev_b32 v237, 3, v237
    s_add_u32 s48, s48, 82944
    s_add_u32 m0, s47, 49152
    s_nop 0
    buffer_load_dwordx4 v216, s[8:11], s48 offen  lds
    v_add_u32 v236, v236, v237
    v_and_b32 v237, 1, v235
    s_add_u32 m0, s47, 53248
    s_nop 0
    buffer_load_dwordx4 v217, s[8:11], s48 offen  lds
    v_lshlrev_b32 v237, 5, v237
    v_add_u32 v212, v236, v237
    s_add_u32 m0, s47, 57344
    s_nop 0
    buffer_load_dwordx4 v218, s[8:11], s48 offen  lds
    v_sub_u32 v213, v236, v237
    v_add_u32 v213, 32, v213
    s_add_u32 s48, s48, 82944
    s_add_u32 m0, s47, 61440
    s_nop 0
    buffer_load_dwordx4 v216, s[8:11], s48 offen  lds
    v_add_u32 v214, s33, v212
    v_add_u32 v215, s33, v213
    s_add_u32 m0, s47, 65536
    s_nop 0
    buffer_load_dwordx4 v217, s[8:11], s48 offen  lds
    v_add_u32 v246, s35, v212
    v_add_u32 v247, s35, v213
    s_add_u32 m0, s47, 69632
    s_nop 0
    buffer_load_dwordx4 v218, s[8:11], s48 offen  lds
    v_lshlrev_b32 v240, 2, v234
    s_add_u32 s48, s48, 82944
    s_add_u32 m0, s47, 73728
    s_nop 0
    buffer_load_dwordx4 v216, s[8:11], s48 offen  lds
    s_add_u32 m0, s47, 77824
    s_nop 0
    buffer_load_dwordx4 v217, s[8:11], s48 offen  lds
    s_add_u32 m0, s47, 81920
    s_nop 0
    buffer_load_dwordx4 v218, s[8:11], s48 offen  lds
    s_add_u32 s48, s48, 82944
    s_add_u32 m0, s47, 86016
    s_nop 0
    buffer_load_dwordx4 v216, s[8:11], s48 offen  lds
    s_add_u32 m0, s47, 90112
    s_nop 0
    buffer_load_dwordx4 v217, s[8:11], s48 offen  lds
    s_add_u32 m0, s47, 94208
    s_nop 0
    buffer_load_dwordx4 v218, s[8:11], s48 offen  lds
    s_branch L_fin_wj_1035
L_fin_wm_1034:
    v_and_b32 v234, 15, v222
    v_lshrrev_b32 v235, 4, v222
    v_mul_u32_u24 v224, 1152, v234
    v_lshlrev_b32 v236, 3, v235
    v_add_u32 v224, v224, v236
    v_lshrrev_b32 v236, 2, v234
    v_and_b32 v237, 3, v234
    v_mov_b32 v238, 0x3f80
    v_and_b32 v239, 1, v237
    v_lshlrev_b32 v239, 4, v239
    v_lshlrev_b32 v238, v239, v238
    v_cmp_eq_u32 vcc, v236, v235
    s_nop 1
    v_cndmask_b32 v238, 0, v238, vcc
    v_cmp_gt_u32 vcc, 2, v237
    s_nop 1
    v_cndmask_b32 v182, 0, v238, vcc
    v_sub_u32 v183, v238, v182
    v_mov_b32 v180, 0
    v_mov_b32 v181, 0
    v_mov_b32 v184, 0
    v_mov_b32 v185, 0
    v_lshrrev_b32 v236, 2, v222
    v_mul_u32_u24 v236, 192, v236
    v_and_b32 v237, 3, v222
    v_lshlrev_b32 v237, 3, v237
    v_add_u32 v236, v236, v237
    v_and_b32 v237, 1, v235
    v_lshlrev_b32 v237, 5, v237
    v_add_u32 v212, v236, v237
    v_sub_u32 v213, v236, v237
    v_add_u32 v213, 32, v213
    v_add_u32 v214, s33, v212
    v_add_u32 v215, s33, v213
    v_add_u32 v246, s35, v212
    v_add_u32 v247, s35, v213
    v_lshlrev_b32 v240, 2, v234
L_fin_wj_1035:
    s_add_u32 m0, s26, 0
    s_mul_i32 s48, s45, 192
    buffer_load_dwordx4 v219, s[8:11], s48 offen  lds
    s_add_u32 m0, s26, 4096
    s_nop 0
    buffer_load_dwordx4 v220, s[8:11], s48 offen  lds
    s_add_u32 m0, s26, 8192
    s_nop 0
    buffer_load_dwordx4 v221, s[8:11], s48 offen  lds
    buffer_load_dwordx2 v[168:169], v224, s[4:7], s41 offen offset:0
    buffer_load_dwordx2 v[170:171], v224, s[4:7], s41 offen offset:32
    buffer_load_dwordx2 v[172:173], v224, s[4:7], s41 offen offset:64
    buffer_load_dwordx2 v[174:175], v224, s[4:7], s41 offen offset:96
    buffer_load_dwordx2 v[176:177], v224, s[4:7], s41 offen offset:128
    buffer_load_dwordx2 v[178:179], v224, s[4:7], s41 offen offset:160
    s_cmp_lg_u32 s59, 0
    s_cbranch_scc1 L_fin_e_1026
    s_cmp_lg_u32 s37, 0
    s_cbranch_scc1 L_fin_pd_1031
    s_mov_b32 s55, 131072
    s_mov_b64 exec, 3
    buffer_load_dword v253, v249, s[20:23], 0 offen offset:128 sc1
    s_mov_b64 exec, -1
L_fin_pl_1029:
    s_waitcnt vmcnt(0)
    v_readlane_b32 s56, v253, 0
    v_readlane_b32 s28, v253, 1
    s_and_b32 s28, s28, s61
    s_cselect_b32 s29, 2, 0
    s_cmp_lg_u32 s56, 0
    s_cselect_b32 s31, 1, 0
    s_or_b32 s29, s29, s31
    s_cbranch_scc1 L_fin_px_1030
    s_mov_b32 s29, 3
    s_sub_u32 s55, s55, 1
    s_cmp_eq_u32 s55, 0
    s_cbranch_scc1 L_fin_px_1030
    s_sleep 1
    s_mov_b64 exec, 3
    buffer_load_dword v253, v249, s[20:23], 0 offen offset:128 sc1
    s_mov_b64 exec, -1
    s_branch L_fin_pl_1029
L_fin_px_1030:
    v_mov_b32 v250, s29
    ds_write_b32 v248, v250
    s_waitcnt lgkmcnt(0)
L_fin_pd_1031:
    s_barrier
    ds_read_b32 v250, v248
    s_waitcnt lgkmcnt(0)
    v_readfirstlane_b32 s29, v250
    s_and_b32 s31, s29, 1
    s_cbranch_scc1 L_fin_a_1027
    buffer_load_dwordx4 a[64:67], v223, s[12:15], s49 offen offset:0 sc1
    buffer_load_dwordx4 a[68:71], v223, s[12:15], s49 offen offset:1024 sc1
    buffer_load_dwordx4 a[72:75], v223, s[12:15], s49 offen offset:2048 sc1
    s_add_u32 s49, s49, 2359296
    buffer_load_dwordx4 a[76:79], v223, s[12:15], s49 offen offset:0 sc1
    buffer_load_dwordx4 a[80:83], v223, s[12:15], s49 offen offset:1024 sc1
    buffer_load_dwordx4 a[84:87], v223, s[12:15], s49 offen offset:2048 sc1
    s_add_u32 s49, s49, 2359296
    buffer_load_dwordx4 a[88:91], v223, s[12:15], s49 offen offset:0 sc1
    buffer_load_dwordx4 a[92:95], v223, s[12:15], s49 offen offset:1024 sc1
    buffer_load_dwordx4 a[96:99], v223, s[12:15], s49 offen offset:2048 sc1
    s_add_u32 s49, s49, 2359296
    buffer_load_dwordx4 a[100:103], v223, s[12:15], s49 offen offset:0 sc1
    buffer_load_dwordx4 a[104:107], v223, s[12:15], s49 offen offset:1024 sc1
    buffer_load_dwordx4 a[108:111], v223, s[12:15], s49 offen offset:2048 sc1
    s_add_u32 s49, s49, 2359296
    buffer_load_dwordx4 a[112:115], v223, s[12:15], s49 offen offset:0 sc1
    buffer_load_dwordx4 a[116:119], v223, s[12:15], s49 offen offset:1024 sc1
    buffer_load_dwordx4 a[120:123], v223, s[12:15], s49 offen offset:2048 sc1
    s_add_u32 s49, s49, 2359296
    buffer_load_dwordx4 a[124:127], v223, s[12:15], s49 offen offset:0 sc1
    buffer_load_dwordx4 a[128:131], v223, s[12:15], s49 offen offset:1024 sc1
    buffer_load_dwordx4 a[132:135], v223, s[12:15], s49 offen offset:2048 sc1
    s_add_u32 s49, s49, 2359296
    buffer_load_dwordx4 a[136:139], v223, s[12:15], s49 offen offset:0 sc1
    buffer_load_dwordx4 a[140:143], v223, s[12:15], s49 offen offset:1024 sc1
    buffer_load_dwordx4 a[144:147], v223, s[12:15], s49 offen offset:2048 sc1
    s_add_u32 s49, s49, 2359296
    buffer_load_dwordx4 a[148:151], v223, s[12:15], s49 offen offset:0 sc1
    buffer_load_dwordx4 a[152:155], v223, s[12:15], s49 offen offset:1024 sc1
    buffer_load_dwordx4 a[156:159], v223, s[12:15], s49 offen offset:2048 sc1
L_fin_e_1026:
    s_cmp_lg_u32 s37, 0
    s_cbranch_scc1 L_pi_1036
    s_mov_b64 exec, 1
    buffer_load_dword v253, off, s[20:23], s57 offset:128 sc1
    s_mov_b64 exec, -1
L_pi_1036:
    s_waitcnt vmcnt(0)
    v_mfma_f32_16x16x32_bf16 a[24:27], v[182:185], a[64:67], 0
    v_mfma_f32_16x16x32_bf16 a[28:31], v[180:183], a[64:67], 0
    v_mfma_f32_16x16x32_bf16 a[32:35], v[182:185], a[68:71], 0
    v_mfma_f32_16x16x32_bf16 a[36:39], v[180:183], a[68:71], 0
    v_mfma_f32_16x16x32_bf16 a[40:43], v[182:185], a[72:75], 0
    v_mfma_f32_16x16x32_bf16 a[44:47], v[180:183], a[72:75], 0
    v_mfma_f32_16x16x32_bf16 a[24:27], v[182:185], a[76:79], a[24:27]
    v_mfma_f32_16x16x32_bf16 a[28:31], v[180:183], a[76:79], a[28:31]
    v_mfma_f32_16x16x32_bf16 a[32:35], v[182:185], a[80:83], a[32:35]
    v_mfma_f32_16x16x32_bf16 a[36:39], v[180:183], a[80:83], a[36:39]
    v_mfma_f32_16x16x32_bf16 a[40:43], v[182:185], a[84:87], a[40:43]
    v_mfma_f32_16x16x32_bf16 a[44:47], v[180:183], a[84:87], a[44:47]
    v_mfma_f32_16x16x32_bf16 a[24:27], v[182:185], a[88:91], a[24:27]
    v_mfma_f32_16x16x32_bf16 a[28:31], v[180:183], a[88:91], a[28:31]
    v_mfma_f32_16x16x32_bf16 a[32:35], v[182:185], a[92:95], a[32:35]
    v_mfma_f32_16x16x32_bf16 a[36:39], v[180:183], a[92:95], a[36:39]
    v_mfma_f32_16x16x32_bf16 a[40:43], v[182:185], a[96:99], a[40:43]
    v_mfma_f32_16x16x32_bf16 a[44:47], v[180:183], a[96:99], a[44:47]
    v_mfma_f32_16x16x32_bf16 a[24:27], v[182:185], a[100:103], a[24:27]
    v_mfma_f32_16x16x32_bf16 a[28:31], v[180:183], a[100:103], a[28:31]
    v_mfma_f32_16x16x32_bf16 a[32:35], v[182:185], a[104:107], a[32:35]
    v_mfma_f32_16x16x32_bf16 a[36:39], v[180:183], a[104:107], a[36:39]
    v_mfma_f32_16x16x32_bf16 a[40:43], v[182:185], a[108:111], a[40:43]
    v_mfma_f32_16x16x32_bf16 a[44:47], v[180:183], a[108:111], a[44:47]
    v_mfma_f32_16x16x32_bf16 a[24:27], v[182:185], a[112:115], a[24:27]
    v_mfma_f32_16x16x32_bf16 a[28:31], v[180:183], a[112:115], a[28:31]
    v_mfma_f32_16x16x32_bf16 a[32:35], v[182:185], a[116:119], a[32:35]
    v_mfma_f32_16x16x32_bf16 a[36:39], v[180:183], a[116:119], a[36:39]
    v_mfma_f32_16x16x32_bf16 a[40:43], v[182:185], a[120:123], a[40:43]
    v_mfma_f32_16x16x32_bf16 a[44:47], v[180:183], a[120:123], a[44:47]
    v_mfma_f32_16x16x32_bf16 a[24:27], v[182:185], a[124:127], a[24:27]
    v_mfma_f32_16x16x32_bf16 a[28:31], v[180:183], a[124:127], a[28:31]
    v_mfma_f32_16x16x32_bf16 a[32:35], v[182:185], a[128:131], a[32:35]
    v_mfma_f32_16x16x32_bf16 a[36:39], v[180:183], a[128:131], a[36:39]
    v_mfma_f32_16x16x32_bf16 a[40:43], v[182:185], a[132:135], a[40:43]
    v_mfma_f32_16x16x32_bf16 a[44:47], v[180:183], a[132:135], a[44:47]
    v_mfma_f32_16x16x32_bf16 a[24:27], v[182:185], a[136:139], a[24:27]
    v_mfma_f32_16x16x32_bf16 a[28:31], v[180:183], a[136:139], a[28:31]
    v_mfma_f32_16x16x32_bf16 a[32:35], v[182:185], a[140:143], a[32:35]
    v_mfma_f32_16x16x32_bf16 a[36:39], v[180:183], a[140:143], a[36:39]
    v_mfma_f32_16x16x32_bf16 a[40:43], v[182:185], a[144:147], a[40:43]
    v_mfma_f32_16x16x32_bf16 a[44:47], v[180:183], a[144:147], a[44:47]
    v_mfma_f32_16x16x32_bf16 a[24:27], v[182:185], a[148:151], a[24:27]
    v_mfma_f32_16x16x32_bf16 a[28:31], v[180:183], a[148:151], a[28:31]
    v_mfma_f32_16x16x32_bf16 a[32:35], v[182:185], a[152:155], a[32:35]
    v_mfma_f32_16x16x32_bf16 a[36:39], v[180:183], a[152:155], a[36:39]
    v_mfma_f32_16x16x32_bf16 a[40:43], v[182:185], a[156:159], a[40:43]
    v_mfma_f32_16x16x32_bf16 a[44:47], v[180:183], a[156:159], a[44:47]
    s_cmp_lg_u32 s37, 0
    s_cbranch_scc1 L_pd_1038
    s_mov_b32 s55, 131072
L_pl_1037:
    s_waitcnt vmcnt(0)
L_pf_1039:
    v_readfirstlane_b32 s56, v253
    s_cmp_lg_u32 s56, 0
    s_cbranch_scc1 L_pd_1038
    s_sub_u32 s55, s55, 1
    s_cmp_eq_u32 s55, 0
    s_cbranch_scc1 L_pd_1038
    s_sleep 1
    s_mov_b64 exec, 1
    buffer_load_dword v253, off, s[20:23], s57 offset:128 sc1
    s_mov_b64 exec, -1
    s_branch L_pl_1037
L_pd_1038:
    s_barrier
    s_mov_b32 s26, 0
    s_mov_b32 s32, 2
    s_branch L_fin_go_1028
L_fin_a_1027:
    s_and_b32 s32, s29, 2
    s_cselect_b32 s26, 0x10000000, 0
    s_cselect_b32 s32, 0, 1
L_fin_go_1028:
    buffer_load_dwordx4 v[0:3], v223, s[12:15], s40 offen offset:0 sc1
    buffer_load_dwordx4 v[4:7], v223, s[12:15], s40 offen offset:1024 sc1
    buffer_load_dwordx4 v[8:11], v223, s[12:15], s40 offen offset:2048 sc1
    buffer_load_dwordx4 v[12:15], v223, s[12:15], s40 offen offset:3072 sc1
    s_add_u32 s40, s40, 4096
    buffer_load_dwordx4 v[16:19], v223, s[12:15], s40 offen offset:0 sc1
    buffer_load_dwordx4 v[20:23], v223, s[12:15], s40 offen offset:1024 sc1
    buffer_load_dwordx4 v[24:27], v223, s[12:15], s40 offen offset:2048 sc1
    buffer_load_dwordx4 v[28:31], v223, s[12:15], s40 offen offset:3072 sc1
    s_add_u32 s40, s40, 4096
    buffer_load_dwordx4 v[32:35], v223, s[12:15], s40 offen offset:0 sc1
    buffer_load_dwordx4 v[36:39], v223, s[12:15], s40 offen offset:1024 sc1
    buffer_load_dwordx4 v[40:43], v223, s[12:15], s40 offen offset:2048 sc1
    buffer_load_dwordx4 v[44:47], v223, s[12:15], s40 offen offset:3072 sc1
    s_add_u32 s40, s40, 4096
    buffer_load_dwordx4 v[48:51], v223, s[12:15], s40 offen offset:0 sc1
    buffer_load_dwordx4 v[52:55], v223, s[12:15], s40 offen offset:1024 sc1
    buffer_load_dwordx4 v[56:59], v223, s[12:15], s40 offen offset:2048 sc1
    buffer_load_dwordx4 v[60:63], v223, s[12:15], s40 offen offset:3072 sc1
    s_add_u32 s40, s40, 4096
    buffer_load_dwordx4 v[64:67], v223, s[12:15], s40 offen offset:0 sc1
    buffer_load_dwordx4 v[68:71], v223, s[12:15], s40 offen offset:1024 sc1
    buffer_load_dword v225, v240, s[12:15], s54 offen sc1
    s_waitcnt vmcnt(25)
    s_barrier
    ds_read_b64_tr_b16 v[188:189], v212 offset:0
    ds_read_b64_tr_b16 v[190:191], v212 offset:3072
    ds_read_b64_tr_b16 v[192:193], v213 offset:0
    ds_read_b64_tr_b16 v[194:195], v213 offset:3072
    ds_read_b64_tr_b16 v[196:197], v212 offset:64
    ds_read_b64_tr_b16 v[198:199], v212 offset:3136
    ds_read_b64_tr_b16 v[200:201], v213 offset:64
    ds_read_b64_tr_b16 v[202:203], v213 offset:3136
    ds_read_b64_tr_b16 v[204:205], v212 offset:128
    ds_read_b64_tr_b16 v[206:207], v212 offset:3200
    s_waitcnt vmcnt(17)
    s_waitcnt lgkmcnt(8)
    v_mfma_f32_16x16x32_bf16 a[0:3], v[188:191], v[0:3], 0
    ds_read_b64_tr_b16 v[208:209], v213 offset:128
    ds_read_b64_tr_b16 v[210:211], v213 offset:3200
    s_waitcnt lgkmcnt(8)
    v_mfma_f32_16x16x32_bf16 a[4:7], v[192:195], v[0:3], 0
    ds_read_b64_tr_b16 v[188:189], v212 offset:6144
    ds_read_b64_tr_b16 v[190:191], v212 offset:9216
    s_waitcnt lgkmcnt(8)
    v_mfma_f32_16x16x32_bf16 a[8:11], v[196:199], v[0:3], 0
    ds_read_b64_tr_b16 v[192:193], v213 offset:6144
    ds_read_b64_tr_b16 v[194:195], v213 offset:9216
    buffer_load_dwordx4 a[64:67], v223, s[24:27], s34 offen offset:0 sc1
    s_waitcnt lgkmcnt(8)
    v_mfma_f32_16x16x32_bf16 a[12:15], v[200:203], v[0:3], 0
    ds_read_b64_tr_b16 v[196:197], v212 offset:6208
    ds_read_b64_tr_b16 v[198:199], v212 offset:9280
    s_waitcnt lgkmcnt(8)
    v_mfma_f32_16x16x32_bf16 a[16:19], v[204:207], v[0:3], 0
    ds_read_b64_tr_b16 v[200:201], v213 offset:6208
    ds_read_b64_tr_b16 v[202:203], v213 offset:9280
    s_waitcnt lgkmcnt(8)
    v_mfma_f32_16x16x32_bf16 a[20:23], v[208:211], v[0:3], 0
    ds_read_b64_tr_b16 v[204:205], v212 offset:6272
    ds_read_b64_tr_b16 v[206:207], v212 offset:9344
    buffer_load_dwordx4 a[68:71], v223, s[24:27], s34 offen offset:1024 sc1
    s_waitcnt lgkmcnt(8)
    v_mfma_f32_16x16x32_bf16 a[0:3], v[188:191], v[4:7], a[0:3]
    ds_read_b64_tr_b16 v[208:209], v213 offset:6272
    ds_read_b64_tr_b16 v[210:211], v213 offset:9344
    s_waitcnt lgkmcnt(8)
    v_mfma_f32_16x16x32_bf16 a[4:7], v[192:195], v[4:7], a[4:7]
    ds_read_b64_tr_b16 v[188:189], v212 offset:12288
    ds_read_b64_tr_b16 v[190:191], v212 offset:15360
    s_waitcnt lgkmcnt(8)
    v_mfma_f32_16x16x32_bf16 a[8:11], v[196:199], v[4:7], a[8:11]
    ds_read_b64_tr_b16 v[192:193], v213 offset:12288
    ds_read_b64_tr_b16 v[194:195], v213 offset:15360
    buffer_load_dwordx4 a[72:75], v223, s[24:27], s34 offen offset:2048 sc1
    s_add_u32 s34, s34, 2359296
    s_waitcnt lgkmcnt(8)
    v_mfma_f32_16x16x32_bf16 a[12:15], v[200:203], v[4:7], a[12:15]
    ds_read_b64_tr_b16 v[196:197], v212 offset:12352
    ds_read_b64_tr_b16 v[198:199], v212 offset:15424
    s_waitcnt lgkmcnt(8)
    v_mfma_f32_16x16x32_bf16 a[16:19], v[204:207], v[4:7], a[16:19]
    ds_read_b64_tr_b16 v[200:201], v213 offset:12352
    ds_read_b64_tr_b16 v[202:203], v213 offset:15424
    s_waitcnt lgkmcnt(8)
    v_mfma_f32_16x16x32_bf16 a[20:23], v[208:211], v[4:7], a[20:23]
    ds_read_b64_tr_b16 v[204:205], v212 offset:12416
    ds_read_b64_tr_b16 v[206:207], v212 offset:15488
    buffer_load_dwordx4 a[76:79], v223, s[24:27], s34 offen offset:0 sc1
    s_waitcnt vmcnt(19)
    s_waitcnt lgkmcnt(8)
    v_mfma_f32_16x16x32_bf16 a[0:3], v[188:191], v[8:11], a[0:3]
    ds_read_b64_tr_b16 v[208:209], v213 offset:12416
    ds_read_b64_tr_b16 v[210:211], v213 offset:15488
    s_waitcnt lgkmcnt(8)
    v_mfma_f32_16x16x32_bf16 a[4:7], v[192:195], v[8:11], a[4:7]
    ds_read_b64_tr_b16 v[188:189], v212 offset:18432
    ds_read_b64_tr_b16 v[190:191], v212 offset:21504
    s_waitcnt lgkmcnt(8)
    v_mfma_f32_16x16x32_bf16 a[8:11], v[196:199], v[8:11], a[8:11]
    ds_read_b64_tr_b16 v[192:193], v213 offset:18432
    ds_read_b64_tr_b16 v[194:195], v213 offset:21504
    buffer_load_dwordx4 a[80:83], v223, s[24:27], s34 offen offset:1024 sc1
    s_waitcnt lgkmcnt(8)
    v_mfma_f32_16x16x32_bf16 a[12:15], v[200:203], v[8:11], a[12:15]
    ds_read_b64_tr_b16 v[196:197], v212 offset:18496
    ds_read_b64_tr_b16 v[198:199], v212 offset:21568
    s_waitcnt lgkmcnt(8)
    v_mfma_f32_16x16x32_bf16 a[16:19], v[204:207], v[8:11], a[16:19]
    ds_read_b64_tr_b16 v[200:201], v213 offset:18496
    ds_read_b64_tr_b16 v[202:203], v213 offset:21568
    s_waitcnt lgkmcnt(8)
    v_mfma_f32_16x16x32_bf16 a[20:23], v[208:211], v[8:11], a[20:23]
    ds_read_b64_tr_b16 v[204:205], v212 offset:18560
    ds_read_b64_tr_b16 v[206:207], v212 offset:21632
    buffer_load_dwordx4 a[84:87], v223, s[24:27], s34 offen offset:2048 sc1
    s_add_u32 s34, s34, 2359296
    s_waitcnt lgkmcnt(8)
    v_mfma_f32_16x16x32_bf16 a[0:3], v[188:191], v[12:15], a[0:3]
    ds_read_b64_tr_b16 v[208:209], v213 offset:18560
    ds_read_b64_tr_b16 v[210:211], v213 offset:21632
    s_waitcnt lgkmcnt(8)
    v_mfma_f32_16x16x32_bf16 a[4:7], v[192:195], v[12:15], a[4:7]
    ds_read_b64_tr_b16 v[188:189], v214 offset:0
    ds_read_b64_tr_b16 v[190:191], v214 offset:3072
    s_waitcnt lgkmcnt(8)
    v_mfma_f32_16x16x32_bf16 a[8:11], v[196:199], v[12:15], a[8:11]
    ds_read_b64_tr_b16 v[192:193], v215 offset:0
    ds_read_b64_tr_b16 v[194:195], v215 offset:3072
    buffer_load_dwordx4 a[88:91], v223, s[24:27], s34 offen offset:0 sc1
    s_waitcnt lgkmcnt(8)
    v_mfma_f32_16x16x32_bf16 a[12:15], v[200:203], v[12:15], a[12:15]
    ds_read_b64_tr_b16 v[196:197], v214 offset:64
    ds_read_b64_tr_b16 v[198:199], v214 offset:3136
    s_waitcnt lgkmcnt(8)
    v_mfma_f32_16x16x32_bf16 a[16:19], v[204:207], v[12:15], a[16:19]
    ds_read_b64_tr_b16 v[200:201], v215 offset:64
    ds_read_b64_tr_b16 v[202:203], v215 offset:3136
    s_waitcnt lgkmcnt(8)
    v_mfma_f32_16x16x32_bf16 a[20:23], v[208:211], v[12:15], a[20:23]
    ds_read_b64_tr_b16 v[204:205], v214 offset:128
    ds_read_b64_tr_b16 v[206:207], v214 offset:3200
    buffer_load_dwordx4 a[92:95], v223, s[24:27], s34 offen offset:1024 sc1
    s_waitcnt vmcnt(21)
    s_waitcnt lgkmcnt(8)
    v_mfma_f32_16x16x32_bf16 a[0:3], v[188:191], v[16:19], a[0:3]
    ds_read_b64_tr_b16 v[208:209], v215 offset:128
    ds_read_b64_tr_b16 v[210:211], v215 offset:3200
    s_waitcnt lgkmcnt(8)
    v_mfma_f32_16x16x32_bf16 a[4:7], v[192:195], v[16:19], a[4:7]
    ds_read_b64_tr_b16 v[188:189], v214 offset:6144
    ds_read_b64_tr_b16 v[190:191], v214 offset:9216
    s_waitcnt lgkmcnt(8)
    v_mfma_f32_16x16x32_bf16 a[8:11], v[196:199], v[16:19], a[8:11]
    ds_read_b64_tr_b16 v[192:193], v215 offset:6144
    ds_read_b64_tr_b16 v[194:195], v215 offset:9216
    buffer_load_dwordx4 a[96:99], v223, s[24:27], s34 offen offset:2048 sc1
    s_add_u32 s34, s34, 2359296
    s_waitcnt lgkmcnt(8)
    v_mfma_f32_16x16x32_bf16 a[12:15], v[200:203], v[16:19], a[12:15]
    ds_read_b64_tr_b16 v[196:197], v214 offset:6208
    ds_read_b64_tr_b16 v[198:199], v214 offset:9280
    s_waitcnt lgkmcnt(8)
    v_mfma_f32_16x16x32_bf16 a[16:19], v[204:207], v[16:19], a[16:19]
    ds_read_b64_tr_b16 v[200:201], v215 offset:6208
    ds_read_b64_tr_b16 v[202:203], v215 offset:9280
    s_waitcnt lgkmcnt(8)
    v_mfma_f32_16x16x32_bf16 a[20:23], v[208:211], v[16:19], a[20:23]
    ds_read_b64_tr_b16 v[204:205], v214 offset:6272
    ds_read_b64_tr_b16 v[206:207], v214 offset:9344
    buffer_load_dwordx4 a[100:103], v223, s[24:27], s34 offen offset:0 sc1
    s_waitcnt lgkmcnt(8)
    v_mfma_f32_16x16x32_bf16 a[0:3], v[188:191], v[20:23], a[0:3]
    ds_read_b64_tr_b16 v[208:209], v215 offset:6272
    ds_read_b64_tr_b16 v[210:211], v215 offset:9344
    s_waitcnt lgkmcnt(8)
    v_mfma_f32_16x16x32_bf16 a[4:7], v[192:195], v[20:23], a[4:7]
    ds_read_b64_tr_b16 v[188:189], v214 offset:12288
    ds_read_b64_tr_b16 v[190:191], v214 offset:15360
    s_waitcnt lgkmcnt(8)
    v_mfma_f32_16x16x32_bf16 a[8:11], v[196:199], v[20:23], a[8:11]
    ds_read_b64_tr_b16 v[192:193], v215 offset:12288
    ds_read_b64_tr_b16 v[194:195], v215 offset:15360
    buffer_load_dwordx4 a[104:107], v223, s[24:27], s34 offen offset:1024 sc1
    s_waitcnt lgkmcnt(8)
    v_mfma_f32_16x16x32_bf16 a[12:15], v[200:203], v[20:23], a[12:15]
    ds_read_b64_tr_b16 v[196:197], v214 offset:12352
    ds_read_b64_tr_b16 v[198:199], v214 offset:15424
    s_waitcnt lgkmcnt(8)
    v_mfma_f32_16x16x32_bf16 a[16:19], v[204:207], v[20:23], a[16:19]
    ds_read_b64_tr_b16 v[200:201], v215 offset:12352
    ds_read_b64_tr_b16 v[202:203], v215 offset:15424
    s_waitcnt lgkmcnt(8)
    v_mfma_f32_16x16x32_bf16 a[20:23], v[208:211], v[20:23], a[20:23]
    ds_read_b64_tr_b16 v[204:205], v214 offset:12416
    ds_read_b64_tr_b16 v[206:207], v214 offset:15488
    buffer_load_dwordx4 a[108:111], v223, s[24:27], s34 offen offset:2048 sc1
    s_add_u32 s34, s34, 2359296
    s_waitcnt vmcnt(23)
    s_waitcnt lgkmcnt(8)
    v_mfma_f32_16x16x32_bf16 a[0:3], v[188:191], v[24:27], a[0:3]
    ds_read_b64_tr_b16 v[208:209], v215 offset:12416
    ds_read_b64_tr_b16 v[210:211], v215 offset:15488
    s_waitcnt lgkmcnt(8)
    v_mfma_f32_16x16x32_bf16 a[4:7], v[192:195], v[24:27], a[4:7]
    ds_read_b64_tr_b16 v[188:189], v214 offset:18432
    ds_read_b64_tr_b16 v[190:191], v214 offset:21504
    s_waitcnt lgkmcnt(8)
    v_mfma_f32_16x16x32_bf16 a[8:11], v[196:199], v[24:27], a[8:11]
    ds_read_b64_tr_b16 v[192:193], v215 offset:18432
    ds_read_b64_tr_b16 v[194:195], v215 offset:21504
    buffer_load_dwordx4 a[112:115], v223, s[24:27], s34 offen offset:0 sc1
    s_waitcnt lgkmcnt(8)
    v_mfma_f32_16x16x32_bf16 a[12:15], v[200:203], v[24:27], a[12:15]
    ds_read_b64_tr_b16 v[196:197], v214 offset:18496
    ds_read_b64_tr_b16 v[198:199], v214 offset:21568
    s_waitcnt lgkmcnt(8)
    v_mfma_f32_16x16x32_bf16 a[16:19], v[204:207], v[24:27], a[16:19]
    ds_read_b64_tr_b16 v[200:201], v215 offset:18496
    ds_read_b64_tr_b16 v[202:203], v215 offset:21568
    s_waitcnt lgkmcnt(8)
    v_mfma_f32_16x16x32_bf16 a[20:23], v[208:211], v[24:27], a[20:23]
    ds_read_b64_tr_b16 v[204:205], v214 offset:18560
    ds_read_b64_tr_b16 v[206:207], v214 offset:21632
    buffer_load_dwordx4 a[116:119], v223, s[24:27], s34 offen offset:1024 sc1
    s_waitcnt lgkmcnt(8)
    v_mfma_f32_16x16x32_bf16 a[0:3], v[188:191], v[28:31], a[0:3]
    ds_read_b64_tr_b16 v[208:209], v215 offset:18560
    ds_read_b64_tr_b16 v[210:211], v215 offset:21632
    s_waitcnt lgkmcnt(8)
    v_mfma_f32_16x16x32_bf16 a[4:7], v[192:195], v[28:31], a[4:7]
    ds_read_b64_tr_b16 v[188:189], v214 offset:24576
    ds_read_b64_tr_b16 v[190:191], v214 offset:27648
    s_waitcnt lgkmcnt(8)
    v_mfma_f32_16x16x32_bf16 a[8:11], v[196:199], v[28:31], a[8:11]
    ds_read_b64_tr_b16 v[192:193], v215 offset:24576
    ds_read_b64_tr_b16 v[194:195], v215 offset:27648
    buffer_load_dwordx4 a[120:123], v223, s[24:27], s34 offen offset:2048 sc1
    s_add_u32 s34, s34, 2359296
    s_waitcnt lgkmcnt(8)
    v_mfma_f32_16x16x32_bf16 a[12:15], v[200:203], v[28:31], a[12:15]
    ds_read_b64_tr_b16 v[196:197], v214 offset:24640
    ds_read_b64_tr_b16 v[198:199], v214 offset:27712
    s_waitcnt lgkmcnt(8)
    v_mfma_f32_16x16x32_bf16 a[16:19], v[204:207], v[28:31], a[16:19]
    ds_read_b64_tr_b16 v[200:201], v215 offset:24640
    ds_read_b64_tr_b16 v[202:203], v215 offset:27712
    s_waitcnt lgkmcnt(8)
    v_mfma_f32_16x16x32_bf16 a[20:23], v[208:211], v[28:31], a[20:23]
    ds_read_b64_tr_b16 v[204:205], v214 offset:24704
    ds_read_b64_tr_b16 v[206:207], v214 offset:27776
    buffer_load_dwordx4 a[124:127], v223, s[24:27], s34 offen offset:0 sc1
    s_waitcnt vmcnt(25)
    s_waitcnt lgkmcnt(8)
    v_mfma_f32_16x16x32_bf16 a[0:3], v[188:191], v[32:35], a[0:3]
    ds_read_b64_tr_b16 v[208:209], v215 offset:24704
    ds_read_b64_tr_b16 v[210:211], v215 offset:27776
    s_waitcnt lgkmcnt(8)
    v_mfma_f32_16x16x32_bf16 a[4:7], v[192:195], v[32:35], a[4:7]
    ds_read_b64_tr_b16 v[188:189], v214 offset:30720
    ds_read_b64_tr_b16 v[190:191], v214 offset:33792
    s_waitcnt lgkmcnt(8)
    v_mfma_f32_16x16x32_bf16 a[8:11], v[196:199], v[32:35], a[8:11]
    ds_read_b64_tr_b16 v[192:193], v215 offset:30720
    ds_read_b64_tr_b16 v[194:195], v215 offset:33792
    buffer_load_dwordx4 a[128:131], v223, s[24:27], s34 offen offset:1024 sc1
    s_waitcnt lgkmcnt(8)
    v_mfma_f32_16x16x32_bf16 a[12:15], v[200:203], v[32:35], a[12:15]
    ds_read_b64_tr_b16 v[196:197], v214 offset:30784
    ds_read_b64_tr_b16 v[198:199], v214 offset:33856
    s_waitcnt lgkmcnt(8)
    v_mfma_f32_16x16x32_bf16 a[16:19], v[204:207], v[32:35], a[16:19]
    ds_read_b64_tr_b16 v[200:201], v215 offset:30784
    ds_read_b64_tr_b16 v[202:203], v215 offset:33856
    s_waitcnt lgkmcnt(8)
    v_mfma_f32_16x16x32_bf16 a[20:23], v[208:211], v[32:35], a[20:23]
    ds_read_b64_tr_b16 v[204:205], v214 offset:30848
    ds_read_b64_tr_b16 v[206:207], v214 offset:33920
    buffer_load_dwordx4 a[132:135], v223, s[24:27], s34 offen offset:2048 sc1
    s_add_u32 s34, s34, 2359296
    s_waitcnt lgkmcnt(8)
    v_mfma_f32_16x16x32_bf16 a[0:3], v[188:191], v[36:39], a[0:3]
    ds_read_b64_tr_b16 v[208:209], v215 offset:30848
    ds_read_b64_tr_b16 v[210:211], v215 offset:33920
    s_waitcnt lgkmcnt(8)
    v_mfma_f32_16x16x32_bf16 a[4:7], v[192:195], v[36:39], a[4:7]
    ds_read_b64_tr_b16 v[188:189], v214 offset:36864
    ds_read_b64_tr_b16 v[190:191], v214 offset:39936
    s_waitcnt lgkmcnt(8)
    v_mfma_f32_16x16x32_bf16 a[8:11], v[196:199], v[36:39], a[8:11]
    ds_read_b64_tr_b16 v[192:193], v215 offset:36864
    ds_read_b64_tr_b16 v[194:195], v215 offset:39936
    buffer_load_dwordx4 a[136:139], v223, s[24:27], s34 offen offset:0 sc1
    s_waitcnt lgkmcnt(8)
    v_mfma_f32_16x16x32_bf16 a[12:15], v[200:203], v[36:39], a[12:15]
    ds_read_b64_tr_b16 v[196:197], v214 offset:36928
    ds_read_b64_tr_b16 v[198:199], v214 offset:40000
    s_waitcnt lgkmcnt(8)
    v_mfma_f32_16x16x32_bf16 a[16:19], v[204:207], v[36:39], a[16:19]
    ds_read_b64_tr_b16 v[200:201], v215 offset:36928
    ds_read_b64_tr_b16 v[202:203], v215 offset:40000
    s_waitcnt lgkmcnt(8)
    v_mfma_f32_16x16x32_bf16 a[20:23], v[208:211], v[36:39], a[20:23]
    ds_read_b64_tr_b16 v[204:205], v214 offset:36992
    ds_read_b64_tr_b16 v[206:207], v214 offset:40064
    buffer_load_dwordx4 a[140:143], v223, s[24:27], s34 offen offset:1024 sc1
    s_waitcnt vmcnt(27)
    s_waitcnt lgkmcnt(8)
    v_mfma_f32_16x16x32_bf16 a[0:3], v[188:191], v[40:43], a[0:3]
    ds_read_b64_tr_b16 v[208:209], v215 offset:36992
    ds_read_b64_tr_b16 v[210:211], v215 offset:40064
    s_waitcnt lgkmcnt(8)
    v_mfma_f32_16x16x32_bf16 a[4:7], v[192:195], v[40:43], a[4:7]
    ds_read_b64_tr_b16 v[188:189], v214 offset:43008
    ds_read_b64_tr_b16 v[190:191], v214 offset:46080
    s_waitcnt lgkmcnt(8)
    v_mfma_f32_16x16x32_bf16 a[8:11], v[196:199], v[40:43], a[8:11]
    ds_read_b64_tr_b16 v[192:193], v215 offset:43008
    ds_read_b64_tr_b16 v[194:195], v215 offset:46080
    buffer_load_dwordx4 a[144:147], v223, s[24:27], s34 offen offset:2048 sc1
    s_add_u32 s34, s34, 2359296
    s_waitcnt lgkmcnt(8)
    v_mfma_f32_16x16x32_bf16 a[12:15], v[200:203], v[40:43], a[12:15]
    ds_read_b64_tr_b16 v[196:197], v214 offset:43072
    ds_read_b64_tr_b16 v[198:199], v214 offset:46144
    s_waitcnt lgkmcnt(8)
    v_mfma_f32_16x16x32_bf16 a[16:19], v[204:207], v[40:43], a[16:19]
    ds_read_b64_tr_b16 v[200:201], v215 offset:43072
    ds_read_b64_tr_b16 v[202:203], v215 offset:46144
    s_waitcnt lgkmcnt(8)
    v_mfma_f32_16x16x32_bf16 a[20:23], v[208:211], v[40:43], a[20:23]
    ds_read_b64_tr_b16 v[204:205], v214 offset:43136
    ds_read_b64_tr_b16 v[206:207], v214 offset:46208
    buffer_load_dwordx4 a[148:151], v223, s[24:27], s34 offen offset:0 sc1
    s_waitcnt lgkmcnt(8)
    v_mfma_f32_16x16x32_bf16 a[0:3], v[188:191], v[44:47], a[0:3]
    ds_read_b64_tr_b16 v[208:209], v215 offset:43136
    ds_read_b64_tr_b16 v[210:211], v215 offset:46208
    s_waitcnt lgkmcnt(8)
    v_mfma_f32_16x16x32_bf16 a[4:7], v[192:195], v[44:47], a[4:7]
    ds_read_b64_tr_b16 v[188:189], v214 offset:49152
    ds_read_b64_tr_b16 v[190:191], v214 offset:52224
    s_waitcnt lgkmcnt(8)
    v_mfma_f32_16x16x32_bf16 a[8:11], v[196:199], v[44:47], a[8:11]
    ds_read_b64_tr_b16 v[192:193], v215 offset:49152
    ds_read_b64_tr_b16 v[194:195], v215 offset:52224
    buffer_load_dwordx4 a[152:155], v223, s[24:27], s34 offen offset:1024 sc1
    s_waitcnt lgkmcnt(8)
    v_mfma_f32_16x16x32_bf16 a[12:15], v[200:203], v[44:47], a[12:15]
    ds_read_b64_tr_b16 v[196:197], v214 offset:49216
    ds_read_b64_tr_b16 v[198:199], v214 offset:52288
    s_waitcnt lgkmcnt(8)
    v_mfma_f32_16x16x32_bf16 a[16:19], v[204:207], v[44:47], a[16:19]
    ds_read_b64_tr_b16 v[200:201], v215 offset:49216
    ds_read_b64_tr_b16 v[202:203], v215 offset:52288
    s_waitcnt lgkmcnt(8)
    v_mfma_f32_16x16x32_bf16 a[20:23], v[208:211], v[44:47], a[20:23]
    ds_read_b64_tr_b16 v[204:205], v214 offset:49280
    ds_read_b64_tr_b16 v[206:207], v214 offset:52352
    buffer_load_dwordx4 a[156:159], v223, s[24:27], s34 offen offset:2048 sc1
    s_waitcnt vmcnt(29)
    s_waitcnt lgkmcnt(8)
    v_mfma_f32_16x16x32_bf16 a[0:3], v[188:191], v[48:51], a[0:3]
    ds_read_b64_tr_b16 v[208:209], v215 offset:49280
    ds_read_b64_tr_b16 v[210:211], v215 offset:52352
    s_waitcnt lgkmcnt(8)
    v_mfma_f32_16x16x32_bf16 a[4:7], v[192:195], v[48:51], a[4:7]
    ds_read_b64_tr_b16 v[188:189], v214 offset:55296
    ds_read_b64_tr_b16 v[190:191], v214 offset:58368
    s_waitcnt lgkmcnt(8)
    v_mfma_f32_16x16x32_bf16 a[8:11], v[196:199], v[48:51], a[8:11]
    ds_read_b64_tr_b16 v[192:193], v215 offset:55296
    ds_read_b64_tr_b16 v[194:195], v215 offset:58368
    s_waitcnt lgkmcnt(8)
    v_mfma_f32_16x16x32_bf16 a[12:15], v[200:203], v[48:51], a[12:15]
    ds_read_b64_tr_b16 v[196:197], v214 offset:55360
    ds_read_b64_tr_b16 v[198:199], v214 offset:58432
    s_waitcnt lgkmcnt(8)
    v_mfma_f32_16x16x32_bf16 a[16:19], v[204:207], v[48:51], a[16:19]
    ds_read_b64_tr_b16 v[200:201], v215 offset:55360
    ds_read_b64_tr_b16 v[202:203], v215 offset:58432
    s_waitcnt lgkmcnt(8)
    v_mfma_f32_16x16x32_bf16 a[20:23], v[208:211], v[48:51], a[20:23]
    ds_read_b64_tr_b16 v[204:205], v214 offset:55424
    ds_read_b64_tr_b16 v[206:207], v214 offset:58496
    s_waitcnt lgkmcnt(8)
    v_mfma_f32_16x16x32_bf16 a[0:3], v[188:191], v[52:55], a[0:3]
    ds_read_b64_tr_b16 v[208:209], v215 offset:55424
    ds_read_b64_tr_b16 v[210:211], v215 offset:58496
    s_waitcnt lgkmcnt(8)
    v_mfma_f32_16x16x32_bf16 a[4:7], v[192:195], v[52:55], a[4:7]
    ds_read_b64_tr_b16 v[188:189], v246 offset:0
    ds_read_b64_tr_b16 v[190:191], v246 offset:3072
    s_waitcnt lgkmcnt(8)
    v_mfma_f32_16x16x32_bf16 a[8:11], v[196:199], v[52:55], a[8:11]
    ds_read_b64_tr_b16 v[192:193], v247 offset:0
    ds_read_b64_tr_b16 v[194:195], v247 offset:3072
    s_waitcnt lgkmcnt(8)
    v_mfma_f32_16x16x32_bf16 a[12:15], v[200:203], v[52:55], a[12:15]
    ds_read_b64_tr_b16 v[196:197], v246 offset:64
    ds_read_b64_tr_b16 v[198:199], v246 offset:3136
    s_waitcnt lgkmcnt(8)
    v_mfma_f32_16x16x32_bf16 a[16:19], v[204:207], v[52:55], a[16:19]
    ds_read_b64_tr_b16 v[200:201], v247 offset:64
    ds_read_b64_tr_b16 v[202:203], v247 offset:3136
    s_waitcnt lgkmcnt(8)
    v_mfma_f32_16x16x32_bf16 a[20:23], v[208:211], v[52:55], a[20:23]
    ds_read_b64_tr_b16 v[204:205], v246 offset:128
    ds_read_b64_tr_b16 v[206:207], v246 offset:3200
    s_waitcnt vmcnt(27)
    s_waitcnt lgkmcnt(8)
    v_mfma_f32_16x16x32_bf16 a[0:3], v[188:191], v[56:59], a[0:3]
    ds_read_b64_tr_b16 v[208:209], v247 offset:128
    ds_read_b64_tr_b16 v[210:211], v247 offset:3200
    s_waitcnt lgkmcnt(8)
    v_mfma_f32_16x16x32_bf16 a[4:7], v[192:195], v[56:59], a[4:7]
    ds_read_b64_tr_b16 v[188:189], v246 offset:6144
    ds_read_b64_tr_b16 v[190:191], v246 offset:9216
    s_waitcnt lgkmcnt(8)
    v_mfma_f32_16x16x32_bf16 a[8:11], v[196:199], v[56:59], a[8:11]
    ds_read_b64_tr_b16 v[192:193], v247 offset:6144
    ds_read_b64_tr_b16 v[194:195], v247 offset:9216
    s_waitcnt lgkmcnt(8)
    v_mfma_f32_16x16x32_bf16 a[12:15], v[200:203], v[56:59], a[12:15]
    ds_read_b64_tr_b16 v[196:197], v246 offset:6208
    ds_read_b64_tr_b16 v[198:199], v246 offset:9280
    s_waitcnt lgkmcnt(8)
    v_mfma_f32_16x16x32_bf16 a[16:19], v[204:207], v[56:59], a[16:19]
    ds_read_b64_tr_b16 v[200:201], v247 offset:6208
    ds_read_b64_tr_b16 v[202:203], v247 offset:9280
    s_waitcnt lgkmcnt(8)
    v_mfma_f32_16x16x32_bf16 a[20:23], v[208:211], v[56:59], a[20:23]
    ds_read_b64_tr_b16 v[204:205], v246 offset:6272
    ds_read_b64_tr_b16 v[206:207], v246 offset:9344
    s_waitcnt lgkmcnt(8)
    v_mfma_f32_16x16x32_bf16 a[0:3], v[188:191], v[60:63], a[0:3]
    ds_read_b64_tr_b16 v[208:209], v247 offset:6272
    ds_read_b64_tr_b16 v[210:211], v247 offset:9344
    s_waitcnt lgkmcnt(8)
    v_mfma_f32_16x16x32_bf16 a[4:7], v[192:195], v[60:63], a[4:7]
    ds_read_b64_tr_b16 v[188:189], v246 offset:12288
    ds_read_b64_tr_b16 v[190:191], v246 offset:15360
    s_waitcnt lgkmcnt(8)
    v_mfma_f32_16x16x32_bf16 a[8:11], v[196:199], v[60:63], a[8:11]
    ds_read_b64_tr_b16 v[192:193], v247 offset:12288
    ds_read_b64_tr_b16 v[194:195], v247 offset:15360
    s_waitcnt lgkmcnt(8)
    v_mfma_f32_16x16x32_bf16 a[12:15], v[200:203], v[60:63], a[12:15]
    ds_read_b64_tr_b16 v[196:197], v246 offset:12352
    ds_read_b64_tr_b16 v[198:199], v246 offset:15424
    s_waitcnt lgkmcnt(8)
    v_mfma_f32_16x16x32_bf16 a[16:19], v[204:207], v[60:63], a[16:19]
    ds_read_b64_tr_b16 v[200:201], v247 offset:12352
    ds_read_b64_tr_b16 v[202:203], v247 offset:15424
    s_waitcnt lgkmcnt(8)
    v_mfma_f32_16x16x32_bf16 a[20:23], v[208:211], v[60:63], a[20:23]
    ds_read_b64_tr_b16 v[204:205], v246 offset:12416
    ds_read_b64_tr_b16 v[206:207], v246 offset:15488
    s_waitcnt vmcnt(25)
    s_waitcnt lgkmcnt(8)
    v_mfma_f32_16x16x32_bf16 a[0:3], v[188:191], v[64:67], a[0:3]
    ds_read_b64_tr_b16 v[208:209], v247 offset:12416
    ds_read_b64_tr_b16 v[210:211], v247 offset:15488
    s_waitcnt lgkmcnt(8)
    v_mfma_f32_16x16x32_bf16 a[4:7], v[192:195], v[64:67], a[4:7]
    ds_read_b64_tr_b16 v[188:189], v246 offset:18432
    ds_read_b64_tr_b16 v[190:191], v246 offset:21504
    s_waitcnt lgkmcnt(8)
    v_mfma_f32_16x16x32_bf16 a[8:11], v[196:199], v[64:67], a[8:11]
    ds_read_b64_tr_b16 v[192:193], v247 offset:18432
    ds_read_b64_tr_b16 v[194:195], v247 offset:21504
    s_waitcnt lgkmcnt(8)
    v_mfma_f32_16x16x32_bf16 a[12:15], v[200:203], v[64:67], a[12:15]
    ds_read_b64_tr_b16 v[196:197], v246 offset:18496
    ds_read_b64_tr_b16 v[198:199], v246 offset:21568
    s_waitcnt lgkmcnt(8)
    v_mfma_f32_16x16x32_bf16 a[16:19], v[204:207], v[64:67], a[16:19]
    ds_read_b64_tr_b16 v[200:201], v247 offset:18496
    ds_read_b64_tr_b16 v[202:203], v247 offset:21568
    s_waitcnt lgkmcnt(8)
    v_mfma_f32_16x16x32_bf16 a[20:23], v[208:211], v[64:67], a[20:23]
    ds_read_b64_tr_b16 v[204:205], v246 offset:18560
    ds_read_b64_tr_b16 v[206:207], v246 offset:21632
    s_waitcnt lgkmcnt(8)
    v_mfma_f32_16x16x32_bf16 a[0:3], v[188:191], v[68:71], a[0:3]
    ds_read_b64_tr_b16 v[208:209], v247 offset:18560
    ds_read_b64_tr_b16 v[210:211], v247 offset:21632
    s_waitcnt lgkmcnt(8)
    v_mfma_f32_16x16x32_bf16 a[4:7], v[192:195], v[68:71], a[4:7]
    s_waitcnt lgkmcnt(6)
    v_mfma_f32_16x16x32_bf16 a[8:11], v[196:199], v[68:71], a[8:11]
    s_waitcnt lgkmcnt(4)
    v_mfma_f32_16x16x32_bf16 a[12:15], v[200:203], v[68:71], a[12:15]
    s_waitcnt lgkmcnt(2)
    v_mfma_f32_16x16x32_bf16 a[16:19], v[204:207], v[68:71], a[16:19]
    s_waitcnt lgkmcnt(0)
    v_mfma_f32_16x16x32_bf16 a[20:23], v[208:211], v[68:71], a[20:23]
    s_cmp_eq_u32 s32, 2
    s_cbranch_scc1 L_fin_s_1033
    s_cmp_eq_u32 s32, 0
    s_cbranch_scc1 L_fin_q_1032
    s_cmp_lg_u32 s37, 0
    s_cbranch_scc1 L_pi_1040
    s_mov_b64 exec, 1
    buffer_load_dword v253, off, s[20:23], s53 offset:128 sc1
    s_mov_b64 exec, -1
L_pi_1040:
    s_cmp_lg_u32 s37, 0
    s_cbranch_scc1 L_pd_1042
    s_mov_b32 s55, 131072
L_pl_1041:
    s_waitcnt vmcnt(0)
L_pf_1043:
    v_readfirstlane_b32 s56, v253
    s_and_b32 s56, s56, s61
    s_cbranch_scc1 L_pd_1042
    s_sub_u32 s55, s55, 1
    s_cmp_eq_u32 s55, 0
    s_cbranch_scc1 L_pd_1042
    s_sleep 1
    s_mov_b64 exec, 1
    buffer_load_dword v253, off, s[20:23], s53 offset:128 sc1
    s_mov_b64 exec, -1
    s_branch L_pl_1041
L_pd_1042:
    s_barrier
    buffer_load_dwordx4 a[64:67], v223, s[12:15], s49 offen offset:0 sc1
    buffer_load_dwordx4 a[68:71], v223, s[12:15], s49 offen offset:1024 sc1
    buffer_load_dwordx4 a[72:75], v223, s[12:15], s49 offen offset:2048 sc1
    s_add_u32 s49, s49, 2359296
    buffer_load_dwordx4 a[76:79], v223, s[12:15], s49 offen offset:0 sc1
    buffer_load_dwordx4 a[80:83], v223, s[12:15], s49 offen offset:1024 sc1
    buffer_load_dwordx4 a[84:87], v223, s[12:15], s49 offen offset:2048 sc1
    s_add_u32 s49, s49, 2359296
    buffer_load_dwordx4 a[88:91], v223, s[12:15], s49 offen offset:0 sc1
    buffer_load_dwordx4 a[92:95], v223, s[12:15], s49 offen offset:1024 sc1
    buffer_load_dwordx4 a[96:99], v223, s[12:15], s49 offen offset:2048 sc1
    s_add_u32 s49, s49, 2359296
    buffer_load_dwordx4 a[100:103], v223, s[12:15], s49 offen offset:0 sc1
    buffer_load_dwordx4 a[104:107], v223, s[12:15], s49 offen offset:1024 sc1
    buffer_load_dwordx4 a[108:111], v223, s[12:15], s49 offen offset:2048 sc1
    s_add_u32 s49, s49, 2359296
    buffer_load_dwordx4 a[112:115], v223, s[12:15], s49 offen offset:0 sc1
    buffer_load_dwordx4 a[116:119], v223, s[12:15], s49 offen offset:1024 sc1
    buffer_load_dwordx4 a[120:123], v223, s[12:15], s49 offen offset:2048 sc1
    s_add_u32 s49, s49, 2359296
    buffer_load_dwordx4 a[124:127], v223, s[12:15], s49 offen offset:0 sc1
    buffer_load_dwordx4 a[128:131], v223, s[12:15], s49 offen offset:1024 sc1
    buffer_load_dwordx4 a[132:135], v223, s[12:15], s49 offen offset:2048 sc1
    s_add_u32 s49, s49, 2359296
    buffer_load_dwordx4 a[136:139], v223, s[12:15], s49 offen offset:0 sc1
    buffer_load_dwordx4 a[140:143], v223, s[12:15], s49 offen offset:1024 sc1
    buffer_load_dwordx4 a[144:147], v223, s[12:15], s49 offen offset:2048 sc1
    s_add_u32 s49, s49, 2359296
    buffer_load_dwordx4 a[148:151], v223, s[12:15], s49 offen offset:0 sc1
    buffer_load_dwordx4 a[152:155], v223, s[12:15], s49 offen offset:1024 sc1
    buffer_load_dwordx4 a[156:159], v223, s[12:15], s49 offen offset:2048 sc1
L_fin_q_1032:
    s_waitcnt vmcnt(21)
    v_mfma_f32_16x16x32_bf16 a[24:27], v[182:185], a[64:67], 0
    v_mfma_f32_16x16x32_bf16 a[28:31], v[180:183], a[64:67], 0
    v_mfma_f32_16x16x32_bf16 a[32:35], v[182:185], a[68:71], 0
    v_mfma_f32_16x16x32_bf16 a[36:39], v[180:183], a[68:71], 0
    v_mfma_f32_16x16x32_bf16 a[40:43], v[182:185], a[72:75], 0
    v_mfma_f32_16x16x32_bf16 a[44:47], v[180:183], a[72:75], 0
    s_waitcnt vmcnt(18)
    v_mfma_f32_16x16x32_bf16 a[24:27], v[182:185], a[76:79], a[24:27]
    v_mfma_f32_16x16x32_bf16 a[28:31], v[180:183], a[76:79], a[28:31]
    v_mfma_f32_16x16x32_bf16 a[32:35], v[182:185], a[80:83], a[32:35]
    v_mfma_f32_16x16x32_bf16 a[36:39], v[180:183], a[80:83], a[36:39]
    v_mfma_f32_16x16x32_bf16 a[40:43], v[182:185], a[84:87], a[40:43]
    v_mfma_f32_16x16x32_bf16 a[44:47], v[180:183], a[84:87], a[44:47]
    s_waitcnt vmcnt(15)
    v_mfma_f32_16x16x32_bf16 a[24:27], v[182:185], a[88:91], a[24:27]
    v_mfma_f32_16x16x32_bf16 a[28:31], v[180:183], a[88:91], a[28:31]
    v_mfma_f32_16x16x32_bf16 a[32:35], v[182:185], a[92:95], a[32:35]
    v_mfma_f32_16x16x32_bf16 a[36:39], v[180:183], a[92:95], a[36:39]
    v_mfma_f32_16x16x32_bf16 a[40:43], v[182:185], a[96:99], a[40:43]
    v_mfma_f32_16x16x32_bf16 a[44:47], v[180:183], a[96:99], a[44:47]
    s_waitcnt vmcnt(12)
    v_mfma_f32_16x16x32_bf16 a[24:27], v[182:185], a[100:103], a[24:27]
    v_mfma_f32_16x16x32_bf16 a[28:31], v[180:183], a[100:103], a[28:31]
    v_mfma_f32_16x16x32_bf16 a[32:35], v[182:185], a[104:107], a[32:35]
    v_mfma_f32_16x16x32_bf16 a[36:39], v[180:183], a[104:107], a[36:39]
    v_mfma_f32_16x16x32_bf16 a[40:43], v[182:185], a[108:111], a[40:43]
    v_mfma_f32_16x16x32_bf16 a[44:47], v[180:183], a[108:111], a[44:47]
    s_waitcnt vmcnt(9)
    v_mfma_f32_16x16x32_bf16 a[24:27], v[182:185], a[112:115], a[24:27]
    v_mfma_f32_16x16x32_bf16 a[28:31], v[180:183], a[112:115], a[28:31]
    v_mfma_f32_16x16x32_bf16 a[32:35], v[182:185], a[116:119], a[32:35]
    v_mfma_f32_16x16x32_bf16 a[36:39], v[180:183], a[116:119], a[36:39]
    v_mfma_f32_16x16x32_bf16 a[40:43], v[182:185], a[120:123], a[40:43]
    v_mfma_f32_16x16x32_bf16 a[44:47], v[180:183], a[120:123], a[44:47]
    s_waitcnt vmcnt(6)
    v_mfma_f32_16x16x32_bf16 a[24:27], v[182:185], a[124:127], a[24:27]
    v_mfma_f32_16x16x32_bf16 a[28:31], v[180:183], a[124:127], a[28:31]
    v_mfma_f32_16x16x32_bf16 a[32:35], v[182:185], a[128:131], a[32:35]
    v_mfma_f32_16x16x32_bf16 a[36:39], v[180:183], a[128:131], a[36:39]
    v_mfma_f32_16x16x32_bf16 a[40:43], v[182:185], a[132:135], a[40:43]
    v_mfma_f32_16x16x32_bf16 a[44:47], v[180:183], a[132:135], a[44:47]
    s_waitcnt vmcnt(3)
    v_mfma_f32_16x16x32_bf16 a[24:27], v[182:185], a[136:139], a[24:27]
    v_mfma_f32_16x16x32_bf16 a[28:31], v[180:183], a[136:139], a[28:31]
    v_mfma_f32_16x16x32_bf16 a[32:35], v[182:185], a[140:143], a[32:35]
    v_mfma_f32_16x16x32_bf16 a[36:39], v[180:183], a[140:143], a[36:39]
    v_mfma_f32_16x16x32_bf16 a[40:43], v[182:185], a[144:147], a[40:43]
    v_mfma_f32_16x16x32_bf16 a[44:47], v[180:183], a[144:147], a[44:47]
    s_waitcnt vmcnt(0)
    v_mfma_f32_16x16x32_bf16 a[24:27], v[182:185], a[148:151], a[24:27]
    v_mfma_f32_16x16x32_bf16 a[28:31], v[180:183], a[148:151], a[28:31]
    v_mfma_f32_16x16x32_bf16 a[32:35], v[182:185], a[152:155], a[32:35]
    v_mfma_f32_16x16x32_bf16 a[36:39], v[180:183], a[152:155], a[36:39]
    v_mfma_f32_16x16x32_bf16 a[40:43], v[182:185], a[156:159], a[40:43]
    v_mfma_f32_16x16x32_bf16 a[44:47], v[180:183], a[156:159], a[44:47]
L_fin_s_1033:
    s_waitcnt vmcnt(0)
    s_mov_b32 s42, 0xbfb8aa3b
    v_mov_b32 v2, s42
    v_mov_b32 v3, s42
    v_mov_b32 v72, 1.0
    v_mov_b32 v73, 1.0
    v_accvgpr_read_b32 v4, a24
    v_accvgpr_read_b32 v5, a25
    v_accvgpr_read_b32 v6, a26
    v_accvgpr_read_b32 v7, a27
    v_accvgpr_read_b32 v8, a0
    v_accvgpr_read_b32 v9, a1
    v_accvgpr_read_b32 v10, a2
    v_accvgpr_read_b32 v11, a3
    v_pk_mul_f32 v[4:5], v[224:225], v[4:5] op_sel:[1,0] op_sel_hi:[1,1]
    v_pk_mul_f32 v[6:7], v[224:225], v[6:7] op_sel:[1,0] op_sel_hi:[1,1]
    v_pk_mul_f32 v[12:13], v[2:3], v[4:5]
    v_pk_mul_f32 v[14:15], v[2:3], v[6:7]
    v_exp_f32 v12, v12
    v_exp_f32 v13, v13
    v_exp_f32 v14, v14
    v_exp_f32 v15, v15
    v_pk_add_f32 v[12:13], v[72:73], v[12:13]
    v_pk_add_f32 v[14:15], v[72:73], v[14:15]
    v_rcp_f32 v12, v12
    v_rcp_f32 v13, v13
    v_rcp_f32 v14, v14
    v_rcp_f32 v15, v15
    v_pk_mul_f32 v[4:5], v[4:5], v[8:9]
    v_pk_mul_f32 v[6:7], v[6:7], v[10:11]
    v_lshlrev_b32 v16, 16, v168
    v_and_b32 v17, 0xffff0000, v168
    v_lshlrev_b32 v18, 16, v169
    v_and_b32 v19, 0xffff0000, v169
    v_pk_fma_f32 v[4:5], v[4:5], v[12:13], v[16:17]
    v_pk_fma_f32 v[6:7], v[6:7], v[14:15], v[18:19]
    v_cvt_pk_bf16_f32 v8, v4, v5
    v_cvt_pk_bf16_f32 v9, v6, v7
    buffer_store_dwordx2 v[8:9], v224, s[16:19], s41 offen offset:0
    v_accvgpr_read_b32 v20, a28
    v_accvgpr_read_b32 v21, a29
    v_accvgpr_read_b32 v22, a30
    v_accvgpr_read_b32 v23, a31
    v_accvgpr_read_b32 v24, a4
    v_accvgpr_read_b32 v25, a5
    v_accvgpr_read_b32 v26, a6
    v_accvgpr_read_b32 v27, a7
    v_pk_mul_f32 v[20:21], v[224:225], v[20:21] op_sel:[1,0] op_sel_hi:[1,1]
    v_pk_mul_f32 v[22:23], v[224:225], v[22:23] op_sel:[1,0] op_sel_hi:[1,1]
    v_pk_mul_f32 v[28:29], v[2:3], v[20:21]
    v_pk_mul_f32 v[30:31], v[2:3], v[22:23]
    v_exp_f32 v28, v28
    v_exp_f32 v29, v29
    v_exp_f32 v30, v30
    v_exp_f32 v31, v31
    v_pk_add_f32 v[28:29], v[72:73], v[28:29]
    v_pk_add_f32 v[30:31], v[72:73], v[30:31]
    v_rcp_f32 v28, v28
    v_rcp_f32 v29, v29
    v_rcp_f32 v30, v30
    v_rcp_f32 v31, v31
    v_pk_mul_f32 v[20:21], v[20:21], v[24:25]
    v_pk_mul_f32 v[22:23], v[22:23], v[26:27]
    v_lshlrev_b32 v32, 16, v170
    v_and_b32 v33, 0xffff0000, v170
    v_lshlrev_b32 v34, 16, v171
    v_and_b32 v35, 0xffff0000, v171
    v_pk_fma_f32 v[20:21], v[20:21], v[28:29], v[32:33]
    v_pk_fma_f32 v[22:23], v[22:23], v[30:31], v[34:35]
    v_cvt_pk_bf16_f32 v24, v20, v21
    v_cvt_pk_bf16_f32 v25, v22, v23
    buffer_store_dwordx2 v[24:25], v224, s[16:19], s41 offen offset:32
    v_accvgpr_read_b32 v36, a32
    v_accvgpr_read_b32 v37, a33
    v_accvgpr_read_b32 v38, a34
    v_accvgpr_read_b32 v39, a35
    v_accvgpr_read_b32 v40, a8
    v_accvgpr_read_b32 v41, a9
    v_accvgpr_read_b32 v42, a10
    v_accvgpr_read_b32 v43, a11
    v_pk_mul_f32 v[36:37], v[224:225], v[36:37] op_sel:[1,0] op_sel_hi:[1,1]
    v_pk_mul_f32 v[38:39], v[224:225], v[38:39] op_sel:[1,0] op_sel_hi:[1,1]
    v_pk_mul_f32 v[44:45], v[2:3], v[36:37]
    v_pk_mul_f32 v[46:47], v[2:3], v[38:39]
    v_exp_f32 v44, v44
    v_exp_f32 v45, v45
    v_exp_f32 v46, v46
    v_exp_f32 v47, v47
    v_pk_add_f32 v[44:45], v[72:73], v[44:45]
    v_pk_add_f32 v[46:47], v[72:73], v[46:47]
    v_rcp_f32 v44, v44
    v_rcp_f32 v45, v45
    v_rcp_f32 v46, v46
    v_rcp_f32 v47, v47
    v_pk_mul_f32 v[36:37], v[36:37], v[40:41]
    v_pk_mul_f32 v[38:39], v[38:39], v[42:43]
    v_lshlrev_b32 v48, 16, v172
    v_and_b32 v49, 0xffff0000, v172
    v_lshlrev_b32 v50, 16, v173
    v_and_b32 v51, 0xffff0000, v173
    v_pk_fma_f32 v[36:37], v[36:37], v[44:45], v[48:49]
    v_pk_fma_f32 v[38:39], v[38:39], v[46:47], v[50:51]
    v_cvt_pk_bf16_f32 v40, v36, v37
    v_cvt_pk_bf16_f32 v41, v38, v39
    buffer_store_dwordx2 v[40:41], v224, s[16:19], s41 offen offset:64
    v_accvgpr_read_b32 v52, a36
    v_accvgpr_read_b32 v53, a37
    v_accvgpr_read_b32 v54, a38
    v_accvgpr_read_b32 v55, a39
    v_accvgpr_read_b32 v56, a12
    v_accvgpr_read_b32 v57, a13
    v_accvgpr_read_b32 v58, a14
    v_accvgpr_read_b32 v59, a15
    v_pk_mul_f32 v[52:53], v[224:225], v[52:53] op_sel:[1,0] op_sel_hi:[1,1]
    v_pk_mul_f32 v[54:55], v[224:225], v[54:55] op_sel:[1,0] op_sel_hi:[1,1]
    v_pk_mul_f32 v[60:61], v[2:3], v[52:53]
    v_pk_mul_f32 v[62:63], v[2:3], v[54:55]
    v_exp_f32 v60, v60
    v_exp_f32 v61, v61
    v_exp_f32 v62, v62
    v_exp_f32 v63, v63
    v_pk_add_f32 v[60:61], v[72:73], v[60:61]
    v_pk_add_f32 v[62:63], v[72:73], v[62:63]
    v_rcp_f32 v60, v60
    v_rcp_f32 v61, v61
    v_rcp_f32 v62, v62
    v_rcp_f32 v63, v63
    v_pk_mul_f32 v[52:53], v[52:53], v[56:57]
    v_pk_mul_f32 v[54:55], v[54:55], v[58:59]
    v_lshlrev_b32 v64, 16, v174
    v_and_b32 v65, 0xffff0000, v174
    v_lshlrev_b32 v66, 16, v175
    v_and_b32 v67, 0xffff0000, v175
    v_pk_fma_f32 v[52:53], v[52:53], v[60:61], v[64:65]
    v_pk_fma_f32 v[54:55], v[54:55], v[62:63], v[66:67]
    v_cvt_pk_bf16_f32 v56, v52, v53
    v_cvt_pk_bf16_f32 v57, v54, v55
    buffer_store_dwordx2 v[56:57], v224, s[16:19], s41 offen offset:96
    v_accvgpr_read_b32 v4, a40
    v_accvgpr_read_b32 v5, a41
    v_accvgpr_read_b32 v6, a42
    v_accvgpr_read_b32 v7, a43
    v_accvgpr_read_b32 v8, a16
    v_accvgpr_read_b32 v9, a17
    v_accvgpr_read_b32 v10, a18
    v_accvgpr_read_b32 v11, a19
    v_pk_mul_f32 v[4:5], v[224:225], v[4:5] op_sel:[1,0] op_sel_hi:[1,1]
    v_pk_mul_f32 v[6:7], v[224:225], v[6:7] op_sel:[1,0] op_sel_hi:[1,1]
    v_pk_mul_f32 v[12:13], v[2:3], v[4:5]
    v_pk_mul_f32 v[14:15], v[2:3], v[6:7]
    v_exp_f32 v12, v12
    v_exp_f32 v13, v13
    v_exp_f32 v14, v14
    v_exp_f32 v15, v15
    v_pk_add_f32 v[12:13], v[72:73], v[12:13]
    v_pk_add_f32 v[14:15], v[72:73], v[14:15]
    v_rcp_f32 v12, v12
    v_rcp_f32 v13, v13
    v_rcp_f32 v14, v14
    v_rcp_f32 v15, v15
    v_pk_mul_f32 v[4:5], v[4:5], v[8:9]
    v_pk_mul_f32 v[6:7], v[6:7], v[10:11]
    v_lshlrev_b32 v16, 16, v176
    v_and_b32 v17, 0xffff0000, v176
    v_lshlrev_b32 v18, 16, v177
    v_and_b32 v19, 0xffff0000, v177
    v_pk_fma_f32 v[4:5], v[4:5], v[12:13], v[16:17]
    v_pk_fma_f32 v[6:7], v[6:7], v[14:15], v[18:19]
    v_cvt_pk_bf16_f32 v8, v4, v5
    v_cvt_pk_bf16_f32 v9, v6, v7
    buffer_store_dwordx2 v[8:9], v224, s[16:19], s41 offen offset:128
    v_accvgpr_read_b32 v20, a44
    v_accvgpr_read_b32 v21, a45
    v_accvgpr_read_b32 v22, a46
    v_accvgpr_read_b32 v23, a47
    v_accvgpr_read_b32 v24, a20
    v_accvgpr_read_b32 v25, a21
    v_accvgpr_read_b32 v26, a22
    v_accvgpr_read_b32 v27, a23
    v_pk_mul_f32 v[20:21], v[224:225], v[20:21] op_sel:[1,0] op_sel_hi:[1,1]
    v_pk_mul_f32 v[22:23], v[224:225], v[22:23] op_sel:[1,0] op_sel_hi:[1,1]
    v_pk_mul_f32 v[28:29], v[2:3], v[20:21]
    v_pk_mul_f32 v[30:31], v[2:3], v[22:23]
    v_exp_f32 v28, v28
    v_exp_f32 v29, v29
    v_exp_f32 v30, v30
    v_exp_f32 v31, v31
    v_pk_add_f32 v[28:29], v[72:73], v[28:29]
    v_pk_add_f32 v[30:31], v[72:73], v[30:31]
    v_rcp_f32 v28, v28
    v_rcp_f32 v29, v29
    v_rcp_f32 v30, v30
    v_rcp_f32 v31, v31
    v_pk_mul_f32 v[20:21], v[20:21], v[24:25]
    v_pk_mul_f32 v[22:23], v[22:23], v[26:27]
    v_lshlrev_b32 v32, 16, v178
    v_and_b32 v33, 0xffff0000, v178
    v_lshlrev_b32 v34, 16, v179
    v_and_b32 v35, 0xffff0000, v179
    v_pk_fma_f32 v[20:21], v[20:21], v[28:29], v[32:33]
    v_pk_fma_f32 v[22:23], v[22:23], v[30:31], v[34:35]
    v_cvt_pk_bf16_f32 v24, v20, v21
    v_cvt_pk_bf16_f32 v25, v22, v23
    buffer_store_dwordx2 v[24:25], v224, s[16:19], s41 offen offset:160
    s_waitcnt vmcnt(0)
    s_endpgm
L_mid_mlp:
    s_and_b32 s50, s2, 7
    s_lshr_b32 s51, s2, 3
    s_and_b32 s51, s51, 15
    s_and_b32 s52, s50, 1
    s_lshl_b32 s52, s52, 3
    s_and_b32 s53, s51, 7
    s_add_u32 s44, s52, s53
    s_lshr_b32 s52, s50, 1
    s_lshl_b32 s52, s52, 1
    s_lshr_b32 s53, s51, 3
    s_add_u32 s45, s52, s53
    s_load_dwordx2 s[4:5], s[0:1], 0
    s_load_dwordx2 s[8:9], s[0:1], 32
    s_load_dwordx2 s[12:13], s[0:1], 40
    s_load_dwordx2 s[16:17], s[0:1], 48
    s_load_dwordx2 s[20:21], s[0:1], 72
    v_lshrrev_b32 v254, 6, v0
    v_and_b32 v255, 63, v0
    s_nop 0
    v_readfirstlane_b32 s37, v254
    v_lshrrev_b32 v144, 3, v255
    v_lshrrev_b32 v145, 4, v255
    v_and_b32 v146, 7, v255
    v_xor_b32 v145, v145, v146
    v_lshlrev_b32 v145, 4, v145
    v_mul_u32_u24 v144, 1152, v144
    v_add_u32 v176, v144, v145
    v_xor_b32 v145, 64, v145
    v_add_u32 v177, v144, v145
    v_add_u32 v177, 9216, v177
    v_and_b32 v144, 15, v255
    v_lshrrev_b32 v145, 1, v144
    v_lshrrev_b32 v146, 4, v255
    v_xor_b32 v145, v145, v146
    v_lshlrev_b32 v145, 4, v145
    v_lshlrev_b32 v144, 7, v144
    v_add_u32 v178, v144, v145
    s_mul_i32 s48, s37, 18432
    s_add_u32 s48, s48, 0
    v_add_u32 v178, s48, v178
    v_xor_b32 v179, 64, v178
    s_mul_i32 s49, s44, 147456
    s_mul_i32 s40, s37, 36864
    s_add_u32 s49, s49, s40
    s_waitcnt lgkmcnt(0)
    s_mov_b32 s6, 2359296
    s_mov_b32 s7, 0x00020000
    s_mov_b32 s10, 5308416
    s_mov_b32 s11, 0x00020000
    s_mov_b32 s14, 5308416
    s_mov_b32 s15, 0x00020000
    s_mov_b32 s18, 5312512
    s_mov_b32 s19, 0x00020000
    s_mov_b32 s22, 0
    s_mov_b32 s23, 0x00020000
    s_add_u32 s50, s49, 0
    s_add_u32 m0, s48, 0
    s_nop 0
    buffer_load_dwordx4 v176, s[4:7], s50 offen  lds
    s_add_u32 m0, s48, 1024
    s_nop 0
    buffer_load_dwordx4 v177, s[4:7], s50 offen  lds
    s_add_u32 m0, s48, 2048
    s_add_u32 s50, s50, 128
    buffer_load_dwordx4 v176, s[4:7], s50 offen  lds
    s_add_u32 m0, s48, 3072
    s_nop 0
    buffer_load_dwordx4 v177, s[4:7], s50 offen  lds
    s_add_u32 m0, s48, 4096
    s_add_u32 s50, s50, 128
    buffer_load_dwordx4 v176, s[4:7], s50 offen  lds
    s_add_u32 m0, s48, 5120
    s_nop 0
    buffer_load_dwordx4 v177, s[4:7], s50 offen  lds
    s_add_u32 m0, s48, 6144
    s_add_u32 s50, s50, 128
    buffer_load_dwordx4 v176, s[4:7], s50 offen  lds
    s_add_u32 m0, s48, 7168
    s_nop 0
    buffer_load_dwordx4 v177, s[4:7], s50 offen  lds
    s_add_u32 m0, s48, 8192
    s_add_u32 s50, s50, 128
    buffer_load_dwordx4 v176, s[4:7], s50 offen  lds
    s_add_u32 m0, s48, 9216
    s_nop 0
    buffer_load_dwordx4 v177, s[4:7], s50 offen  lds
    s_add_u32 m0, s48, 10240
    s_add_u32 s50, s50, 128
    buffer_load_dwordx4 v176, s[4:7], s50 offen  lds
    s_add_u32 m0, s48, 11264
    s_nop 0
    buffer_load_dwordx4 v177, s[4:7], s50 offen  lds
    s_add_u32 m0, s48, 12288
    s_add_u32 s50, s50, 128
    buffer_load_dwordx4 v176, s[4:7], s50 offen  lds
    s_add_u32 m0, s48, 13312
    s_nop 0
    buffer_load_dwordx4 v177, s[4:7], s50 offen  lds
    s_add_u32 m0, s48, 14336
    s_add_u32 s50, s50, 128
    buffer_load_dwordx4 v176, s[4:7], s50 offen  lds
    s_add_u32 m0, s48, 15360
    s_nop 0
    buffer_load_dwordx4 v177, s[4:7], s50 offen  lds
    s_add_u32 m0, s48, 16384
    s_add_u32 s50, s50, 128
    buffer_load_dwordx4 v176, s[4:7], s50 offen  lds
    s_add_u32 m0, s48, 17408
    s_nop 0
    buffer_load_dwordx4 v177, s[4:7], s50 offen  lds
    s_add_u32 s50, s49, 18432
    s_add_u32 m0, s48, 73728
    s_nop 0
    buffer_load_dwordx4 v176, s[4:7], s50 offen  lds
    s_add_u32 m0, s48, 74752
    s_nop 0
    buffer_load_dwordx4 v177, s[4:7], s50 offen  lds
    s_add_u32 m0, s48, 75776
    s_add_u32 s50, s50, 128
    buffer_load_dwordx4 v176, s[4:7], s50 offen  lds
    s_add_u32 m0, s48, 76800
    s_nop 0
    buffer_load_dwordx4 v177, s[4:7], s50 offen  lds
    s_add_u32 m0, s48, 77824
    s_add_u32 s50, s50, 128
    buffer_load_dwordx4 v176, s[4:7], s50 offen  lds
    s_add_u32 m0, s48, 78848
    s_nop 0
    buffer_load_dwordx4 v177, s[4:7], s50 offen  lds
    s_add_u32 m0, s48, 79872
    s_add_u32 s50, s50, 128
    buffer_load_dwordx4 v176, s[4:7], s50 offen  lds
    s_add_u32 m0, s48, 80896
    s_nop 0
    buffer_load_dwordx4 v177, s[4:7], s50 offen  lds
    s_add_u32 m0, s48, 81920
    s_add_u32 s50, s50, 128
    buffer_load_dwordx4 v176, s[4:7], s50 offen  lds
    s_add_u32 m0, s48, 82944
    s_nop 0
    buffer_load_dwordx4 v177, s[4:7], s50 offen  lds
    s_add_u32 m0, s48, 83968
    s_add_u32 s50, s50, 128
    buffer_load_dwordx4 v176, s[4:7], s50 offen  lds
    s_add_u32 m0, s48, 84992
    s_nop 0
    buffer_load_dwordx4 v177, s[4:7], s50 offen  lds
    s_add_u32 m0, s48, 86016
    s_add_u32 s50, s50, 128
    buffer_load_dwordx4 v176, s[4:7], s50 offen  lds
    s_add_u32 m0, s48, 87040
    s_nop 0
    buffer_load_dwordx4 v177, s[4:7], s50 offen  lds
    s_add_u32 m0, s48, 88064
    s_add_u32 s50, s50, 128
    buffer_load_dwordx4 v176, s[4:7], s50 offen  lds
    s_add_u32 m0, s48, 89088
    s_nop 0
    buffer_load_dwordx4 v177, s[4:7], s50 offen  lds
    s_add_u32 m0, s48, 90112
    s_add_u32 s50, s50, 128
    buffer_load_dwordx4 v176, s[4:7], s50 offen  lds
    s_add_u32 m0, s48, 91136
    s_nop 0
    buffer_load_dwordx4 v177, s[4:7], s50 offen  lds
    v_lshrrev_b32 v144, 2, v255
    v_lshlrev_b32 v144, 7, v144
    v_bfe_u32 v145, v255, 3, 2
    v_lshlrev_b32 v145, 5, v145
    v_and_b32 v146, 3, v255
    v_lshlrev_b32 v146, 3, v146
    v_add3_u32 v248, v144, v145, v146
    v_xor_b32 v249, 32, v248
    v_xor_b32 v250, 64, v248
    v_xor_b32 v251, 96, v248
    v_lshrrev_b32 v144, 3, v255
    v_bfe_u32 v145, v255, 4, 2
    v_lshlrev_b32 v145, 1, v145
    v_and_b32 v146, 7, v255
    v_xor_b32 v145, v145, v146
    v_lshlrev_b32 v145, 4, v145
    v_mul_u32_u24 v253, 1152, v144
    v_add_u32 v253, v253, v145
    v_lshrrev_b32 v146, 2, v144
    v_lshlrev_b32 v146, 3, v146
    v_and_b32 v147, 3, v144
    v_add_u32 v146, v146, v147
    v_mul_u32_u24 v252, 9216, v146
    v_add_u32 v252, v252, v145
    s_mul_i32 s36, s37, 6144
    s_mul_i32 s42, s37, 48
    s_add_u32 s42, s42, 0
    s_and_b32 s40, s42, 0xffffffe0
    s_bfe_u32 s41, s42, 0x10003
    s_lshl_b32 s41, s41, 4
    s_add_u32 s40, s40, s41
    s_bfe_u32 s41, s42, 0x10004
    s_lshl_b32 s41, s41, 2
    s_add_u32 s40, s40, s41
    s_mul_i32 s40, s40, 9216
    s_sub_u32 s24, s40, 0
    s_mul_i32 s40, s42, 1152
    s_add_u32 s30, s40, 4096
    s_mul_i32 s42, s37, 48
    s_add_u32 s42, s42, 8
    s_and_b32 s40, s42, 0xffffffe0
    s_bfe_u32 s41, s42, 0x10003
    s_lshl_b32 s41, s41, 4
    s_add_u32 s40, s40, s41
    s_bfe_u32 s41, s42, 0x10004
    s_lshl_b32 s41, s41, 2
    s_add_u32 s40, s40, s41
    s_mul_i32 s40, s40, 9216
    s_sub_u32 s25, s40, 1024
    s_mul_i32 s40, s42, 1152
    s_add_u32 s31, s40, 3072
    s_mul_i32 s42, s37, 48
    s_add_u32 s42, s42, 16
    s_and_b32 s40, s42, 0xffffffe0
    s_bfe_u32 s41, s42, 0x10003
    s_lshl_b32 s41, s41, 4
    s_add_u32 s40, s40, s41
    s_bfe_u32 s41, s42, 0x10004
    s_lshl_b32 s41, s41, 2
    s_add_u32 s40, s40, s41
    s_mul_i32 s40, s40, 9216
    s_sub_u32 s26, s40, 2048
    s_mul_i32 s40, s42, 1152
    s_add_u32 s32, s40, 2048
    s_mul_i32 s42, s37, 48
    s_add_u32 s42, s42, 24
    s_and_b32 s40, s42, 0xffffffe0
    s_bfe_u32 s41, s42, 0x10003
    s_lshl_b32 s41, s41, 4
    s_add_u32 s40, s40, s41
    s_bfe_u32 s41, s42, 0x10004
    s_lshl_b32 s41, s41, 2
    s_add_u32 s40, s40, s41
    s_mul_i32 s40, s40, 9216
    s_sub_u32 s27, s40, 3072
    s_mul_i32 s40, s42, 1152
    s_add_u32 s33, s40, 1024
    s_mul_i32 s42, s37, 48
    s_add_u32 s42, s42, 32
    s_and_b32 s40, s42, 0xffffffe0
    s_bfe_u32 s41, s42, 0x10003
    s_lshl_b32 s41, s41, 4
    s_add_u32 s40, s40, s41
    s_bfe_u32 s41, s42, 0x10004
    s_lshl_b32 s41, s41, 2
    s_add_u32 s40, s40, s41
    s_mul_i32 s40, s40, 9216
    s_sub_u32 s28, s40, 0
    s_mul_i32 s40, s42, 1152
    s_add_u32 s34, s40, 4096
    s_mul_i32 s42, s37, 48
    s_add_u32 s42, s42, 40
    s_and_b32 s40, s42, 0xffffffe0
    s_bfe_u32 s41, s42, 0x10003
    s_lshl_b32 s41, s41, 4
    s_add_u32 s40, s40, s41
    s_bfe_u32 s41, s42, 0x10004
    s_lshl_b32 s41, s41, 2
    s_add_u32 s40, s40, s41
    s_mul_i32 s40, s40, 9216
    s_sub_u32 s29, s40, 1024
    s_mul_i32 s40, s42, 1152
    s_add_u32 s35, s40, 3072
    s_mov_b32 s43, 0xffff0000
    s_mul_i32 s42, s45, 1152
    s_add_u32 s8, s8, s42
    s_addc_u32 s9, s9, 0
    s_add_u32 s12, s12, s42
    s_addc_u32 s13, s13, 0
    s_mul_i32 s42, s45, 663552
    s_add_u32 s16, s16, s42
    s_addc_u32 s17, s17, 0
    s_and_b32 s42, s44, 7
    s_lshl_b32 s42, s42, 2
    s_add_u32 s42, s42, s37
    s_mul_i32 s41, s45, 1152
    s_sub_u32 s54, 5308416, s41
    s_mov_b32 s55, 0x00020000
    s_mov_b32 s52, s8
    s_mov_b32 s53, s9
    s_mov_b32 s56, 9216
    s_mov_b32 s58, 128
    s_cmp_ge_u32 s42, 9
    s_cselect_b32 s52, s12, s52
    s_cselect_b32 s53, s13, s53
    s_cselect_b32 s41, 9, 0
    s_cselect_b32 s59, 2, 3
    s_sub_u32 s57, s42, s41
    s_cmp_ge_u32 s42, 18
    s_cselect_b32 s54, 0, s54
    s_mul_i32 s57, s57, 589824
    s_add_u32 s16, s16, 0xfffff000
    s_addc_u32 s17, s17, 0xffffffff
    s_mov_b32 s46, 0xffca0080
    s_mov_b32 s47, 1769472
    v_mbcnt_lo_u32_b32 v254, -1, 0
    v_mbcnt_hi_u32_b32 v254, -1, v254
    v_mul_u32_u24 v254, s56, v254
    s_mov_b32 m0, 147456
    s_nop 0
    buffer_load_dword v254, s[52:55], s57 offen lds
    s_add_u32 s57, s57, s58
    v_mbcnt_lo_u32_b32 v254, -1, 0
    v_mbcnt_hi_u32_b32 v254, -1, v254
    v_mul_u32_u24 v254, s56, v254
    s_mov_b32 m0, 147456
    s_nop 0
    buffer_load_dword v254, s[52:55], s57 offen lds
    s_add_u32 s57, s57, s58
    v_and_b32 v152, 15, v255
    v_lshrrev_b32 v153, 4, v255
    v_lshrrev_b32 v154, 2, v152
    v_cmp_eq_u32 vcc, v154, v153
    v_and_b32 v155, 1, v152
    v_lshlrev_b32 v155, 4, v155
    v_mov_b32 v156, 0x3f80
    v_lshlrev_b32 v156, v155, v156
    v_cndmask_b32 v156, 0, v156, vcc
    v_and_b32 v155, 2, v152
    v_cmp_eq_u32 vcc, 0, v155
    v_mov_b32 v192, 0
    v_mov_b32 v193, 0
    v_cndmask_b32 v194, 0, v156, vcc
    v_mov_b32 v196, 0
    v_mov_b32 v197, 0
    v_sub_u32 v195, v156, v194
    v_mov_b32 v200, 0x3f803f80
    v_mov_b32 v201, 0x3f803f80
    v_mov_b32 v202, 0x3f803f80
    v_mov_b32 v203, 0x3f803f80
    v_mbcnt_lo_u32_b32 v135, -1, 0
    v_mbcnt_hi_u32_b32 v135, -1, v135
    s_and_b32 s42, s37, 1
    s_mul_i32 s42, s42, 384
    v_add_u32 v128, s42, v135
    v_mul_u32_u24 v129, 683, v128
    v_lshrrev_b32 v129, 13, v129
    v_mul_u32_u24 v130, 12, v129
    v_sub_u32 v130, v128, v130
    v_bfe_u32 v131, v129, 2, 1
    v_lshlrev_b32 v131, 1, v131
    v_xor_b32 v130, v130, v131
    v_lshlrev_b32 v130, 4, v130
    v_lshrrev_b32 v131, 5, v129
    v_bfe_u32 v132, v129, 4, 1
    v_bfe_u32 v133, v129, 2, 2
    v_mul_u32_u24 v134, 36, v131
    v_lshrrev_b32 v128, 1, v133
    v_mul_u32_u24 v128, 18, v128
    v_add_u32 v134, v134, v128
    v_and_b32 v128, 1, v133
    v_lshlrev_b32 v128, 2, v128
    v_add_u32 v134, v134, v128
    v_lshlrev_b32 v128, 3, v132
    v_add_u32 v134, v134, v128
    v_and_b32 v128, 3, v129
    v_add_u32 v134, v134, v128
    v_mul_u32_u24 v134, 1152, v134
    v_add_u32 v134, v134, v130
    v_accvgpr_write_b32 a144, v134
    v_add_u32 v128, s42, v135
    v_add_u32 v128, 64, v128
    v_mul_u32_u24 v129, 683, v128
    v_lshrrev_b32 v129, 13, v129
    v_mul_u32_u24 v130, 12, v129
    v_sub_u32 v130, v128, v130
    v_bfe_u32 v131, v129, 2, 1
    v_lshlrev_b32 v131, 1, v131
    v_xor_b32 v130, v130, v131
    v_lshlrev_b32 v130, 4, v130
    v_lshrrev_b32 v131, 5, v129
    v_bfe_u32 v132, v129, 4, 1
    v_bfe_u32 v133, v129, 2, 2
    v_mul_u32_u24 v134, 36, v131
    v_lshrrev_b32 v128, 1, v133
    v_mul_u32_u24 v128, 18, v128
    v_add_u32 v134, v134, v128
    v_and_b32 v128, 1, v133
    v_lshlrev_b32 v128, 2, v128
    v_add_u32 v134, v134, v128
    v_lshlrev_b32 v128, 3, v132
    v_add_u32 v134, v134, v128
    v_and_b32 v128, 3, v129
    v_add_u32 v134, v134, v128
    v_mul_u32_u24 v134, 1152, v134
    v_add_u32 v134, v134, v130
    v_accvgpr_write_b32 a145, v134
    v_add_u32 v128, s42, v135
    v_add_u32 v128, 128, v128
    v_mul_u32_u24 v129, 683, v128
    v_lshrrev_b32 v129, 13, v129
    v_mul_u32_u24 v130, 12, v129
    v_sub_u32 v130, v128, v130
    v_bfe_u32 v131, v129, 2, 1
    v_lshlrev_b32 v131, 1, v131
    v_xor_b32 v130, v130, v131
    v_lshlrev_b32 v130, 4, v130
    v_lshrrev_b32 v131, 5, v129
    v_bfe_u32 v132, v129, 4, 1
    v_bfe_u32 v133, v129, 2, 2
    v_mul_u32_u24 v134, 36, v131
    v_lshrrev_b32 v128, 1, v133
    v_mul_u32_u24 v128, 18, v128
    v_add_u32 v134, v134, v128
    v_and_b32 v128, 1, v133
    v_lshlrev_b32 v128, 2, v128
    v_add_u32 v134, v134, v128
    v_lshlrev_b32 v128, 3, v132
    v_add_u32 v134, v134, v128
    v_and_b32 v128, 3, v129
    v_add_u32 v134, v134, v128
    v_mul_u32_u24 v134, 1152, v134
    v_add_u32 v134, v134, v130
    v_accvgpr_write_b32 a146, v134
    v_add_u32 v128, s42, v135
    v_add_u32 v128, 192, v128
    v_mul_u32_u24 v129, 683, v128
    v_lshrrev_b32 v129, 13, v129
    v_mul_u32_u24 v130, 12, v129
    v_sub_u32 v130, v128, v130
    v_bfe_u32 v131, v129, 2, 1
    v_lshlrev_b32 v131, 1, v131
    v_xor_b32 v130, v130, v131
    v_lshlrev_b32 v130, 4, v130
    v_lshrrev_b32 v131, 5, v129
    v_bfe_u32 v132, v129, 4, 1
    v_bfe_u32 v133, v129, 2, 2
    v_mul_u32_u24 v134, 36, v131
    v_lshrrev_b32 v128, 1, v133
    v_mul_u32_u24 v128, 18, v128
    v_add_u32 v134, v134, v128
    v_and_b32 v128, 1, v133
    v_lshlrev_b32 v128, 2, v128
    v_add_u32 v134, v134, v128
    v_lshlrev_b32 v128, 3, v132
    v_add_u32 v134, v134, v128
    v_and_b32 v128, 3, v129
    v_add_u32 v134, v134, v128
    v_mul_u32_u24 v134, 1152, v134
    v_add_u32 v134, v134, v130
    v_accvgpr_write_b32 a147, v134
    v_add_u32 v128, s42, v135
    v_add_u32 v128, 256, v128
    v_mul_u32_u24 v129, 683, v128
    v_lshrrev_b32 v129, 13, v129
    v_mul_u32_u24 v130, 12, v129
    v_sub_u32 v130, v128, v130
    v_bfe_u32 v131, v129, 2, 1
    v_lshlrev_b32 v131, 1, v131
    v_xor_b32 v130, v130, v131
    v_lshlrev_b32 v130, 4, v130
    v_lshrrev_b32 v131, 5, v129
    v_bfe_u32 v132, v129, 4, 1
    v_bfe_u32 v133, v129, 2, 2
    v_mul_u32_u24 v134, 36, v131
    v_lshrrev_b32 v128, 1, v133
    v_mul_u32_u24 v128, 18, v128
    v_add_u32 v134, v134, v128
    v_and_b32 v128, 1, v133
    v_lshlrev_b32 v128, 2, v128
    v_add_u32 v134, v134, v128
    v_lshlrev_b32 v128, 3, v132
    v_add_u32 v134, v134, v128
    v_and_b32 v128, 3, v129
    v_add_u32 v134, v134, v128
    v_mul_u32_u24 v134, 1152, v134
    v_add_u32 v134, v134, v130
    v_accvgpr_write_b32 a148, v134
    v_add_u32 v128, s42, v135
    v_add_u32 v128, 320, v128
    v_mul_u32_u24 v129, 683, v128
    v_lshrrev_b32 v129, 13, v129
    v_mul_u32_u24 v130, 12, v129
    v_sub_u32 v130, v128, v130
    v_bfe_u32 v131, v129, 2, 1
    v_lshlrev_b32 v131, 1, v131
    v_xor_b32 v130, v130, v131
    v_lshlrev_b32 v130, 4, v130
    v_lshrrev_b32 v131, 5, v129
    v_bfe_u32 v132, v129, 4, 1
    v_bfe_u32 v133, v129, 2, 2
    v_mul_u32_u24 v134, 36, v131
    v_lshrrev_b32 v128, 1, v133
    v_mul_u32_u24 v128, 18, v128
    v_add_u32 v134, v134, v128
    v_and_b32 v128, 1, v133
    v_lshlrev_b32 v128, 2, v128
    v_add_u32 v134, v134, v128
    v_lshlrev_b32 v128, 3, v132
    v_add_u32 v134, v134, v128
    v_and_b32 v128, 3, v129
    v_add_u32 v134, v134, v128
    v_mul_u32_u24 v134, 1152, v134
    v_add_u32 v134, v134, v130
    v_accvgpr_write_b32 a149, v134
    s_waitcnt vmcnt(20)
    ds_read_b128 v[0:3], v178 offset:0
    ds_read_b128 v[4:7], v179 offset:0
    ds_read_b128 v[8:11], v178 offset:2048
    ds_read_b128 v[12:15], v179 offset:2048
    ds_read_b128 v[16:19], v178 offset:4096
    ds_read_b128 v[20:23], v179 offset:4096
    ds_read_b128 v[24:27], v178 offset:6144
    ds_read_b128 v[28:31], v179 offset:6144
    ds_read_b128 v[32:35], v178 offset:8192
    ds_read_b128 v[36:39], v179 offset:8192
    ds_read_b128 v[40:43], v178 offset:10240
    ds_read_b128 v[44:47], v179 offset:10240
    ds_read_b128 v[48:51], v178 offset:12288
    ds_read_b128 v[52:55], v179 offset:12288
    ds_read_b128 v[56:59], v178 offset:14336
    ds_read_b128 v[60:63], v179 offset:14336
    ds_read_b128 v[64:67], v178 offset:16384
    ds_read_b128 v[68:71], v179 offset:16384
    s_waitcnt lgkmcnt(15)
    v_mfma_f32_16x16x32_bf16 v[204:207], v[200:203], v[0:3], 0
    v_mfma_f32_16x16x32_bf16 v[204:207], v[200:203], v[4:7], v[204:207]
    v_mfma_f32_16x16x32_bf16 v[204:207], v[200:203], v[8:11], v[204:207]
    s_waitcnt lgkmcnt(12)
    v_mfma_f32_16x16x32_bf16 v[204:207], v[200:203], v[12:15], v[204:207]
    v_mfma_f32_16x16x32_bf16 v[204:207], v[200:203], v[16:19], v[204:207]
    v_mfma_f32_16x16x32_bf16 v[204:207], v[200:203], v[20:23], v[204:207]
    s_waitcnt lgkmcnt(9)
    v_mfma_f32_16x16x32_bf16 v[204:207], v[200:203], v[24:27], v[204:207]
    v_mfma_f32_16x16x32_bf16 v[204:207], v[200:203], v[28:31], v[204:207]
    v_mfma_f32_16x16x32_bf16 v[204:207], v[200:203], v[32:35], v[204:207]
    s_waitcnt lgkmcnt(6)
    v_mfma_f32_16x16x32_bf16 v[204:207], v[200:203], v[36:39], v[204:207]
    v_mfma_f32_16x16x32_bf16 v[204:207], v[200:203], v[40:43], v[204:207]
    v_mfma_f32_16x16x32_bf16 v[204:207], v[200:203], v[44:47], v[204:207]
    s_waitcnt lgkmcnt(3)
    v_mfma_f32_16x16x32_bf16 v[204:207], v[200:203], v[48:51], v[204:207]
    v_mfma_f32_16x16x32_bf16 v[204:207], v[200:203], v[52:55], v[204:207]
    v_mfma_f32_16x16x32_bf16 v[204:207], v[200:203], v[56:59], v[204:207]
    s_waitcnt lgkmcnt(0)
    v_mfma_f32_16x16x32_bf16 v[204:207], v[200:203], v[60:63], v[204:207]
    v_mfma_f32_16x16x32_bf16 v[204:207], v[200:203], v[64:67], v[204:207]
    v_mfma_f32_16x16x32_bf16 v[204:207], v[200:203], v[68:71], v[204:207]
    s_barrier
    s_nop 6
    v_mul_f32 v204, 0xbae38e39, v204
    s_add_u32 m0, s36, 0
    s_nop 0
    buffer_load_dwordx4 v252, s[8:11], s24 offen offset:0 lds
    s_nop 2
    v_mul_f32 v205, 0xbae38e39, v205
    s_nop 1
    v_mul_f32 v206, 0xbae38e39, v206
    s_nop 0
    v_mul_f32 v207, 0xbae38e39, v207
    s_nop 1
    v_mfma_f32_16x16x32_bf16 v[144:147], v[194:197], v[0:3], v[204:207]
    s_nop 0
    v_mfma_f32_16x16x32_bf16 v[148:151], v[192:195], v[0:3], v[204:207]
    buffer_load_dwordx4 v252, s[8:11], s25 offen offset:1024 lds
    v_mfma_f32_16x16x32_bf16 v[152:155], v[194:197], v[4:7], v[204:207]
    v_mfma_f32_16x16x32_bf16 v[156:159], v[192:195], v[4:7], v[204:207]
    v_mfma_f32_16x16x32_bf16 v[160:163], v[194:197], v[8:11], v[204:207]
    v_mfma_f32_16x16x32_bf16 v[164:167], v[192:195], v[8:11], v[204:207]
    s_nop 1
    v_cvt_pk_bf16_f32 v0, v144, v145
    buffer_load_dwordx4 v252, s[8:11], s26 offen offset:2048 lds
    v_cvt_pk_bf16_f32 v1, v146, v147
    v_cvt_pk_bf16_f32 v2, v148, v149
    v_cvt_pk_bf16_f32 v3, v150, v151
    v_mfma_f32_16x16x32_bf16 v[144:147], v[194:197], v[12:15], v[204:207]
    v_mfma_f32_16x16x32_bf16 v[148:151], v[192:195], v[12:15], v[204:207]
    buffer_load_dwordx4 v252, s[8:11], s27 offen offset:3072 lds
    v_cvt_pk_bf16_f32 v4, v152, v153
    v_cvt_pk_bf16_f32 v5, v154, v155
    v_cvt_pk_bf16_f32 v6, v156, v157
    v_cvt_pk_bf16_f32 v7, v158, v159
    v_mfma_f32_16x16x32_bf16 v[152:155], v[194:197], v[16:19], v[204:207]
    s_add_u32 m0, s36, 4096
    s_nop 0
    buffer_load_dwordx4 v252, s[8:11], s28 offen offset:0 lds
    v_mfma_f32_16x16x32_bf16 v[156:159], v[192:195], v[16:19], v[204:207]
    v_cvt_pk_bf16_f32 v8, v160, v161
    v_cvt_pk_bf16_f32 v9, v162, v163
    v_cvt_pk_bf16_f32 v10, v164, v165
    v_cvt_pk_bf16_f32 v11, v166, v167
    buffer_load_dwordx4 v252, s[8:11], s29 offen offset:1024 lds
    v_mfma_f32_16x16x32_bf16 v[160:163], v[194:197], v[20:23], v[204:207]
    v_mfma_f32_16x16x32_bf16 v[164:167], v[192:195], v[20:23], v[204:207]
    v_cvt_pk_bf16_f32 v12, v144, v145
    v_cvt_pk_bf16_f32 v13, v146, v147
    v_cvt_pk_bf16_f32 v14, v148, v149
    s_add_u32 s8, s8, s47
    s_addc_u32 s9, s9, 0
    v_cvt_pk_bf16_f32 v15, v150, v151
    v_mfma_f32_16x16x32_bf16 v[144:147], v[194:197], v[24:27], v[204:207]
    v_mfma_f32_16x16x32_bf16 v[148:151], v[192:195], v[24:27], v[204:207]
    v_cvt_pk_bf16_f32 v16, v152, v153
    v_cvt_pk_bf16_f32 v17, v154, v155
    s_add_u32 m0, s36, 24576
    s_nop 0
    buffer_load_dwordx4 v252, s[8:11], s24 offen offset:0 lds
    v_cvt_pk_bf16_f32 v18, v156, v157
    v_cvt_pk_bf16_f32 v19, v158, v159
    v_mfma_f32_16x16x32_bf16 v[152:155], v[194:197], v[28:31], v[204:207]
    v_mfma_f32_16x16x32_bf16 v[156:159], v[192:195], v[28:31], v[204:207]
    v_cvt_pk_bf16_f32 v20, v160, v161
    buffer_load_dwordx4 v252, s[8:11], s25 offen offset:1024 lds
    v_cvt_pk_bf16_f32 v21, v162, v163
    v_cvt_pk_bf16_f32 v22, v164, v165
    v_cvt_pk_bf16_f32 v23, v166, v167
    v_mfma_f32_16x16x32_bf16 v[160:163], v[194:197], v[32:35], v[204:207]
    v_mfma_f32_16x16x32_bf16 v[164:167], v[192:195], v[32:35], v[204:207]
    buffer_load_dwordx4 v252, s[8:11], s26 offen offset:2048 lds
    v_cvt_pk_bf16_f32 v24, v144, v145
    v_cvt_pk_bf16_f32 v25, v146, v147
    v_cvt_pk_bf16_f32 v26, v148, v149
    v_cvt_pk_bf16_f32 v27, v150, v151
    v_mfma_f32_16x16x32_bf16 v[144:147], v[194:197], v[36:39], v[204:207]
    buffer_load_dwordx4 v252, s[8:11], s27 offen offset:3072 lds
    v_mfma_f32_16x16x32_bf16 v[148:151], v[192:195], v[36:39], v[204:207]
    v_cvt_pk_bf16_f32 v28, v152, v153
    v_cvt_pk_bf16_f32 v29, v154, v155
    v_cvt_pk_bf16_f32 v30, v156, v157
    v_cvt_pk_bf16_f32 v31, v158, v159
    v_mfma_f32_16x16x32_bf16 v[152:155], v[194:197], v[40:43], v[204:207]
    s_add_u32 m0, s36, 28672
    s_nop 0
    buffer_load_dwordx4 v252, s[8:11], s28 offen offset:0 lds
    v_mfma_f32_16x16x32_bf16 v[156:159], v[192:195], v[40:43], v[204:207]
    v_cvt_pk_bf16_f32 v32, v160, v161
    v_cvt_pk_bf16_f32 v33, v162, v163
    v_cvt_pk_bf16_f32 v34, v164, v165
    v_cvt_pk_bf16_f32 v35, v166, v167
    buffer_load_dwordx4 v252, s[8:11], s29 offen offset:1024 lds
    v_mfma_f32_16x16x32_bf16 v[160:163], v[194:197], v[44:47], v[204:207]
    v_mfma_f32_16x16x32_bf16 v[164:167], v[192:195], v[44:47], v[204:207]
    v_cvt_pk_bf16_f32 v36, v144, v145
    v_cvt_pk_bf16_f32 v37, v146, v147
    v_cvt_pk_bf16_f32 v38, v148, v149
    s_add_u32 s8, s8, s47
    s_addc_u32 s9, s9, 0
    v_cvt_pk_bf16_f32 v39, v150, v151
    v_mfma_f32_16x16x32_bf16 v[144:147], v[194:197], v[48:51], v[204:207]
    v_mfma_f32_16x16x32_bf16 v[148:151], v[192:195], v[48:51], v[204:207]
    v_cvt_pk_bf16_f32 v40, v152, v153
    v_cvt_pk_bf16_f32 v41, v154, v155
    s_add_u32 m0, s36, 49152
    s_nop 0
    buffer_load_dwordx4 v252, s[8:11], s24 offen offset:0 lds
    v_cvt_pk_bf16_f32 v42, v156, v157
    v_cvt_pk_bf16_f32 v43, v158, v159
    v_mfma_f32_16x16x32_bf16 v[152:155], v[194:197], v[52:55], v[204:207]
    v_mfma_f32_16x16x32_bf16 v[156:159], v[192:195], v[52:55], v[204:207]
    v_cvt_pk_bf16_f32 v44, v160, v161
    buffer_load_dwordx4 v252, s[8:11], s25 offen offset:1024 lds
    v_cvt_pk_bf16_f32 v45, v162, v163
    v_cvt_pk_bf16_f32 v46, v164, v165
    v_cvt_pk_bf16_f32 v47, v166, v167
    v_mfma_f32_16x16x32_bf16 v[160:163], v[194:197], v[56:59], v[204:207]
    v_mfma_f32_16x16x32_bf16 v[164:167], v[192:195], v[56:59], v[204:207]
    buffer_load_dwordx4 v252, s[8:11], s26 offen offset:2048 lds
    v_cvt_pk_bf16_f32 v48, v144, v145
    v_cvt_pk_bf16_f32 v49, v146, v147
    v_cvt_pk_bf16_f32 v50, v148, v149
    v_cvt_pk_bf16_f32 v51, v150, v151
    v_mfma_f32_16x16x32_bf16 v[144:147], v[194:197], v[60:63], v[204:207]
    buffer_load_dwordx4 v252, s[8:11], s27 offen offset:3072 lds
    v_mfma_f32_16x16x32_bf16 v[148:151], v[192:195], v[60:63], v[204:207]
    v_cvt_pk_bf16_f32 v52, v152, v153
    v_cvt_pk_bf16_f32 v53, v154, v155
    v_cvt_pk_bf16_f32 v54, v156, v157
    v_cvt_pk_bf16_f32 v55, v158, v159
    s_add_u32 m0, s36, 53248
    s_nop 0
    buffer_load_dwordx4 v252, s[8:11], s28 offen offset:0 lds
    v_mfma_f32_16x16x32_bf16 v[152:155], v[194:197], v[64:67], v[204:207]
    v_mfma_f32_16x16x32_bf16 v[156:159], v[192:195], v[64:67], v[204:207]
    v_cvt_pk_bf16_f32 v56, v160, v161
    v_cvt_pk_bf16_f32 v57, v162, v163
    v_cvt_pk_bf16_f32 v58, v164, v165
    buffer_load_dwordx4 v252, s[8:11], s29 offen offset:1024 lds
    v_cvt_pk_bf16_f32 v59, v166, v167
    v_mfma_f32_16x16x32_bf16 v[160:163], v[194:197], v[68:71], v[204:207]
    v_mfma_f32_16x16x32_bf16 v[164:167], v[192:195], v[68:71], v[204:207]
    v_cvt_pk_bf16_f32 v60, v144, v145
    v_cvt_pk_bf16_f32 v61, v146, v147
    s_add_u32 s8, s8, s46
    s_addc_u32 s9, s9, -1
    v_cvt_pk_bf16_f32 v62, v148, v149
    v_cvt_pk_bf16_f32 v63, v150, v151
    v_cvt_pk_bf16_f32 v64, v152, v153
    v_cvt_pk_bf16_f32 v65, v154, v155
    v_cvt_pk_bf16_f32 v66, v156, v157
    v_cvt_pk_bf16_f32 v67, v158, v159
    v_cvt_pk_bf16_f32 v68, v160, v161
    v_cvt_pk_bf16_f32 v69, v162, v163
    v_cvt_pk_bf16_f32 v70, v164, v165
    v_cvt_pk_bf16_f32 v71, v166, v167
    s_waitcnt vmcnt(18)
    v_add_u32 v178, 73728, v178
    v_add_u32 v179, 73728, v179
    ds_read_b128 v[72:75], v178 offset:0
    ds_read_b128 v[76:79], v179 offset:0
    ds_read_b128 v[80:83], v178 offset:2048
    ds_read_b128 v[84:87], v179 offset:2048
    ds_read_b128 v[88:91], v178 offset:4096
    ds_read_b128 v[92:95], v179 offset:4096
    ds_read_b128 v[96:99], v178 offset:6144
    ds_read_b128 v[100:103], v179 offset:6144
    ds_read_b128 v[104:107], v178 offset:8192
    ds_read_b128 v[108:111], v179 offset:8192
    ds_read_b128 v[112:115], v178 offset:10240
    ds_read_b128 v[116:119], v179 offset:10240
    ds_read_b128 v[120:123], v178 offset:12288
    ds_read_b128 v[124:127], v179 offset:12288
    ds_read_b128 v[128:131], v178 offset:14336
    ds_read_b128 v[132:135], v179 offset:14336
    ds_read_b128 v[136:139], v178 offset:16384
    ds_read_b128 v[140:143], v179 offset:16384
    s_waitcnt lgkmcnt(15)
    v_mfma_f32_16x16x32_bf16 v[204:207], v[200:203], v[72:75], 0
    v_mfma_f32_16x16x32_bf16 v[204:207], v[200:203], v[76:79], v[204:207]
    v_mfma_f32_16x16x32_bf16 v[204:207], v[200:203], v[80:83], v[204:207]
    s_waitcnt lgkmcnt(12)
    v_mfma_f32_16x16x32_bf16 v[204:207], v[200:203], v[84:87], v[204:207]
    v_mfma_f32_16x16x32_bf16 v[204:207], v[200:203], v[88:91], v[204:207]
    v_mfma_f32_16x16x32_bf16 v[204:207], v[200:203], v[92:95], v[204:207]
    s_waitcnt lgkmcnt(9)
    v_mfma_f32_16x16x32_bf16 v[204:207], v[200:203], v[96:99], v[204:207]
    v_mfma_f32_16x16x32_bf16 v[204:207], v[200:203], v[100:103], v[204:207]
    v_mfma_f32_16x16x32_bf16 v[204:207], v[200:203], v[104:107], v[204:207]
    s_waitcnt lgkmcnt(6)
    v_mfma_f32_16x16x32_bf16 v[204:207], v[200:203], v[108:111], v[204:207]
    v_mfma_f32_16x16x32_bf16 v[204:207], v[200:203], v[112:115], v[204:207]
    v_mfma_f32_16x16x32_bf16 v[204:207], v[200:203], v[116:119], v[204:207]
    s_waitcnt lgkmcnt(3)
    v_mfma_f32_16x16x32_bf16 v[204:207], v[200:203], v[120:123], v[204:207]
    v_mfma_f32_16x16x32_bf16 v[204:207], v[200:203], v[124:127], v[204:207]
    v_mfma_f32_16x16x32_bf16 v[204:207], v[200:203], v[128:131], v[204:207]
    s_waitcnt lgkmcnt(0)
    v_mfma_f32_16x16x32_bf16 v[204:207], v[200:203], v[132:135], v[204:207]
    v_mfma_f32_16x16x32_bf16 v[204:207], v[200:203], v[136:139], v[204:207]
    v_mfma_f32_16x16x32_bf16 v[204:207], v[200:203], v[140:143], v[204:207]
    s_barrier
    s_nop 6
    v_mul_f32 v204, 0xbae38e39, v204
    s_add_u32 m0, s36, 73728
    s_nop 0
    buffer_load_dwordx4 v252, s[12:15], s24 offen offset:0 lds
    s_nop 2
    v_mul_f32 v205, 0xbae38e39, v205
    s_nop 1
    v_mul_f32 v206, 0xbae38e39, v206
    s_nop 0
    v_mul_f32 v207, 0xbae38e39, v207
    s_nop 1
    v_mfma_f32_16x16x32_bf16 v[144:147], v[194:197], v[72:75], v[204:207]
    buffer_load_dwordx4 v252, s[12:15], s25 offen offset:1024 lds
    v_mfma_f32_16x16x32_bf16 v[148:151], v[192:195], v[72:75], v[204:207]
    v_mfma_f32_16x16x32_bf16 v[152:155], v[194:197], v[76:79], v[204:207]
    v_mfma_f32_16x16x32_bf16 v[156:159], v[192:195], v[76:79], v[204:207]
    v_mfma_f32_16x16x32_bf16 v[160:163], v[194:197], v[80:83], v[204:207]
    buffer_load_dwordx4 v252, s[12:15], s26 offen offset:2048 lds
    v_mfma_f32_16x16x32_bf16 v[164:167], v[192:195], v[80:83], v[204:207]
    s_nop 0
    v_cvt_pk_bf16_f32 v72, v144, v145
    v_cvt_pk_bf16_f32 v73, v146, v147
    s_nop 0
    v_cvt_pk_bf16_f32 v74, v148, v149
    buffer_load_dwordx4 v252, s[12:15], s27 offen offset:3072 lds
    v_cvt_pk_bf16_f32 v75, v150, v151
    v_mfma_f32_16x16x32_bf16 v[144:147], v[194:197], v[84:87], v[204:207]
    v_mfma_f32_16x16x32_bf16 v[148:151], v[192:195], v[84:87], v[204:207]
    v_cvt_pk_bf16_f32 v76, v152, v153
    v_cvt_pk_bf16_f32 v77, v154, v155
    s_add_u32 m0, s36, 77824
    s_nop 0
    buffer_load_dwordx4 v252, s[12:15], s28 offen offset:0 lds
    v_cvt_pk_bf16_f32 v78, v156, v157
    v_cvt_pk_bf16_f32 v79, v158, v159
    v_mfma_f32_16x16x32_bf16 v[152:155], v[194:197], v[88:91], v[204:207]
    v_mfma_f32_16x16x32_bf16 v[156:159], v[192:195], v[88:91], v[204:207]
    buffer_load_dwordx4 v252, s[12:15], s29 offen offset:1024 lds
    v_cvt_pk_bf16_f32 v80, v160, v161
    v_cvt_pk_bf16_f32 v81, v162, v163
    v_cvt_pk_bf16_f32 v82, v164, v165
    v_cvt_pk_bf16_f32 v83, v166, v167
    s_add_u32 s12, s12, 1769472
    s_addc_u32 s13, s13, 0
    v_mfma_f32_16x16x32_bf16 v[160:163], v[194:197], v[92:95], v[204:207]
    v_mfma_f32_16x16x32_bf16 v[164:167], v[192:195], v[92:95], v[204:207]
    v_cvt_pk_bf16_f32 v84, v144, v145
    v_cvt_pk_bf16_f32 v85, v146, v147
    v_cvt_pk_bf16_f32 v86, v148, v149
    v_accvgpr_write_b32 a0, v0
    v_accvgpr_write_b32 a1, v1
    v_accvgpr_write_b32 a2, v2
    v_accvgpr_write_b32 a3, v3
    v_cvt_pk_bf16_f32 v87, v150, v151
    v_mfma_f32_16x16x32_bf16 v[144:147], v[194:197], v[96:99], v[204:207]
    v_mfma_f32_16x16x32_bf16 v[148:151], v[192:195], v[96:99], v[204:207]
    v_cvt_pk_bf16_f32 v88, v152, v153
    v_accvgpr_write_b32 a4, v4
    v_accvgpr_write_b32 a5, v5
    v_accvgpr_write_b32 a6, v6
    v_accvgpr_write_b32 a7, v7
    v_cvt_pk_bf16_f32 v89, v154, v155
    v_cvt_pk_bf16_f32 v90, v156, v157
    v_cvt_pk_bf16_f32 v91, v158, v159
    v_mfma_f32_16x16x32_bf16 v[152:155], v[194:197], v[100:103], v[204:207]
    v_accvgpr_write_b32 a8, v8
    v_accvgpr_write_b32 a9, v9
    v_accvgpr_write_b32 a10, v10
    v_accvgpr_write_b32 a11, v11
    v_mfma_f32_16x16x32_bf16 v[156:159], v[192:195], v[100:103], v[204:207]
    v_cvt_pk_bf16_f32 v92, v160, v161
    v_cvt_pk_bf16_f32 v93, v162, v163
    v_cvt_pk_bf16_f32 v94, v164, v165
    v_cvt_pk_bf16_f32 v95, v166, v167
    v_accvgpr_write_b32 a12, v12
    v_accvgpr_write_b32 a13, v13
    v_accvgpr_write_b32 a14, v14
    v_accvgpr_write_b32 a15, v15
    v_mfma_f32_16x16x32_bf16 v[160:163], v[194:197], v[104:107], v[204:207]
    v_mfma_f32_16x16x32_bf16 v[164:167], v[192:195], v[104:107], v[204:207]
    v_cvt_pk_bf16_f32 v96, v144, v145
    v_cvt_pk_bf16_f32 v97, v146, v147
    v_accvgpr_write_b32 a16, v16
    v_accvgpr_write_b32 a17, v17
    v_accvgpr_write_b32 a18, v18
    v_accvgpr_write_b32 a19, v19
    v_cvt_pk_bf16_f32 v98, v148, v149
    v_cvt_pk_bf16_f32 v99, v150, v151
    v_mfma_f32_16x16x32_bf16 v[144:147], v[194:197], v[108:111], v[204:207]
    v_mfma_f32_16x16x32_bf16 v[148:151], v[192:195], v[108:111], v[204:207]
    v_accvgpr_write_b32 a20, v20
    v_accvgpr_write_b32 a21, v21
    v_accvgpr_write_b32 a22, v22
    v_accvgpr_write_b32 a23, v23
    v_cvt_pk_bf16_f32 v100, v152, v153
    v_cvt_pk_bf16_f32 v101, v154, v155
    v_cvt_pk_bf16_f32 v102, v156, v157
    v_cvt_pk_bf16_f32 v103, v158, v159
    v_accvgpr_write_b32 a24, v24
    v_accvgpr_write_b32 a25, v25
    v_accvgpr_write_b32 a26, v26
    v_accvgpr_write_b32 a27, v27
    v_mfma_f32_16x16x32_bf16 v[152:155], v[194:197], v[112:115], v[204:207]
    v_mfma_f32_16x16x32_bf16 v[156:159], v[192:195], v[112:115], v[204:207]
    v_cvt_pk_bf16_f32 v104, v160, v161
    v_cvt_pk_bf16_f32 v105, v162, v163
    v_cvt_pk_bf16_f32 v106, v164, v165
    v_accvgpr_write_b32 a28, v28
    v_accvgpr_write_b32 a29, v29
    v_accvgpr_write_b32 a30, v30
    v_accvgpr_write_b32 a31, v31
    v_cvt_pk_bf16_f32 v107, v166, v167
    v_mfma_f32_16x16x32_bf16 v[160:163], v[194:197], v[116:119], v[204:207]
    v_mfma_f32_16x16x32_bf16 v[164:167], v[192:195], v[116:119], v[204:207]
    v_cvt_pk_bf16_f32 v108, v144, v145
    v_accvgpr_write_b32 a32, v32
    v_accvgpr_write_b32 a33, v33
    v_accvgpr_write_b32 a34, v34
    v_accvgpr_write_b32 a35, v35
    v_cvt_pk_bf16_f32 v109, v146, v147
    v_cvt_pk_bf16_f32 v110, v148, v149
    v_cvt_pk_bf16_f32 v111, v150, v151
    v_mfma_f32_16x16x32_bf16 v[144:147], v[194:197], v[120:123], v[204:207]
    v_accvgpr_write_b32 a36, v36
    v_accvgpr_write_b32 a37, v37
    v_accvgpr_write_b32 a38, v38
    v_accvgpr_write_b32 a39, v39
    v_mfma_f32_16x16x32_bf16 v[148:151], v[192:195], v[120:123], v[204:207]
    v_cvt_pk_bf16_f32 v112, v152, v153
    v_cvt_pk_bf16_f32 v113, v154, v155
    v_cvt_pk_bf16_f32 v114, v156, v157
    v_cvt_pk_bf16_f32 v115, v158, v159
    v_accvgpr_write_b32 a40, v40
    v_accvgpr_write_b32 a41, v41
    v_accvgpr_write_b32 a42, v42
    v_accvgpr_write_b32 a43, v43
    v_mfma_f32_16x16x32_bf16 v[152:155], v[194:197], v[124:127], v[204:207]
    v_mfma_f32_16x16x32_bf16 v[156:159], v[192:195], v[124:127], v[204:207]
    v_cvt_pk_bf16_f32 v116, v160, v161
    v_cvt_pk_bf16_f32 v117, v162, v163
    v_accvgpr_write_b32 a44, v44
    v_accvgpr_write_b32 a45, v45
    v_accvgpr_write_b32 a46, v46
    v_accvgpr_write_b32 a47, v47
    v_cvt_pk_bf16_f32 v118, v164, v165
    v_cvt_pk_bf16_f32 v119, v166, v167
    v_mfma_f32_16x16x32_bf16 v[160:163], v[194:197], v[128:131], v[204:207]
    v_mfma_f32_16x16x32_bf16 v[164:167], v[192:195], v[128:131], v[204:207]
    v_accvgpr_write_b32 a48, v48
    v_accvgpr_write_b32 a49, v49
    v_accvgpr_write_b32 a50, v50
    v_accvgpr_write_b32 a51, v51
    v_cvt_pk_bf16_f32 v120, v144, v145
    v_cvt_pk_bf16_f32 v121, v146, v147
    v_cvt_pk_bf16_f32 v122, v148, v149
    v_cvt_pk_bf16_f32 v123, v150, v151
    v_mfma_f32_16x16x32_bf16 v[144:147], v[194:197], v[132:135], v[204:207]
    v_accvgpr_write_b32 a52, v52
    v_accvgpr_write_b32 a53, v53
    v_accvgpr_write_b32 a54, v54
    v_accvgpr_write_b32 a55, v55
    v_mfma_f32_16x16x32_bf16 v[148:151], v[192:195], v[132:135], v[204:207]
    v_cvt_pk_bf16_f32 v124, v152, v153
    v_cvt_pk_bf16_f32 v125, v154, v155
    v_cvt_pk_bf16_f32 v126, v156, v157
    v_accvgpr_write_b32 a56, v56
    v_accvgpr_write_b32 a57, v57
    v_accvgpr_write_b32 a58, v58
    v_accvgpr_write_b32 a59, v59
    v_cvt_pk_bf16_f32 v127, v158, v159
    v_mfma_f32_16x16x32_bf16 v[152:155], v[194:197], v[136:139], v[204:207]
    v_mfma_f32_16x16x32_bf16 v[156:159], v[192:195], v[136:139], v[204:207]
    v_cvt_pk_bf16_f32 v128, v160, v161
    v_accvgpr_write_b32 a60, v60
    v_accvgpr_write_b32 a61, v61
    v_accvgpr_write_b32 a62, v62
    v_accvgpr_write_b32 a63, v63
    v_cvt_pk_bf16_f32 v129, v162, v163
    v_cvt_pk_bf16_f32 v130, v164, v165
    v_cvt_pk_bf16_f32 v131, v166, v167
    v_mfma_f32_16x16x32_bf16 v[160:163], v[194:197], v[140:143], v[204:207]
    v_mfma_f32_16x16x32_bf16 v[164:167], v[192:195], v[140:143], v[204:207]
    v_accvgpr_write_b32 a64, v64
    v_accvgpr_write_b32 a65, v65
    v_accvgpr_write_b32 a66, v66
    v_accvgpr_write_b32 a67, v67
    v_cvt_pk_bf16_f32 v132, v144, v145
    v_cvt_pk_bf16_f32 v133, v146, v147
    v_cvt_pk_bf16_f32 v134, v148, v149
    v_cvt_pk_bf16_f32 v135, v150, v151
    v_accvgpr_write_b32 a68, v68
    v_accvgpr_write_b32 a69, v69
    v_accvgpr_write_b32 a70, v70
    v_accvgpr_write_b32 a71, v71
    v_cvt_pk_bf16_f32 v136, v152, v153
    v_cvt_pk_bf16_f32 v137, v154, v155
    v_cvt_pk_bf16_f32 v138, v156, v157
    v_cvt_pk_bf16_f32 v139, v158, v159
    v_cvt_pk_bf16_f32 v140, v160, v161
    v_cvt_pk_bf16_f32 v141, v162, v163
    v_cvt_pk_bf16_f32 v142, v164, v165
    v_cvt_pk_bf16_f32 v143, v166, v167
    v_accvgpr_write_b32 a72, v72
    v_accvgpr_write_b32 a73, v73
    v_accvgpr_write_b32 a74, v74
    v_accvgpr_write_b32 a75, v75
    v_accvgpr_write_b32 a76, v76
    v_accvgpr_write_b32 a77, v77
    v_accvgpr_write_b32 a78, v78
    v_accvgpr_write_b32 a79, v79
    v_accvgpr_write_b32 a80, v80
    v_accvgpr_write_b32 a81, v81
    v_accvgpr_write_b32 a82, v82
    v_accvgpr_write_b32 a83, v83
    v_accvgpr_write_b32 a84, v84
    v_accvgpr_write_b32 a85, v85
    v_accvgpr_write_b32 a86, v86
    v_accvgpr_write_b32 a87, v87
    v_accvgpr_write_b32 a88, v88
    v_accvgpr_write_b32 a89, v89
    v_accvgpr_write_b32 a90, v90
    v_accvgpr_write_b32 a91, v91
    v_accvgpr_write_b32 a92, v92
    v_accvgpr_write_b32 a93, v93
    v_accvgpr_write_b32 a94, v94
    v_accvgpr_write_b32 a95, v95
    v_accvgpr_write_b32 a96, v96
    v_accvgpr_write_b32 a97, v97
    v_accvgpr_write_b32 a98, v98
    v_accvgpr_write_b32 a99, v99
    v_accvgpr_write_b32 a100, v100
    v_accvgpr_write_b32 a101, v101
    v_accvgpr_write_b32 a102, v102
    v_accvgpr_write_b32 a103, v103
    v_accvgpr_write_b32 a104, v104
    v_accvgpr_write_b32 a105, v105
    v_accvgpr_write_b32 a106, v106
    v_accvgpr_write_b32 a107, v107
    v_accvgpr_write_b32 a108, v108
    v_accvgpr_write_b32 a109, v109
    v_accvgpr_write_b32 a110, v110
    v_accvgpr_write_b32 a111, v111
    v_accvgpr_write_b32 a112, v112
    v_accvgpr_write_b32 a113, v113
    v_accvgpr_write_b32 a114, v114
    v_accvgpr_write_b32 a115, v115
    v_accvgpr_write_b32 a116, v116
    v_accvgpr_write_b32 a117, v117
    v_accvgpr_write_b32 a118, v118
    v_accvgpr_write_b32 a119, v119
    v_accvgpr_write_b32 a120, v120
    v_accvgpr_write_b32 a121, v121
    v_accvgpr_write_b32 a122, v122
    v_accvgpr_write_b32 a123, v123
    v_accvgpr_write_b32 a124, v124
    v_accvgpr_write_b32 a125, v125
    v_accvgpr_write_b32 a126, v126
    v_accvgpr_write_b32 a127, v127
    v_accvgpr_write_b32 a128, v128
    v_accvgpr_write_b32 a129, v129
    v_accvgpr_write_b32 a130, v130
    v_accvgpr_write_b32 a131, v131
    v_accvgpr_write_b32 a132, v132
    v_accvgpr_write_b32 a133, v133
    v_accvgpr_write_b32 a134, v134
    v_accvgpr_write_b32 a135, v135
    v_accvgpr_write_b32 a136, v136
    v_accvgpr_write_b32 a137, v137
    v_accvgpr_write_b32 a138, v138
    v_accvgpr_write_b32 a139, v139
    v_accvgpr_write_b32 a140, v140
    v_accvgpr_write_b32 a141, v141
    v_accvgpr_write_b32 a142, v142
    v_accvgpr_write_b32 a143, v143
    s_load_dwordx2 s[4:5], s[0:1], 64
    s_mul_i32 s42, s45, 2359296
    s_lshl_b32 s40, s44, 2
    s_add_u32 s40, s40, s37
    s_mul_i32 s40, s40, 36864
    s_add_u32 s42, s42, s40
    s_add_u32 s50, s42, 10098688
    s_add_u32 s51, s50, 18432
    s_mov_b32 s48, 221184
    s_mov_b32 s49, 442240
    s_mov_b32 s39, 128
    s_mov_b32 s38, 0
    s_waitcnt vmcnt(18) lgkmcnt(0)
    s_mov_b32 s6, 256
    s_mov_b32 s7, 0x00020000
    s_barrier
    ds_read_b64_tr_b16 v[192:193], v248 offset:0
    ds_read_b64_tr_b16 v[194:195], v248 offset:2048
    ds_read_b64_tr_b16 v[196:197], v249 offset:0
    ds_read_b64_tr_b16 v[198:199], v249 offset:2048
    ds_read_b64_tr_b16 v[200:201], v248 offset:4096
    ds_read_b64_tr_b16 v[202:203], v248 offset:6144
    ds_read_b64_tr_b16 v[204:205], v249 offset:4096
    ds_read_b64_tr_b16 v[206:207], v249 offset:6144
    ds_read_b64_tr_b16 v[208:209], v248 offset:8192
    ds_read_b64_tr_b16 v[210:211], v248 offset:10240
.p2align 6
L_mlp_p1_1044:
    s_waitcnt lgkmcnt(6)
    v_mfma_f32_16x16x32_bf16 v[144:147], v[192:195], a[0:3], 0
    ds_read_b64_tr_b16 v[212:213], v249 offset:8192
    v_lshlrev_b32 v254, 16, v180
    v_and_b32 v255, s43, v180
    v_mfma_f32_16x16x32_bf16 v[148:151], v[192:195], a[72:75], 0
    ds_read_b64_tr_b16 v[214:215], v249 offset:10240
    v_mul_f32 v160, v160, v254
    v_mul_f32 v161, v161, v255
    v_mfma_f32_16x16x32_bf16 v[152:155], v[196:199], a[0:3], 0
    ds_read_b64_tr_b16 v[192:193], v248 offset:12288
    v_cvt_pk_bf16_f32 v180, v160, v161
    v_lshlrev_b32 v254, 16, v181
    v_mfma_f32_16x16x32_bf16 v[156:159], v[196:199], a[72:75], 0
    ds_read_b64_tr_b16 v[194:195], v248 offset:14336
    v_and_b32 v255, s43, v181
    s_waitcnt lgkmcnt(6)
    v_mfma_f32_16x16x32_bf16 v[144:147], v[200:203], a[4:7], v[144:147]
    ds_read_b64_tr_b16 v[196:197], v249 offset:12288
    v_mul_f32 v162, v162, v254
    v_mul_f32 v163, v163, v255
    v_mfma_f32_16x16x32_bf16 v[148:151], v[200:203], a[76:79], v[148:151]
    ds_read_b64_tr_b16 v[198:199], v249 offset:14336
    v_cvt_pk_bf16_f32 v181, v162, v163
    v_lshlrev_b32 v254, 16, v188
    v_mfma_f32_16x16x32_bf16 v[152:155], v[204:207], a[4:7], v[152:155]
    ds_read_b64_tr_b16 v[200:201], v248 offset:16384
    v_and_b32 v255, s43, v188
    v_mul_f32 v164, v164, v254
    v_mfma_f32_16x16x32_bf16 v[156:159], v[204:207], a[76:79], v[156:159]
    ds_read_b64_tr_b16 v[202:203], v248 offset:18432
    v_mul_f32 v165, v165, v255
    s_waitcnt lgkmcnt(6)
    v_mfma_f32_16x16x32_bf16 v[144:147], v[208:211], a[8:11], v[144:147]
    ds_read_b64_tr_b16 v[204:205], v249 offset:16384
    v_cvt_pk_bf16_f32 v188, v164, v165
    v_lshlrev_b32 v254, 16, v189
    v_mfma_f32_16x16x32_bf16 v[148:151], v[208:211], a[80:83], v[148:151]
    ds_read_b64_tr_b16 v[206:207], v249 offset:18432
    v_and_b32 v255, s43, v189
    v_mul_f32 v166, v166, v254
    v_mfma_f32_16x16x32_bf16 v[152:155], v[212:215], a[8:11], v[152:155]
    ds_read_b64_tr_b16 v[208:209], v248 offset:20480
    v_mul_f32 v167, v167, v255
    v_cvt_pk_bf16_f32 v189, v166, v167
    v_mfma_f32_16x16x32_bf16 v[156:159], v[212:215], a[80:83], v[156:159]
    ds_read_b64_tr_b16 v[210:211], v248 offset:22528
    s_waitcnt lgkmcnt(6)
    v_mfma_f32_16x16x32_bf16 v[144:147], v[192:195], a[12:15], v[144:147]
    ds_read_b64_tr_b16 v[212:213], v249 offset:20480
    v_lshlrev_b32 v254, 16, v182
    v_and_b32 v255, s43, v182
    v_mfma_f32_16x16x32_bf16 v[148:151], v[192:195], a[84:87], v[148:151]
    ds_read_b64_tr_b16 v[214:215], v249 offset:22528
    v_mul_f32 v168, v168, v254
    v_mul_f32 v169, v169, v255
    v_mfma_f32_16x16x32_bf16 v[152:155], v[196:199], a[12:15], v[152:155]
    ds_read_b64_tr_b16 v[192:193], v250 offset:0
    v_cvt_pk_bf16_f32 v182, v168, v169
    v_lshlrev_b32 v254, 16, v183
    v_mfma_f32_16x16x32_bf16 v[156:159], v[196:199], a[84:87], v[156:159]
    ds_read_b64_tr_b16 v[194:195], v250 offset:2048
    v_and_b32 v255, s43, v183
    s_waitcnt lgkmcnt(6)
    v_mfma_f32_16x16x32_bf16 v[144:147], v[200:203], a[16:19], v[144:147]
    ds_read_b64_tr_b16 v[196:197], v251 offset:0
    v_mul_f32 v170, v170, v254
    v_mul_f32 v171, v171, v255
    v_mfma_f32_16x16x32_bf16 v[148:151], v[200:203], a[88:91], v[148:151]
    ds_read_b64_tr_b16 v[198:199], v251 offset:2048
    v_cvt_pk_bf16_f32 v183, v170, v171
    v_lshlrev_b32 v254, 16, v190
    v_mfma_f32_16x16x32_bf16 v[152:155], v[204:207], a[16:19], v[152:155]
    ds_read_b64_tr_b16 v[200:201], v250 offset:4096
    v_and_b32 v255, s43, v190
    v_mul_f32 v172, v172, v254
    v_mfma_f32_16x16x32_bf16 v[156:159], v[204:207], a[88:91], v[156:159]
    ds_read_b64_tr_b16 v[202:203], v250 offset:6144
    v_mul_f32 v173, v173, v255
    s_waitcnt lgkmcnt(6)
    v_mfma_f32_16x16x32_bf16 v[144:147], v[208:211], a[20:23], v[144:147]
    ds_read_b64_tr_b16 v[204:205], v251 offset:4096
    v_cvt_pk_bf16_f32 v190, v172, v173
    v_lshlrev_b32 v254, 16, v191
    v_mfma_f32_16x16x32_bf16 v[148:151], v[208:211], a[92:95], v[148:151]
    ds_read_b64_tr_b16 v[206:207], v251 offset:6144
    v_and_b32 v255, s43, v191
    v_mul_f32 v174, v174, v254
    v_mfma_f32_16x16x32_bf16 v[152:155], v[212:215], a[20:23], v[152:155]
    ds_read_b64_tr_b16 v[208:209], v250 offset:8192
    v_mul_f32 v175, v175, v255
    v_cvt_pk_bf16_f32 v191, v174, v175
    v_mfma_f32_16x16x32_bf16 v[156:159], v[212:215], a[92:95], v[156:159]
    ds_read_b64_tr_b16 v[210:211], v250 offset:10240
    s_waitcnt lgkmcnt(6)
    v_mfma_f32_16x16x32_bf16 v[160:163], v[192:195], a[0:3], 0
    ds_read_b64_tr_b16 v[212:213], v251 offset:8192
    s_add_u32 m0, s36, 98304
    v_mfma_f32_16x16x32_bf16 v[164:167], v[192:195], a[72:75], 0
    ds_read_b64_tr_b16 v[214:215], v251 offset:10240
    buffer_load_dwordx4 v252, s[12:15], s24 offen offset:0 lds
    v_mfma_f32_16x16x32_bf16 v[168:171], v[196:199], a[0:3], 0
    ds_read_b64_tr_b16 v[192:193], v250 offset:12288
    buffer_load_dwordx4 v252, s[12:15], s25 offen offset:1024 lds
    v_mfma_f32_16x16x32_bf16 v[172:175], v[196:199], a[72:75], 0
    ds_read_b64_tr_b16 v[194:195], v250 offset:14336
    s_waitcnt lgkmcnt(6)
    v_mfma_f32_16x16x32_bf16 v[160:163], v[200:203], a[4:7], v[160:163]
    ds_read_b64_tr_b16 v[196:197], v251 offset:12288
    buffer_load_dwordx4 v252, s[12:15], s26 offen offset:2048 lds
    v_mfma_f32_16x16x32_bf16 v[164:167], v[200:203], a[76:79], v[164:167]
    ds_read_b64_tr_b16 v[198:199], v251 offset:14336
    buffer_load_dwordx4 v252, s[12:15], s27 offen offset:3072 lds
    v_mfma_f32_16x16x32_bf16 v[168:171], v[204:207], a[4:7], v[168:171]
    ds_read_b64_tr_b16 v[200:201], v250 offset:16384
    s_add_u32 m0, s36, 102400
    v_mfma_f32_16x16x32_bf16 v[172:175], v[204:207], a[76:79], v[172:175]
    ds_read_b64_tr_b16 v[202:203], v250 offset:18432
    s_waitcnt lgkmcnt(6)
    v_mfma_f32_16x16x32_bf16 v[160:163], v[208:211], a[8:11], v[160:163]
    ds_read_b64_tr_b16 v[204:205], v251 offset:16384
    buffer_load_dwordx4 v252, s[12:15], s28 offen offset:0 lds
    v_mfma_f32_16x16x32_bf16 v[164:167], v[208:211], a[80:83], v[164:167]
    ds_read_b64_tr_b16 v[206:207], v251 offset:18432
    buffer_load_dwordx4 v252, s[12:15], s29 offen offset:1024 lds
    v_mfma_f32_16x16x32_bf16 v[168:171], v[212:215], a[8:11], v[168:171]
    ds_read_b64_tr_b16 v[208:209], v250 offset:20480
    s_add_u32 s12, s12, 1769472
    s_addc_u32 s13, s13, 0
    v_mfma_f32_16x16x32_bf16 v[172:175], v[212:215], a[80:83], v[172:175]
    ds_read_b64_tr_b16 v[210:211], v250 offset:22528
    s_waitcnt lgkmcnt(6)
    v_mfma_f32_16x16x32_bf16 v[160:163], v[192:195], a[12:15], v[160:163]
    ds_read_b64_tr_b16 v[212:213], v251 offset:20480
    v_mfma_f32_16x16x32_bf16 v[164:167], v[192:195], a[84:87], v[164:167]
    ds_read_b64_tr_b16 v[214:215], v251 offset:22528
    s_waitcnt vmcnt(18)
    s_barrier
    s_set_gpr_idx_on s39, gpr_idx(DST)
    s_nop 0
    v_mov_b32 v0, v176
    v_mov_b32 v1, v177
    v_mov_b32 v2, v178
    v_mov_b32 v3, v179
    v_mov_b32 v4, v180
    v_mov_b32 v5, v181
    v_mov_b32 v6, v182
    v_mov_b32 v7, v183
    s_set_gpr_idx_off
    v_mfma_f32_16x16x32_bf16 v[168:171], v[196:199], a[12:15], v[168:171]
    ds_read_b64_tr_b16 v[192:193], v248 offset:24576
    v_mfma_f32_16x16x32_bf16 v[172:175], v[196:199], a[84:87], v[172:175]
    ds_read_b64_tr_b16 v[194:195], v248 offset:26624
    s_waitcnt lgkmcnt(6)
    v_mfma_f32_16x16x32_bf16 v[160:163], v[200:203], a[16:19], v[160:163]
    ds_read_b64_tr_b16 v[196:197], v249 offset:24576
    s_add_u32 m0, s36, 122880
    v_mfma_f32_16x16x32_bf16 v[164:167], v[200:203], a[88:91], v[164:167]
    ds_read_b64_tr_b16 v[198:199], v249 offset:26624
    buffer_load_dwordx4 v252, s[12:15], s24 offen offset:0 lds
    v_mfma_f32_16x16x32_bf16 v[168:171], v[204:207], a[16:19], v[168:171]
    ds_read_b64_tr_b16 v[200:201], v248 offset:28672
    v_mfma_f32_16x16x32_bf16 v[172:175], v[204:207], a[88:91], v[172:175]
    ds_read_b64_tr_b16 v[202:203], v248 offset:30720
    s_waitcnt lgkmcnt(6)
    v_mfma_f32_16x16x32_bf16 v[160:163], v[208:211], a[20:23], v[160:163]
    ds_read_b64_tr_b16 v[204:205], v249 offset:28672
    v_mfma_f32_16x16x32_bf16 v[164:167], v[208:211], a[92:95], v[164:167]
    ds_read_b64_tr_b16 v[206:207], v249 offset:30720
    v_mfma_f32_16x16x32_bf16 v[168:171], v[212:215], a[20:23], v[168:171]
    ds_read_b64_tr_b16 v[208:209], v248 offset:32768
    v_mfma_f32_16x16x32_bf16 v[172:175], v[212:215], a[92:95], v[172:175]
    ds_read_b64_tr_b16 v[210:211], v248 offset:34816
    s_waitcnt lgkmcnt(6)
    v_mfma_f32_16x16x32_bf16 v[144:147], v[192:195], a[24:27], v[144:147]
    ds_read_b64_tr_b16 v[212:213], v249 offset:32768
    buffer_load_dwordx4 v252, s[12:15], s25 offen offset:1024 lds
    v_mfma_f32_16x16x32_bf16 v[148:151], v[192:195], a[96:99], v[148:151]
    ds_read_b64_tr_b16 v[214:215], v249 offset:34816
    v_mfma_f32_16x16x32_bf16 v[152:155], v[196:199], a[24:27], v[152:155]
    ds_read_b64_tr_b16 v[192:193], v248 offset:36864
    v_mfma_f32_16x16x32_bf16 v[156:159], v[196:199], a[96:99], v[156:159]
    ds_read_b64_tr_b16 v[194:195], v248 offset:38912
    s_waitcnt lgkmcnt(6)
    v_mfma_f32_16x16x32_bf16 v[144:147], v[200:203], a[28:31], v[144:147]
    ds_read_b64_tr_b16 v[196:197], v249 offset:36864
    v_mfma_f32_16x16x32_bf16 v[148:151], v[200:203], a[100:103], v[148:151]
    ds_read_b64_tr_b16 v[198:199], v249 offset:38912
    v_mfma_f32_16x16x32_bf16 v[152:155], v[204:207], a[28:31], v[152:155]
    ds_read_b64_tr_b16 v[200:201], v248 offset:40960
    buffer_load_dwordx4 v252, s[12:15], s26 offen offset:2048 lds
    v_mfma_f32_16x16x32_bf16 v[156:159], v[204:207], a[100:103], v[156:159]
    ds_read_b64_tr_b16 v[202:203], v248 offset:43008
    s_waitcnt lgkmcnt(6)
    v_mfma_f32_16x16x32_bf16 v[144:147], v[208:211], a[32:35], v[144:147]
    ds_read_b64_tr_b16 v[204:205], v249 offset:40960
    v_mfma_f32_16x16x32_bf16 v[148:151], v[208:211], a[104:107], v[148:151]
    ds_read_b64_tr_b16 v[206:207], v249 offset:43008
    v_mfma_f32_16x16x32_bf16 v[152:155], v[212:215], a[32:35], v[152:155]
    ds_read_b64_tr_b16 v[208:209], v248 offset:45056
    v_mfma_f32_16x16x32_bf16 v[156:159], v[212:215], a[104:107], v[156:159]
    ds_read_b64_tr_b16 v[210:211], v248 offset:47104
    v_add_u32 v248, 0xc000, v248
    s_waitcnt lgkmcnt(6)
    v_mfma_f32_16x16x32_bf16 v[144:147], v[192:195], a[36:39], v[144:147]
    ds_read_b64_tr_b16 v[212:213], v249 offset:45056
    v_mfma_f32_16x16x32_bf16 v[148:151], v[192:195], a[108:111], v[148:151]
    ds_read_b64_tr_b16 v[214:215], v249 offset:47104
    v_add_u32 v249, 0xc000, v249
    v_mfma_f32_16x16x32_bf16 v[152:155], v[196:199], a[36:39], v[152:155]
    ds_read_b64_tr_b16 v[192:193], v250 offset:24576
    v_mfma_f32_16x16x32_bf16 v[156:159], v[196:199], a[108:111], v[156:159]
    ds_read_b64_tr_b16 v[194:195], v250 offset:26624
    s_waitcnt lgkmcnt(6)
    v_mfma_f32_16x16x32_bf16 v[144:147], v[200:203], a[40:43], v[144:147]
    ds_read_b64_tr_b16 v[196:197], v251 offset:24576
    buffer_load_dwordx4 v252, s[12:15], s27 offen offset:3072 lds
    v_mfma_f32_16x16x32_bf16 v[148:151], v[200:203], a[112:115], v[148:151]
    ds_read_b64_tr_b16 v[198:199], v251 offset:26624
    v_mfma_f32_16x16x32_bf16 v[152:155], v[204:207], a[40:43], v[152:155]
    ds_read_b64_tr_b16 v[200:201], v250 offset:28672
    v_mfma_f32_16x16x32_bf16 v[156:159], v[204:207], a[112:115], v[156:159]
    ds_read_b64_tr_b16 v[202:203], v250 offset:30720
    s_waitcnt lgkmcnt(6)
    v_mfma_f32_16x16x32_bf16 v[144:147], v[208:211], a[44:47], v[144:147]
    ds_read_b64_tr_b16 v[204:205], v251 offset:28672
    v_mfma_f32_16x16x32_bf16 v[148:151], v[208:211], a[116:119], v[148:151]
    ds_read_b64_tr_b16 v[206:207], v251 offset:30720
    s_add_u32 m0, s36, 126976
    v_mfma_f32_16x16x32_bf16 v[152:155], v[212:215], a[44:47], v[152:155]
    ds_read_b64_tr_b16 v[208:209], v250 offset:32768
    buffer_load_dwordx4 v252, s[12:15], s28 offen offset:0 lds
    v_mfma_f32_16x16x32_bf16 v[156:159], v[212:215], a[116:119], v[156:159]
    ds_read_b64_tr_b16 v[210:211], v250 offset:34816
    s_waitcnt lgkmcnt(6)
    v_mfma_f32_16x16x32_bf16 v[160:163], v[192:195], a[24:27], v[160:163]
    ds_read_b64_tr_b16 v[212:213], v251 offset:32768
    v_mfma_f32_16x16x32_bf16 v[164:167], v[192:195], a[96:99], v[164:167]
    ds_read_b64_tr_b16 v[214:215], v251 offset:34816
    v_mfma_f32_16x16x32_bf16 v[168:171], v[196:199], a[24:27], v[168:171]
    ds_read_b64_tr_b16 v[192:193], v250 offset:36864
    v_mfma_f32_16x16x32_bf16 v[172:175], v[196:199], a[96:99], v[172:175]
    ds_read_b64_tr_b16 v[194:195], v250 offset:38912
    s_waitcnt lgkmcnt(6)
    v_mfma_f32_16x16x32_bf16 v[160:163], v[200:203], a[28:31], v[160:163]
    ds_read_b64_tr_b16 v[196:197], v251 offset:36864
    v_mfma_f32_16x16x32_bf16 v[164:167], v[200:203], a[100:103], v[164:167]
    ds_read_b64_tr_b16 v[198:199], v251 offset:38912
    buffer_load_dwordx4 v252, s[12:15], s29 offen offset:1024 lds
    v_mfma_f32_16x16x32_bf16 v[168:171], v[204:207], a[28:31], v[168:171]
    ds_read_b64_tr_b16 v[200:201], v250 offset:40960
    s_add_u32 s12, s12, s46
    s_addc_u32 s13, s13, -1
    v_mfma_f32_16x16x32_bf16 v[172:175], v[204:207], a[100:103], v[172:175]
    ds_read_b64_tr_b16 v[202:203], v250 offset:43008
    s_waitcnt lgkmcnt(6)
    v_mfma_f32_16x16x32_bf16 v[160:163], v[208:211], a[32:35], v[160:163]
    ds_read_b64_tr_b16 v[204:205], v251 offset:40960
    v_mfma_f32_16x16x32_bf16 v[164:167], v[208:211], a[104:107], v[164:167]
    ds_read_b64_tr_b16 v[206:207], v251 offset:43008
    v_mfma_f32_16x16x32_bf16 v[168:171], v[212:215], a[32:35], v[168:171]
    ds_read_b64_tr_b16 v[208:209], v250 offset:45056
    v_mfma_f32_16x16x32_bf16 v[172:175], v[212:215], a[104:107], v[172:175]
    ds_read_b64_tr_b16 v[210:211], v250 offset:47104
    v_add_u32 v250, 0xc000, v250
    s_waitcnt lgkmcnt(6)
    v_mfma_f32_16x16x32_bf16 v[160:163], v[192:195], a[36:39], v[160:163]
    ds_read_b64_tr_b16 v[212:213], v251 offset:45056
    v_mfma_f32_16x16x32_bf16 v[164:167], v[192:195], a[108:111], v[164:167]
    ds_read_b64_tr_b16 v[214:215], v251 offset:47104
    v_add_u32 v251, 0xc000, v251
    s_waitcnt vmcnt(18)
    s_barrier
    s_set_gpr_idx_on s39, gpr_idx(DST)
    s_nop 0
    v_mov_b32 v8, v184
    v_mov_b32 v9, v185
    v_mov_b32 v10, v186
    v_mov_b32 v11, v187
    v_mov_b32 v12, v188
    v_mov_b32 v13, v189
    v_mov_b32 v14, v190
    v_mov_b32 v15, v191
    s_set_gpr_idx_off
    s_add_u32 s39, s39, 16
    s_cmp_eq_u32 s39, 144
    s_cselect_b32 s39, 0, s39
    s_cmp_eq_u32 s38, 8
    s_cbranch_scc1 L_mlp_sw_1045
L_mlp_swb_1046:
    v_mfma_f32_16x16x32_bf16 v[168:171], v[196:199], a[36:39], v[168:171]
    ds_read_b64_tr_b16 v[192:193], v248 offset:0
    v_mfma_f32_16x16x32_bf16 v[172:175], v[196:199], a[108:111], v[172:175]
    ds_read_b64_tr_b16 v[194:195], v248 offset:2048
    s_waitcnt lgkmcnt(6)
    v_mfma_f32_16x16x32_bf16 v[160:163], v[200:203], a[40:43], v[160:163]
    ds_read_b64_tr_b16 v[196:197], v249 offset:0
    s_add_u32 m0, s36, 0
    v_mfma_f32_16x16x32_bf16 v[164:167], v[200:203], a[112:115], v[164:167]
    ds_read_b64_tr_b16 v[198:199], v249 offset:2048
    buffer_load_dwordx4 v252, s[8:11], s24 offen offset:0 lds
    v_mfma_f32_16x16x32_bf16 v[168:171], v[204:207], a[40:43], v[168:171]
    ds_read_b64_tr_b16 v[200:201], v248 offset:4096
    v_mfma_f32_16x16x32_bf16 v[172:175], v[204:207], a[112:115], v[172:175]
    ds_read_b64_tr_b16 v[202:203], v248 offset:6144
    s_waitcnt lgkmcnt(6)
    v_mfma_f32_16x16x32_bf16 v[160:163], v[208:211], a[44:47], v[160:163]
    ds_read_b64_tr_b16 v[204:205], v249 offset:4096
    v_mfma_f32_16x16x32_bf16 v[164:167], v[208:211], a[116:119], v[164:167]
    ds_read_b64_tr_b16 v[206:207], v249 offset:6144
    v_mfma_f32_16x16x32_bf16 v[168:171], v[212:215], a[44:47], v[168:171]
    ds_read_b64_tr_b16 v[208:209], v248 offset:8192
    buffer_load_dwordx4 v252, s[8:11], s25 offen offset:1024 lds
    v_mfma_f32_16x16x32_bf16 v[172:175], v[212:215], a[116:119], v[172:175]
    ds_read_b64_tr_b16 v[210:211], v248 offset:10240
    s_waitcnt lgkmcnt(6)
    v_mfma_f32_16x16x32_bf16 v[144:147], v[192:195], a[48:51], v[144:147]
    ds_read_b64_tr_b16 v[212:213], v249 offset:8192
    v_mfma_f32_16x16x32_bf16 v[148:151], v[192:195], a[120:123], v[148:151]
    ds_read_b64_tr_b16 v[214:215], v249 offset:10240
    v_mfma_f32_16x16x32_bf16 v[152:155], v[196:199], a[48:51], v[152:155]
    ds_read_b64_tr_b16 v[192:193], v248 offset:12288
    v_mfma_f32_16x16x32_bf16 v[156:159], v[196:199], a[120:123], v[156:159]
    ds_read_b64_tr_b16 v[194:195], v248 offset:14336
    s_waitcnt lgkmcnt(6)
    v_mfma_f32_16x16x32_bf16 v[144:147], v[200:203], a[52:55], v[144:147]
    ds_read_b64_tr_b16 v[196:197], v249 offset:12288
    buffer_load_dwordx4 v252, s[8:11], s26 offen offset:2048 lds
    v_mfma_f32_16x16x32_bf16 v[148:151], v[200:203], a[124:127], v[148:151]
    ds_read_b64_tr_b16 v[198:199], v249 offset:14336
    v_mfma_f32_16x16x32_bf16 v[152:155], v[204:207], a[52:55], v[152:155]
    ds_read_b64_tr_b16 v[200:201], v248 offset:16384
    v_mfma_f32_16x16x32_bf16 v[156:159], v[204:207], a[124:127], v[156:159]
    ds_read_b64_tr_b16 v[202:203], v248 offset:18432
    s_waitcnt lgkmcnt(6)
    v_mfma_f32_16x16x32_bf16 v[144:147], v[208:211], a[56:59], v[144:147]
    ds_read_b64_tr_b16 v[204:205], v249 offset:16384
    v_mfma_f32_16x16x32_bf16 v[148:151], v[208:211], a[128:131], v[148:151]
    ds_read_b64_tr_b16 v[206:207], v249 offset:18432
    v_mfma_f32_16x16x32_bf16 v[152:155], v[212:215], a[56:59], v[152:155]
    ds_read_b64_tr_b16 v[208:209], v248 offset:20480
    buffer_load_dwordx4 v252, s[8:11], s27 offen offset:3072 lds
    v_mfma_f32_16x16x32_bf16 v[156:159], v[212:215], a[128:131], v[156:159]
    ds_read_b64_tr_b16 v[210:211], v248 offset:22528
    s_waitcnt lgkmcnt(6)
    v_mfma_f32_16x16x32_bf16 v[144:147], v[192:195], a[60:63], v[144:147]
    ds_read_b64_tr_b16 v[212:213], v249 offset:20480
    v_mfma_f32_16x16x32_bf16 v[148:151], v[192:195], a[132:135], v[148:151]
    ds_read_b64_tr_b16 v[214:215], v249 offset:22528
    v_mfma_f32_16x16x32_bf16 v[152:155], v[196:199], a[60:63], v[152:155]
    ds_read_b64_tr_b16 v[192:193], v250 offset:0
    s_add_u32 m0, s36, 4096
    v_mfma_f32_16x16x32_bf16 v[156:159], v[196:199], a[132:135], v[156:159]
    ds_read_b64_tr_b16 v[194:195], v250 offset:2048
    s_waitcnt lgkmcnt(6)
    v_mfma_f32_16x16x32_bf16 v[144:147], v[200:203], a[64:67], v[144:147]
    ds_read_b64_tr_b16 v[196:197], v251 offset:0
    buffer_load_dwordx4 v252, s[8:11], s28 offen offset:0 lds
    v_mfma_f32_16x16x32_bf16 v[148:151], v[200:203], a[136:139], v[148:151]
    ds_read_b64_tr_b16 v[198:199], v251 offset:2048
    v_mfma_f32_16x16x32_bf16 v[152:155], v[204:207], a[64:67], v[152:155]
    ds_read_b64_tr_b16 v[200:201], v250 offset:4096
    v_mfma_f32_16x16x32_bf16 v[156:159], v[204:207], a[136:139], v[156:159]
    ds_read_b64_tr_b16 v[202:203], v250 offset:6144
    s_waitcnt lgkmcnt(6)
    v_mfma_f32_16x16x32_bf16 v[144:147], v[208:211], a[68:71], v[144:147]
    ds_read_b64_tr_b16 v[204:205], v251 offset:4096
    v_mfma_f32_16x16x32_bf16 v[148:151], v[208:211], a[140:143], v[148:151]
    ds_read_b64_tr_b16 v[206:207], v251 offset:6144
    buffer_load_dwordx4 v252, s[8:11], s29 offen offset:1024 lds
    v_mfma_f32_16x16x32_bf16 v[152:155], v[212:215], a[68:71], v[152:155]
    ds_read_b64_tr_b16 v[208:209], v250 offset:8192
    s_add_u32 s8, s8, s47
    s_addc_u32 s9, s9, 0
    v_mfma_f32_16x16x32_bf16 v[156:159], v[212:215], a[140:143], v[156:159]
    ds_read_b64_tr_b16 v[210:211], v250 offset:10240
    s_waitcnt lgkmcnt(6)
    v_mfma_f32_16x16x32_bf16 v[160:163], v[192:195], a[48:51], v[160:163]
    ds_read_b64_tr_b16 v[212:213], v251 offset:8192
    v_mfma_f32_16x16x32_bf16 v[164:167], v[192:195], a[120:123], v[164:167]
    ds_read_b64_tr_b16 v[214:215], v251 offset:10240
    v_mfma_f32_16x16x32_bf16 v[168:171], v[196:199], a[48:51], v[168:171]
    ds_read_b64_tr_b16 v[192:193], v250 offset:12288
    v_cvt_pk_bf16_f32 v176, v144, v145
    v_mfma_f32_16x16x32_bf16 v[172:175], v[196:199], a[120:123], v[172:175]
    ds_read_b64_tr_b16 v[194:195], v250 offset:14336
    s_waitcnt lgkmcnt(6)
    v_mfma_f32_16x16x32_bf16 v[160:163], v[200:203], a[52:55], v[160:163]
    ds_read_b64_tr_b16 v[196:197], v251 offset:12288
    v_cvt_pk_bf16_f32 v177, v146, v147
    v_mfma_f32_16x16x32_bf16 v[164:167], v[200:203], a[124:127], v[164:167]
    ds_read_b64_tr_b16 v[198:199], v251 offset:14336
    v_cvt_pk_bf16_f32 v184, v148, v149
    v_mfma_f32_16x16x32_bf16 v[168:171], v[204:207], a[52:55], v[168:171]
    ds_read_b64_tr_b16 v[200:201], v250 offset:16384
    v_cvt_pk_bf16_f32 v185, v150, v151
    v_mfma_f32_16x16x32_bf16 v[172:175], v[204:207], a[124:127], v[172:175]
    ds_read_b64_tr_b16 v[202:203], v250 offset:18432
    s_waitcnt lgkmcnt(6)
    v_mfma_f32_16x16x32_bf16 v[160:163], v[208:211], a[56:59], v[160:163]
    ds_read_b64_tr_b16 v[204:205], v251 offset:16384
    v_cvt_pk_bf16_f32 v178, v152, v153
    v_mfma_f32_16x16x32_bf16 v[164:167], v[208:211], a[128:131], v[164:167]
    ds_read_b64_tr_b16 v[206:207], v251 offset:18432
    v_cvt_pk_bf16_f32 v179, v154, v155
    v_mfma_f32_16x16x32_bf16 v[168:171], v[212:215], a[56:59], v[168:171]
    ds_read_b64_tr_b16 v[208:209], v250 offset:20480
    v_cvt_pk_bf16_f32 v186, v156, v157
    v_mfma_f32_16x16x32_bf16 v[172:175], v[212:215], a[128:131], v[172:175]
    ds_read_b64_tr_b16 v[210:211], v250 offset:22528
    s_waitcnt lgkmcnt(6)
    v_mfma_f32_16x16x32_bf16 v[160:163], v[192:195], a[60:63], v[160:163]
    ds_read_b64_tr_b16 v[212:213], v251 offset:20480
    v_mfma_f32_16x16x32_bf16 v[164:167], v[192:195], a[132:135], v[164:167]
    ds_read_b64_tr_b16 v[214:215], v251 offset:22528
    s_waitcnt vmcnt(18)
    s_barrier
    v_mfma_f32_16x16x32_bf16 v[168:171], v[196:199], a[60:63], v[168:171]
    ds_read_b64_tr_b16 v[192:193], v248 offset:24576
    v_cvt_pk_bf16_f32 v187, v158, v159
    v_mfma_f32_16x16x32_bf16 v[172:175], v[196:199], a[132:135], v[172:175]
    ds_read_b64_tr_b16 v[194:195], v248 offset:26624
    s_waitcnt lgkmcnt(6)
    v_mfma_f32_16x16x32_bf16 v[160:163], v[200:203], a[64:67], v[160:163]
    ds_read_b64_tr_b16 v[196:197], v249 offset:24576
    s_add_u32 m0, s36, 24576
    v_mfma_f32_16x16x32_bf16 v[164:167], v[200:203], a[136:139], v[164:167]
    ds_read_b64_tr_b16 v[198:199], v249 offset:26624
    buffer_load_dwordx4 v252, s[8:11], s24 offen offset:0 lds
    v_mfma_f32_16x16x32_bf16 v[168:171], v[204:207], a[64:67], v[168:171]
    ds_read_b64_tr_b16 v[200:201], v248 offset:28672
    v_mfma_f32_16x16x32_bf16 v[172:175], v[204:207], a[136:139], v[172:175]
    ds_read_b64_tr_b16 v[202:203], v248 offset:30720
    s_waitcnt lgkmcnt(6)
    v_mfma_f32_16x16x32_bf16 v[160:163], v[208:211], a[68:71], v[160:163]
    ds_read_b64_tr_b16 v[204:205], v249 offset:28672
    v_mfma_f32_16x16x32_bf16 v[164:167], v[208:211], a[140:143], v[164:167]
    ds_read_b64_tr_b16 v[206:207], v249 offset:30720
    v_mfma_f32_16x16x32_bf16 v[168:171], v[212:215], a[68:71], v[168:171]
    ds_read_b64_tr_b16 v[208:209], v248 offset:32768
    buffer_load_dwordx4 v252, s[8:11], s25 offen offset:1024 lds
    v_mfma_f32_16x16x32_bf16 v[172:175], v[212:215], a[140:143], v[172:175]
    ds_read_b64_tr_b16 v[210:211], v248 offset:34816
    s_waitcnt lgkmcnt(6)
    v_mfma_f32_16x16x32_bf16 v[144:147], v[192:195], a[0:3], 0
    ds_read_b64_tr_b16 v[212:213], v249 offset:32768
    v_mfma_f32_16x16x32_bf16 v[148:151], v[192:195], a[72:75], 0
    ds_read_b64_tr_b16 v[214:215], v249 offset:34816
    v_mfma_f32_16x16x32_bf16 v[152:155], v[196:199], a[0:3], 0
    ds_read_b64_tr_b16 v[192:193], v248 offset:36864
    v_mfma_f32_16x16x32_bf16 v[156:159], v[196:199], a[72:75], 0
    ds_read_b64_tr_b16 v[194:195], v248 offset:38912
    s_waitcnt lgkmcnt(6)
    v_mfma_f32_16x16x32_bf16 v[144:147], v[200:203], a[4:7], v[144:147]
    ds_read_b64_tr_b16 v[196:197], v249 offset:36864
    v_cvt_pk_bf16_f32 v180, v160, v161
    v_mfma_f32_16x16x32_bf16 v[148:151], v[200:203], a[76:79], v[148:151]
    ds_read_b64_tr_b16 v[198:199], v249 offset:38912
    v_cvt_pk_bf16_f32 v181, v162, v163
    v_mfma_f32_16x16x32_bf16 v[152:155], v[204:207], a[4:7], v[152:155]
    ds_read_b64_tr_b16 v[200:201], v248 offset:40960
    v_cvt_pk_bf16_f32 v188, v164, v165
    v_mfma_f32_16x16x32_bf16 v[156:159], v[204:207], a[76:79], v[156:159]
    ds_read_b64_tr_b16 v[202:203], v248 offset:43008
    s_waitcnt lgkmcnt(6)
    v_mfma_f32_16x16x32_bf16 v[144:147], v[208:211], a[8:11], v[144:147]
    ds_read_b64_tr_b16 v[204:205], v249 offset:40960
    v_cvt_pk_bf16_f32 v189, v166, v167
    v_mfma_f32_16x16x32_bf16 v[148:151], v[208:211], a[80:83], v[148:151]
    ds_read_b64_tr_b16 v[206:207], v249 offset:43008
    v_cvt_pk_bf16_f32 v182, v168, v169
    v_mfma_f32_16x16x32_bf16 v[152:155], v[212:215], a[8:11], v[152:155]
    ds_read_b64_tr_b16 v[208:209], v248 offset:45056
    v_cvt_pk_bf16_f32 v183, v170, v171
    v_mfma_f32_16x16x32_bf16 v[156:159], v[212:215], a[80:83], v[156:159]
    ds_read_b64_tr_b16 v[210:211], v248 offset:47104
    v_add_u32 v248, 0xc000, v248
    s_waitcnt lgkmcnt(6)
    v_mfma_f32_16x16x32_bf16 v[144:147], v[192:195], a[12:15], v[144:147]
    ds_read_b64_tr_b16 v[212:213], v249 offset:45056
    v_cvt_pk_bf16_f32 v190, v172, v173
    v_mfma_f32_16x16x32_bf16 v[148:151], v[192:195], a[84:87], v[148:151]
    ds_read_b64_tr_b16 v[214:215], v249 offset:47104
    v_add_u32 v249, 0xc000, v249
    v_mfma_f32_16x16x32_bf16 v[152:155], v[196:199], a[12:15], v[152:155]
    ds_read_b64_tr_b16 v[192:193], v250 offset:24576
    v_cvt_pk_bf16_f32 v191, v174, v175
    v_mfma_f32_16x16x32_bf16 v[156:159], v[196:199], a[84:87], v[156:159]
    ds_read_b64_tr_b16 v[194:195], v250 offset:26624
    s_waitcnt lgkmcnt(6)
    v_mfma_f32_16x16x32_bf16 v[144:147], v[200:203], a[16:19], v[144:147]
    ds_read_b64_tr_b16 v[196:197], v251 offset:24576
    buffer_load_dwordx4 v252, s[8:11], s26 offen offset:2048 lds
    v_mfma_f32_16x16x32_bf16 v[148:151], v[200:203], a[88:91], v[148:151]
    ds_read_b64_tr_b16 v[198:199], v251 offset:26624
    v_mfma_f32_16x16x32_bf16 v[152:155], v[204:207], a[16:19], v[152:155]
    ds_read_b64_tr_b16 v[200:201], v250 offset:28672
    v_mfma_f32_16x16x32_bf16 v[156:159], v[204:207], a[88:91], v[156:159]
    ds_read_b64_tr_b16 v[202:203], v250 offset:30720
    s_waitcnt lgkmcnt(6)
    v_mfma_f32_16x16x32_bf16 v[144:147], v[208:211], a[20:23], v[144:147]
    ds_read_b64_tr_b16 v[204:205], v251 offset:28672
    v_mfma_f32_16x16x32_bf16 v[148:151], v[208:211], a[92:95], v[148:151]
    ds_read_b64_tr_b16 v[206:207], v251 offset:30720
    buffer_load_dwordx4 v252, s[8:11], s27 offen offset:3072 lds
    v_mfma_f32_16x16x32_bf16 v[152:155], v[212:215], a[20:23], v[152:155]
    ds_read_b64_tr_b16 v[208:209], v250 offset:32768
    v_mfma_f32_16x16x32_bf16 v[156:159], v[212:215], a[92:95], v[156:159]
    ds_read_b64_tr_b16 v[210:211], v250 offset:34816
    s_waitcnt lgkmcnt(6)
    v_mfma_f32_16x16x32_bf16 v[160:163], v[192:195], a[0:3], 0
    ds_read_b64_tr_b16 v[212:213], v251 offset:32768
    v_mfma_f32_16x16x32_bf16 v[164:167], v[192:195], a[72:75], 0
    ds_read_b64_tr_b16 v[214:215], v251 offset:34816
    s_add_u32 m0, s36, 28672
    v_mfma_f32_16x16x32_bf16 v[168:171], v[196:199], a[0:3], 0
    ds_read_b64_tr_b16 v[192:193], v250 offset:36864
    buffer_load_dwordx4 v252, s[8:11], s28 offen offset:0 lds
    v_mfma_f32_16x16x32_bf16 v[172:175], v[196:199], a[72:75], 0
    ds_read_b64_tr_b16 v[194:195], v250 offset:38912
    s_waitcnt lgkmcnt(6)
    v_mfma_f32_16x16x32_bf16 v[160:163], v[200:203], a[4:7], v[160:163]
    ds_read_b64_tr_b16 v[196:197], v251 offset:36864
    v_mfma_f32_16x16x32_bf16 v[164:167], v[200:203], a[76:79], v[164:167]
    ds_read_b64_tr_b16 v[198:199], v251 offset:38912
    v_mfma_f32_16x16x32_bf16 v[168:171], v[204:207], a[4:7], v[168:171]
    ds_read_b64_tr_b16 v[200:201], v250 offset:40960
    v_mfma_f32_16x16x32_bf16 v[172:175], v[204:207], a[76:79], v[172:175]
    ds_read_b64_tr_b16 v[202:203], v250 offset:43008
    s_waitcnt lgkmcnt(6)
    v_mfma_f32_16x16x32_bf16 v[160:163], v[208:211], a[8:11], v[160:163]
    ds_read_b64_tr_b16 v[204:205], v251 offset:40960
    buffer_load_dwordx4 v252, s[8:11], s29 offen offset:1024 lds
    v_mfma_f32_16x16x32_bf16 v[164:167], v[208:211], a[80:83], v[164:167]
    ds_read_b64_tr_b16 v[206:207], v251 offset:43008
    s_add_u32 s8, s8, s47
    s_addc_u32 s9, s9, 0
    v_mfma_f32_16x16x32_bf16 v[168:171], v[212:215], a[8:11], v[168:171]
    ds_read_b64_tr_b16 v[208:209], v250 offset:45056
    v_mfma_f32_16x16x32_bf16 v[172:175], v[212:215], a[80:83], v[172:175]
    ds_read_b64_tr_b16 v[210:211], v250 offset:47104
    v_add_u32 v250, 0xc000, v250
    s_waitcnt lgkmcnt(6)
    v_mfma_f32_16x16x32_bf16 v[160:163], v[192:195], a[12:15], v[160:163]
    ds_read_b64_tr_b16 v[212:213], v251 offset:45056
    v_mfma_f32_16x16x32_bf16 v[164:167], v[192:195], a[84:87], v[164:167]
    ds_read_b64_tr_b16 v[214:215], v251 offset:47104
    v_add_u32 v251, 0xc000, v251
    s_waitcnt vmcnt(18)
    s_barrier
    v_mfma_f32_16x16x32_bf16 v[168:171], v[196:199], a[12:15], v[168:171]
    ds_read_b64_tr_b16 v[192:193], v248 offset:0
    v_mfma_f32_16x16x32_bf16 v[172:175], v[196:199], a[84:87], v[172:175]
    ds_read_b64_tr_b16 v[194:195], v248 offset:2048
    s_waitcnt lgkmcnt(6)
    v_mfma_f32_16x16x32_bf16 v[160:163], v[200:203], a[16:19], v[160:163]
    ds_read_b64_tr_b16 v[196:197], v249 offset:0
    s_add_u32 m0, s36, 49152
    v_mfma_f32_16x16x32_bf16 v[164:167], v[200:203], a[88:91], v[164:167]
    ds_read_b64_tr_b16 v[198:199], v249 offset:2048
    buffer_load_dwordx4 v252, s[8:11], s24 offen offset:0 lds
    v_mfma_f32_16x16x32_bf16 v[168:171], v[204:207], a[16:19], v[168:171]
    ds_read_b64_tr_b16 v[200:201], v248 offset:4096
    v_mfma_f32_16x16x32_bf16 v[172:175], v[204:207], a[88:91], v[172:175]
    ds_read_b64_tr_b16 v[202:203], v248 offset:6144
    s_waitcnt lgkmcnt(6)
    v_mfma_f32_16x16x32_bf16 v[160:163], v[208:211], a[20:23], v[160:163]
    ds_read_b64_tr_b16 v[204:205], v249 offset:4096
    v_mfma_f32_16x16x32_bf16 v[164:167], v[208:211], a[92:95], v[164:167]
    ds_read_b64_tr_b16 v[206:207], v249 offset:6144
    v_mfma_f32_16x16x32_bf16 v[168:171], v[212:215], a[20:23], v[168:171]
    ds_read_b64_tr_b16 v[208:209], v248 offset:8192
    buffer_load_dwordx4 v252, s[8:11], s25 offen offset:1024 lds
    v_mfma_f32_16x16x32_bf16 v[172:175], v[212:215], a[92:95], v[172:175]
    ds_read_b64_tr_b16 v[210:211], v248 offset:10240
    s_waitcnt lgkmcnt(6)
    v_mfma_f32_16x16x32_bf16 v[144:147], v[192:195], a[24:27], v[144:147]
    ds_read_b64_tr_b16 v[212:213], v249 offset:8192
    v_mfma_f32_16x16x32_bf16 v[148:151], v[192:195], a[96:99], v[148:151]
    ds_read_b64_tr_b16 v[214:215], v249 offset:10240
    v_mfma_f32_16x16x32_bf16 v[152:155], v[196:199], a[24:27], v[152:155]
    ds_read_b64_tr_b16 v[192:193], v248 offset:12288
    v_mfma_f32_16x16x32_bf16 v[156:159], v[196:199], a[96:99], v[156:159]
    ds_read_b64_tr_b16 v[194:195], v248 offset:14336
    s_waitcnt lgkmcnt(6)
    v_mfma_f32_16x16x32_bf16 v[144:147], v[200:203], a[28:31], v[144:147]
    ds_read_b64_tr_b16 v[196:197], v249 offset:12288
    v_mfma_f32_16x16x32_bf16 v[148:151], v[200:203], a[100:103], v[148:151]
    ds_read_b64_tr_b16 v[198:199], v249 offset:14336
    buffer_load_dwordx4 v252, s[8:11], s26 offen offset:2048 lds
    v_mfma_f32_16x16x32_bf16 v[152:155], v[204:207], a[28:31], v[152:155]
    ds_read_b64_tr_b16 v[200:201], v248 offset:16384
    v_mfma_f32_16x16x32_bf16 v[156:159], v[204:207], a[100:103], v[156:159]
    ds_read_b64_tr_b16 v[202:203], v248 offset:18432
    s_waitcnt lgkmcnt(6)
    v_mfma_f32_16x16x32_bf16 v[144:147], v[208:211], a[32:35], v[144:147]
    ds_read_b64_tr_b16 v[204:205], v249 offset:16384
    v_mfma_f32_16x16x32_bf16 v[148:151], v[208:211], a[104:107], v[148:151]
    ds_read_b64_tr_b16 v[206:207], v249 offset:18432
    v_mfma_f32_16x16x32_bf16 v[152:155], v[212:215], a[32:35], v[152:155]
    ds_read_b64_tr_b16 v[208:209], v248 offset:20480
    v_mfma_f32_16x16x32_bf16 v[156:159], v[212:215], a[104:107], v[156:159]
    ds_read_b64_tr_b16 v[210:211], v248 offset:22528
    s_waitcnt lgkmcnt(6)
    v_mfma_f32_16x16x32_bf16 v[144:147], v[192:195], a[36:39], v[144:147]
    ds_read_b64_tr_b16 v[212:213], v249 offset:20480
    buffer_load_dwordx4 v252, s[8:11], s27 offen offset:3072 lds
    v_mfma_f32_16x16x32_bf16 v[148:151], v[192:195], a[108:111], v[148:151]
    ds_read_b64_tr_b16 v[214:215], v249 offset:22528
    v_mfma_f32_16x16x32_bf16 v[152:155], v[196:199], a[36:39], v[152:155]
    ds_read_b64_tr_b16 v[192:193], v250 offset:0
    v_mfma_f32_16x16x32_bf16 v[156:159], v[196:199], a[108:111], v[156:159]
    ds_read_b64_tr_b16 v[194:195], v250 offset:2048
    s_waitcnt lgkmcnt(6)
    v_mfma_f32_16x16x32_bf16 v[144:147], v[200:203], a[40:43], v[144:147]
    ds_read_b64_tr_b16 v[196:197], v251 offset:0
    s_add_u32 m0, s36, 53248
    v_mfma_f32_16x16x32_bf16 v[148:151], v[200:203], a[112:115], v[148:151]
    ds_read_b64_tr_b16 v[198:199], v251 offset:2048
    buffer_load_dwordx4 v252, s[8:11], s28 offen offset:0 lds
    v_mfma_f32_16x16x32_bf16 v[152:155], v[204:207], a[40:43], v[152:155]
    ds_read_b64_tr_b16 v[200:201], v250 offset:4096
    v_mfma_f32_16x16x32_bf16 v[156:159], v[204:207], a[112:115], v[156:159]
    ds_read_b64_tr_b16 v[202:203], v250 offset:6144
    s_waitcnt lgkmcnt(6)
    v_mfma_f32_16x16x32_bf16 v[144:147], v[208:211], a[44:47], v[144:147]
    ds_read_b64_tr_b16 v[204:205], v251 offset:4096
    v_mfma_f32_16x16x32_bf16 v[148:151], v[208:211], a[116:119], v[148:151]
    ds_read_b64_tr_b16 v[206:207], v251 offset:6144
    v_mfma_f32_16x16x32_bf16 v[152:155], v[212:215], a[44:47], v[152:155]
    ds_read_b64_tr_b16 v[208:209], v250 offset:8192
    v_mfma_f32_16x16x32_bf16 v[156:159], v[212:215], a[116:119], v[156:159]
    ds_read_b64_tr_b16 v[210:211], v250 offset:10240
    s_waitcnt lgkmcnt(6)
    v_mfma_f32_16x16x32_bf16 v[160:163], v[192:195], a[24:27], v[160:163]
    ds_read_b64_tr_b16 v[212:213], v251 offset:8192
    buffer_load_dwordx4 v252, s[8:11], s29 offen offset:1024 lds
    v_mfma_f32_16x16x32_bf16 v[164:167], v[192:195], a[96:99], v[164:167]
    ds_read_b64_tr_b16 v[214:215], v251 offset:10240
    s_add_u32 s8, s8, s46
    s_addc_u32 s9, s9, -1
    v_mfma_f32_16x16x32_bf16 v[168:171], v[196:199], a[24:27], v[168:171]
    ds_read_b64_tr_b16 v[192:193], v250 offset:12288
    s_cmp_ge_u32 s38, 3
    s_cselect_b32 s54, 0, s54
    v_mfma_f32_16x16x32_bf16 v[172:175], v[196:199], a[96:99], v[172:175]
    ds_read_b64_tr_b16 v[194:195], v250 offset:14336
    s_waitcnt lgkmcnt(6)
    v_mfma_f32_16x16x32_bf16 v[160:163], v[200:203], a[28:31], v[160:163]
    ds_read_b64_tr_b16 v[196:197], v251 offset:12288
    v_mbcnt_lo_u32_b32 v254, -1, 0
    v_mfma_f32_16x16x32_bf16 v[164:167], v[200:203], a[100:103], v[164:167]
    ds_read_b64_tr_b16 v[198:199], v251 offset:14336
    v_mbcnt_hi_u32_b32 v254, -1, v254
    v_mfma_f32_16x16x32_bf16 v[168:171], v[204:207], a[28:31], v[168:171]
    ds_read_b64_tr_b16 v[200:201], v250 offset:16384
    v_mul_u32_u24 v254, s56, v254
    v_mfma_f32_16x16x32_bf16 v[172:175], v[204:207], a[100:103], v[172:175]
    ds_read_b64_tr_b16 v[202:203], v250 offset:18432
    s_waitcnt lgkmcnt(6)
    v_mfma_f32_16x16x32_bf16 v[160:163], v[208:211], a[32:35], v[160:163]
    ds_read_b64_tr_b16 v[204:205], v251 offset:16384
    s_mov_b32 m0, 147456
    v_mfma_f32_16x16x32_bf16 v[164:167], v[208:211], a[104:107], v[164:167]
    ds_read_b64_tr_b16 v[206:207], v251 offset:18432
    buffer_load_dword v254, s[52:55], s57 offen lds
    v_mfma_f32_16x16x32_bf16 v[168:171], v[212:215], a[32:35], v[168:171]
    ds_read_b64_tr_b16 v[208:209], v250 offset:20480
    s_add_u32 s57, s57, s58
    v_mfma_f32_16x16x32_bf16 v[172:175], v[212:215], a[104:107], v[172:175]
    ds_read_b64_tr_b16 v[210:211], v250 offset:22528
    s_waitcnt lgkmcnt(6)
    v_mfma_f32_16x16x32_bf16 v[160:163], v[192:195], a[36:39], v[160:163]
    ds_read_b64_tr_b16 v[212:213], v251 offset:20480
    v_mfma_f32_16x16x32_bf16 v[164:167], v[192:195], a[108:111], v[164:167]
    ds_read_b64_tr_b16 v[214:215], v251 offset:22528
    s_waitcnt vmcnt(19)
    s_barrier
    v_mfma_f32_16x16x32_bf16 v[168:171], v[196:199], a[36:39], v[168:171]
    ds_read_b64_tr_b16 v[192:193], v248 offset:24576
    v_mfma_f32_16x16x32_bf16 v[172:175], v[196:199], a[108:111], v[172:175]
    ds_read_b64_tr_b16 v[194:195], v248 offset:26624
    s_waitcnt lgkmcnt(6)
    v_mfma_f32_16x16x32_bf16 v[160:163], v[200:203], a[40:43], v[160:163]
    ds_read_b64_tr_b16 v[196:197], v248 offset:28672
    s_add_u32 m0, s36, 73728
    v_mfma_f32_16x16x32_bf16 v[164:167], v[200:203], a[112:115], v[164:167]
    ds_read_b64_tr_b16 v[198:199], v248 offset:30720
    buffer_load_dwordx4 v252, s[12:15], s24 offen offset:0 lds
    v_mfma_f32_16x16x32_bf16 v[168:171], v[204:207], a[40:43], v[168:171]
    ds_read_b64_tr_b16 v[200:201], v248 offset:32768
    v_mfma_f32_16x16x32_bf16 v[172:175], v[204:207], a[112:115], v[172:175]
    ds_read_b64_tr_b16 v[202:203], v248 offset:34816
    s_waitcnt lgkmcnt(6)
    v_mfma_f32_16x16x32_bf16 v[160:163], v[208:211], a[44:47], v[160:163]
    ds_read_b64_tr_b16 v[204:205], v248 offset:36864
    buffer_load_dwordx4 v252, s[12:15], s25 offen offset:1024 lds
    v_mfma_f32_16x16x32_bf16 v[164:167], v[208:211], a[116:119], v[164:167]
    ds_read_b64_tr_b16 v[206:207], v248 offset:38912
    v_mfma_f32_16x16x32_bf16 v[168:171], v[212:215], a[44:47], v[168:171]
    ds_read_b64_tr_b16 v[208:209], v248 offset:40960
    v_mfma_f32_16x16x32_bf16 v[172:175], v[212:215], a[116:119], v[172:175]
    ds_read_b64_tr_b16 v[210:211], v248 offset:43008
    s_waitcnt lgkmcnt(6)
    v_mfma_f32_16x16x32_bf16 v[144:147], v[192:195], a[48:51], v[144:147]
    ds_read_b64_tr_b16 v[212:213], v248 offset:45056
    buffer_load_dwordx4 v252, s[12:15], s26 offen offset:2048 lds
    v_mfma_f32_16x16x32_bf16 v[148:151], v[192:195], a[120:123], v[148:151]
    ds_read_b64_tr_b16 v[214:215], v248 offset:47104
    v_add_u32 v248, 0xfffe8000, v248
    v_mfma_f32_16x16x32_bf16 v[144:147], v[196:199], a[52:55], v[144:147]
    ds_read_b64_tr_b16 v[192:193], v249 offset:24576
    v_mfma_f32_16x16x32_bf16 v[148:151], v[196:199], a[124:127], v[148:151]
    ds_read_b64_tr_b16 v[194:195], v249 offset:26624
    s_waitcnt lgkmcnt(6)
    v_mfma_f32_16x16x32_bf16 v[144:147], v[200:203], a[56:59], v[144:147]
    ds_read_b64_tr_b16 v[196:197], v249 offset:28672
    v_mfma_f32_16x16x32_bf16 v[148:151], v[200:203], a[128:131], v[148:151]
    ds_read_b64_tr_b16 v[198:199], v249 offset:30720
    buffer_load_dwordx4 v252, s[12:15], s27 offen offset:3072 lds
    v_mfma_f32_16x16x32_bf16 v[144:147], v[204:207], a[60:63], v[144:147]
    ds_read_b64_tr_b16 v[200:201], v249 offset:32768
    s_add_u32 m0, s36, 77824
    v_mfma_f32_16x16x32_bf16 v[148:151], v[204:207], a[132:135], v[148:151]
    ds_read_b64_tr_b16 v[202:203], v249 offset:34816
    s_waitcnt lgkmcnt(6)
    v_mfma_f32_16x16x32_bf16 v[144:147], v[208:211], a[64:67], v[144:147]
    ds_read_b64_tr_b16 v[204:205], v249 offset:36864
    buffer_load_dwordx4 v252, s[12:15], s28 offen offset:0 lds
    v_mfma_f32_16x16x32_bf16 v[148:151], v[208:211], a[136:139], v[148:151]
    ds_read_b64_tr_b16 v[206:207], v249 offset:38912
    v_mfma_f32_16x16x32_bf16 v[144:147], v[212:215], a[68:71], v[144:147]
    ds_read_b64_tr_b16 v[208:209], v249 offset:40960
    v_mfma_f32_16x16x32_bf16 v[148:151], v[212:215], a[140:143], v[148:151]
    ds_read_b64_tr_b16 v[210:211], v249 offset:43008
    s_waitcnt lgkmcnt(6)
    v_mfma_f32_16x16x32_bf16 v[152:155], v[192:195], a[48:51], v[152:155]
    ds_read_b64_tr_b16 v[212:213], v249 offset:45056
    buffer_load_dwordx4 v252, s[12:15], s29 offen offset:1024 lds
    v_mfma_f32_16x16x32_bf16 v[156:159], v[192:195], a[120:123], v[156:159]
    ds_read_b64_tr_b16 v[214:215], v249 offset:47104
    v_add_u32 v249, 0xfffe8000, v249
    v_mfma_f32_16x16x32_bf16 v[152:155], v[196:199], a[52:55], v[152:155]
    ds_read_b64_tr_b16 v[192:193], v250 offset:24576
    s_add_u32 s12, s12, 1769472
    s_addc_u32 s13, s13, 0
    v_mfma_f32_16x16x32_bf16 v[156:159], v[196:199], a[124:127], v[156:159]
    ds_read_b64_tr_b16 v[194:195], v250 offset:26624
    s_waitcnt lgkmcnt(6)
    v_mfma_f32_16x16x32_bf16 v[152:155], v[200:203], a[56:59], v[152:155]
    ds_read_b64_tr_b16 v[196:197], v250 offset:28672
    v_lshlrev_b32 v254, 16, v176
    v_and_b32 v255, s43, v176
    v_mfma_f32_16x16x32_bf16 v[156:159], v[200:203], a[128:131], v[156:159]
    ds_read_b64_tr_b16 v[198:199], v250 offset:30720
    v_mul_f32 v144, v144, v254
    v_mul_f32 v145, v145, v255
    v_mfma_f32_16x16x32_bf16 v[152:155], v[204:207], a[60:63], v[152:155]
    ds_read_b64_tr_b16 v[200:201], v250 offset:32768
    v_cvt_pk_bf16_f32 v176, v144, v145
    v_lshlrev_b32 v254, 16, v177
    v_mfma_f32_16x16x32_bf16 v[156:159], v[204:207], a[132:135], v[156:159]
    ds_read_b64_tr_b16 v[202:203], v250 offset:34816
    s_waitcnt lgkmcnt(6)
    v_mfma_f32_16x16x32_bf16 v[152:155], v[208:211], a[64:67], v[152:155]
    ds_read_b64_tr_b16 v[204:205], v250 offset:36864
    v_and_b32 v255, s43, v177
    v_mul_f32 v146, v146, v254
    v_mfma_f32_16x16x32_bf16 v[156:159], v[208:211], a[136:139], v[156:159]
    ds_read_b64_tr_b16 v[206:207], v250 offset:38912
    v_mul_f32 v147, v147, v255
    v_cvt_pk_bf16_f32 v177, v146, v147
    v_mfma_f32_16x16x32_bf16 v[152:155], v[212:215], a[68:71], v[152:155]
    ds_read_b64_tr_b16 v[208:209], v250 offset:40960
    v_lshlrev_b32 v254, 16, v184
    v_mfma_f32_16x16x32_bf16 v[156:159], v[212:215], a[140:143], v[156:159]
    ds_read_b64_tr_b16 v[210:211], v250 offset:43008
    v_and_b32 v255, s43, v184
    s_waitcnt lgkmcnt(6)
    v_mfma_f32_16x16x32_bf16 v[160:163], v[192:195], a[48:51], v[160:163]
    ds_read_b64_tr_b16 v[212:213], v250 offset:45056
    v_mul_f32 v148, v148, v254
    v_mul_f32 v149, v149, v255
    v_mfma_f32_16x16x32_bf16 v[164:167], v[192:195], a[120:123], v[164:167]
    ds_read_b64_tr_b16 v[214:215], v250 offset:47104
    v_add_u32 v250, 0xfffe8000, v250
    v_cvt_pk_bf16_f32 v184, v148, v149
    v_mfma_f32_16x16x32_bf16 v[160:163], v[196:199], a[52:55], v[160:163]
    ds_read_b64_tr_b16 v[192:193], v251 offset:24576
    v_lshlrev_b32 v254, 16, v185
    v_mfma_f32_16x16x32_bf16 v[164:167], v[196:199], a[124:127], v[164:167]
    ds_read_b64_tr_b16 v[194:195], v251 offset:26624
    v_and_b32 v255, s43, v185
    s_waitcnt lgkmcnt(6)
    v_mfma_f32_16x16x32_bf16 v[160:163], v[200:203], a[56:59], v[160:163]
    ds_read_b64_tr_b16 v[196:197], v251 offset:28672
    v_mul_f32 v150, v150, v254
    v_mul_f32 v151, v151, v255
    v_mfma_f32_16x16x32_bf16 v[164:167], v[200:203], a[128:131], v[164:167]
    ds_read_b64_tr_b16 v[198:199], v251 offset:30720
    v_cvt_pk_bf16_f32 v185, v150, v151
    v_mfma_f32_16x16x32_bf16 v[160:163], v[204:207], a[60:63], v[160:163]
    ds_read_b64_tr_b16 v[200:201], v251 offset:32768
    v_lshlrev_b32 v254, 16, v178
    v_and_b32 v255, s43, v178
    v_mfma_f32_16x16x32_bf16 v[164:167], v[204:207], a[132:135], v[164:167]
    ds_read_b64_tr_b16 v[202:203], v251 offset:34816
    v_mul_f32 v152, v152, v254
    s_waitcnt lgkmcnt(6)
    v_mfma_f32_16x16x32_bf16 v[160:163], v[208:211], a[64:67], v[160:163]
    ds_read_b64_tr_b16 v[204:205], v251 offset:36864
    v_mul_f32 v153, v153, v255
    v_mfma_f32_16x16x32_bf16 v[164:167], v[208:211], a[136:139], v[164:167]
    ds_read_b64_tr_b16 v[206:207], v251 offset:38912
    v_cvt_pk_bf16_f32 v178, v152, v153
    v_lshlrev_b32 v254, 16, v179
    v_mfma_f32_16x16x32_bf16 v[160:163], v[212:215], a[68:71], v[160:163]
    ds_read_b64_tr_b16 v[208:209], v251 offset:40960
    v_and_b32 v255, s43, v179
    v_mul_f32 v154, v154, v254
    v_mfma_f32_16x16x32_bf16 v[164:167], v[212:215], a[140:143], v[164:167]
    ds_read_b64_tr_b16 v[210:211], v251 offset:43008
    s_waitcnt lgkmcnt(6)
    v_mfma_f32_16x16x32_bf16 v[168:171], v[192:195], a[48:51], v[168:171]
    ds_read_b64_tr_b16 v[212:213], v251 offset:45056
    v_mul_f32 v155, v155, v255
    v_mfma_f32_16x16x32_bf16 v[172:175], v[192:195], a[120:123], v[172:175]
    ds_read_b64_tr_b16 v[214:215], v251 offset:47104
    v_add_u32 v251, 0xfffe8000, v251
    s_waitcnt vmcnt(19)
    s_barrier
    v_mfma_f32_16x16x32_bf16 v[168:171], v[196:199], a[52:55], v[168:171]
    ds_read_b64_tr_b16 v[192:193], v248 offset:0
    v_cvt_pk_bf16_f32 v179, v154, v155
    v_lshlrev_b32 v254, 16, v186
    v_mfma_f32_16x16x32_bf16 v[172:175], v[196:199], a[124:127], v[172:175]
    ds_read_b64_tr_b16 v[194:195], v248 offset:2048
    v_and_b32 v255, s43, v186
    s_waitcnt lgkmcnt(6)
    v_mfma_f32_16x16x32_bf16 v[168:171], v[200:203], a[56:59], v[168:171]
    ds_read_b64_tr_b16 v[196:197], v249 offset:0
    v_mul_f32 v156, v156, v254
    v_mfma_f32_16x16x32_bf16 v[172:175], v[200:203], a[128:131], v[172:175]
    ds_read_b64_tr_b16 v[198:199], v249 offset:2048
    v_mul_f32 v157, v157, v255
    v_cvt_pk_bf16_f32 v186, v156, v157
    v_mfma_f32_16x16x32_bf16 v[168:171], v[204:207], a[60:63], v[168:171]
    ds_read_b64_tr_b16 v[200:201], v248 offset:4096
    v_lshlrev_b32 v254, 16, v187
    v_and_b32 v255, s43, v187
    v_mfma_f32_16x16x32_bf16 v[172:175], v[204:207], a[132:135], v[172:175]
    ds_read_b64_tr_b16 v[202:203], v248 offset:6144
    s_waitcnt lgkmcnt(6)
    v_mfma_f32_16x16x32_bf16 v[168:171], v[208:211], a[64:67], v[168:171]
    ds_read_b64_tr_b16 v[204:205], v249 offset:4096
    v_mul_f32 v158, v158, v254
    v_mul_f32 v159, v159, v255
    v_mfma_f32_16x16x32_bf16 v[172:175], v[208:211], a[136:139], v[172:175]
    ds_read_b64_tr_b16 v[206:207], v249 offset:6144
    v_cvt_pk_bf16_f32 v187, v158, v159
    v_mfma_f32_16x16x32_bf16 v[168:171], v[212:215], a[68:71], v[168:171]
    ds_read_b64_tr_b16 v[208:209], v248 offset:8192
    v_mfma_f32_16x16x32_bf16 v[172:175], v[212:215], a[140:143], v[172:175]
    ds_read_b64_tr_b16 v[210:211], v248 offset:10240
    s_add_u32 s38, s38, 1
    s_cmp_lg_u32 s38, 9
    s_cbranch_scc1 L_mlp_p1_1044
    s_load_dwordx2 s[8:9], s[0:1], 16
    v_lshlrev_b32 v254, 16, v180
    v_and_b32 v255, s43, v180
    v_mul_f32 v160, v160, v254
    v_mul_f32 v161, v161, v255
    v_cvt_pk_bf16_f32 v180, v160, v161
    v_lshlrev_b32 v254, 16, v181
    v_and_b32 v255, s43, v181
    v_mul_f32 v162, v162, v254
    v_mul_f32 v163, v163, v255
    v_cvt_pk_bf16_f32 v181, v162, v163
    v_lshlrev_b32 v254, 16, v188
    v_and_b32 v255, s43, v188
    v_mul_f32 v164, v164, v254
    v_mul_f32 v165, v165, v255
    v_cvt_pk_bf16_f32 v188, v164, v165
    v_lshlrev_b32 v254, 16, v189
    v_and_b32 v255, s43, v189
    v_mul_f32 v166, v166, v254
    v_mul_f32 v167, v167, v255
    v_cvt_pk_bf16_f32 v189, v166, v167
    v_lshlrev_b32 v254, 16, v182
    v_and_b32 v255, s43, v182
    v_mul_f32 v168, v168, v254
    v_mul_f32 v169, v169, v255
    v_cvt_pk_bf16_f32 v182, v168, v169
    v_lshlrev_b32 v254, 16, v183
    v_and_b32 v255, s43, v183
    v_mul_f32 v170, v170, v254
    v_mul_f32 v171, v171, v255
    v_cvt_pk_bf16_f32 v183, v170, v171
    v_lshlrev_b32 v254, 16, v190
    v_and_b32 v255, s43, v190
    v_mul_f32 v172, v172, v254
    v_mul_f32 v173, v173, v255
    v_cvt_pk_bf16_f32 v190, v172, v173
    v_lshlrev_b32 v254, 16, v191
    v_and_b32 v255, s43, v191
    v_mul_f32 v174, v174, v254
    v_mul_f32 v175, v175, v255
    v_cvt_pk_bf16_f32 v191, v174, v175
    s_waitcnt lgkmcnt(0)
    v_mbcnt_lo_u32_b32 v252, -1, 0
    v_mbcnt_hi_u32_b32 v252, -1, v252
    v_lshlrev_b32 v252, 4, v252
    s_mov_b32 s38, 0
    v_mov_b32 v128, v253
    v_mov_b32 v129, v253
    v_mov_b32 v130, v253
    v_mov_b32 v131, v253
    v_mov_b32 v132, v253
    v_mov_b32 v133, v253
.p2align 6
L_mlp_p2_1049:
    s_waitcnt lgkmcnt(6)
    v_mfma_f32_16x16x32_bf16 v[144:147], v[192:195], v[0:3], 0
    ds_read_b64_tr_b16 v[212:213], v249 offset:8192
    s_add_u32 m0, s36, 98304
    v_mfma_f32_16x16x32_bf16 v[148:151], v[192:195], v[8:11], 0
    ds_read_b64_tr_b16 v[214:215], v249 offset:10240
    buffer_load_dwordx4 v128, s[16:19], s30 offen offset:0 lds
    v_mfma_f32_16x16x32_bf16 v[152:155], v[196:199], v[0:3], 0
    ds_read_b64_tr_b16 v[192:193], v248 offset:12288
    v_mfma_f32_16x16x32_bf16 v[156:159], v[196:199], v[8:11], 0
    ds_read_b64_tr_b16 v[194:195], v248 offset:14336
    s_waitcnt lgkmcnt(6)
    v_mfma_f32_16x16x32_bf16 v[144:147], v[200:203], v[4:7], v[144:147]
    ds_read_b64_tr_b16 v[196:197], v249 offset:12288
    v_mfma_f32_16x16x32_bf16 v[148:151], v[200:203], v[12:15], v[148:151]
    ds_read_b64_tr_b16 v[198:199], v249 offset:14336
    buffer_load_dwordx4 v129, s[16:19], s31 offen offset:1024 lds
    v_mfma_f32_16x16x32_bf16 v[152:155], v[204:207], v[4:7], v[152:155]
    ds_read_b64_tr_b16 v[200:201], v248 offset:16384
    v_mfma_f32_16x16x32_bf16 v[156:159], v[204:207], v[12:15], v[156:159]
    ds_read_b64_tr_b16 v[202:203], v248 offset:18432
    s_waitcnt lgkmcnt(6)
    v_mfma_f32_16x16x32_bf16 v[144:147], v[208:211], v[16:19], v[144:147]
    ds_read_b64_tr_b16 v[204:205], v249 offset:16384
    v_mfma_f32_16x16x32_bf16 v[148:151], v[208:211], v[24:27], v[148:151]
    ds_read_b64_tr_b16 v[206:207], v249 offset:18432
    v_mfma_f32_16x16x32_bf16 v[152:155], v[212:215], v[16:19], v[152:155]
    ds_read_b64_tr_b16 v[208:209], v248 offset:20480
    buffer_load_dwordx4 v130, s[16:19], s32 offen offset:2048 lds
    v_mfma_f32_16x16x32_bf16 v[156:159], v[212:215], v[24:27], v[156:159]
    ds_read_b64_tr_b16 v[210:211], v248 offset:22528
    s_waitcnt lgkmcnt(6)
    v_mfma_f32_16x16x32_bf16 v[144:147], v[192:195], v[20:23], v[144:147]
    ds_read_b64_tr_b16 v[212:213], v249 offset:20480
    v_mfma_f32_16x16x32_bf16 v[148:151], v[192:195], v[28:31], v[148:151]
    ds_read_b64_tr_b16 v[214:215], v249 offset:22528
    v_mfma_f32_16x16x32_bf16 v[152:155], v[196:199], v[20:23], v[152:155]
    ds_read_b64_tr_b16 v[192:193], v250 offset:0
    buffer_load_dwordx4 v131, s[16:19], s33 offen offset:3072 lds
    v_mfma_f32_16x16x32_bf16 v[156:159], v[196:199], v[28:31], v[156:159]
    ds_read_b64_tr_b16 v[194:195], v250 offset:2048
    s_waitcnt lgkmcnt(6)
    v_mfma_f32_16x16x32_bf16 v[144:147], v[200:203], v[32:35], v[144:147]
    ds_read_b64_tr_b16 v[196:197], v251 offset:0
    v_mfma_f32_16x16x32_bf16 v[148:151], v[200:203], v[40:43], v[148:151]
    ds_read_b64_tr_b16 v[198:199], v251 offset:2048
    v_mfma_f32_16x16x32_bf16 v[152:155], v[204:207], v[32:35], v[152:155]
    ds_read_b64_tr_b16 v[200:201], v250 offset:4096
    s_add_u32 m0, s36, 102400
    v_cvt_pk_bf16_f32 v216, v216, v217
    v_mfma_f32_16x16x32_bf16 v[156:159], v[204:207], v[40:43], v[156:159]
    ds_read_b64_tr_b16 v[202:203], v250 offset:6144
    s_waitcnt lgkmcnt(6)
    v_mfma_f32_16x16x32_bf16 v[144:147], v[208:211], v[36:39], v[144:147]
    ds_read_b64_tr_b16 v[204:205], v251 offset:4096
    buffer_load_dwordx4 v132, s[16:19], s34 offen offset:0 lds
    v_mfma_f32_16x16x32_bf16 v[148:151], v[208:211], v[44:47], v[148:151]
    ds_read_b64_tr_b16 v[206:207], v251 offset:6144
    v_cvt_pk_bf16_f32 v217, v218, v219
    v_mfma_f32_16x16x32_bf16 v[152:155], v[212:215], v[36:39], v[152:155]
    ds_read_b64_tr_b16 v[208:209], v250 offset:8192
    v_cvt_pk_bf16_f32 v218, v224, v225
    v_mfma_f32_16x16x32_bf16 v[156:159], v[212:215], v[44:47], v[156:159]
    ds_read_b64_tr_b16 v[210:211], v250 offset:10240
    s_waitcnt lgkmcnt(6)
    v_mfma_f32_16x16x32_bf16 v[160:163], v[192:195], v[0:3], 0
    ds_read_b64_tr_b16 v[212:213], v251 offset:8192
    v_cvt_pk_bf16_f32 v219, v226, v227
    v_mfma_f32_16x16x32_bf16 v[164:167], v[192:195], v[8:11], 0
    ds_read_b64_tr_b16 v[214:215], v251 offset:10240
    buffer_load_dwordx4 v133, s[16:19], s35 offen offset:1024 lds
    v_mfma_f32_16x16x32_bf16 v[168:171], v[196:199], v[0:3], 0
    ds_read_b64_tr_b16 v[192:193], v250 offset:12288
    s_add_u32 s16, s16, s48
    s_addc_u32 s17, s17, 0
    v_mfma_f32_16x16x32_bf16 v[172:175], v[196:199], v[8:11], 0
    ds_read_b64_tr_b16 v[194:195], v250 offset:14336
    s_waitcnt lgkmcnt(6)
    v_mfma_f32_16x16x32_bf16 v[160:163], v[200:203], v[4:7], v[160:163]
    ds_read_b64_tr_b16 v[196:197], v251 offset:12288
    buffer_store_dwordx4 v[216:219], v252, s[20:23], s50 offen offset:0 sc1
    v_mfma_f32_16x16x32_bf16 v[164:167], v[200:203], v[12:15], v[164:167]
    ds_read_b64_tr_b16 v[198:199], v251 offset:14336
    v_cvt_pk_bf16_f32 v220, v220, v221
    v_mfma_f32_16x16x32_bf16 v[168:171], v[204:207], v[4:7], v[168:171]
    ds_read_b64_tr_b16 v[200:201], v250 offset:16384
    v_cvt_pk_bf16_f32 v221, v222, v223
    v_mfma_f32_16x16x32_bf16 v[172:175], v[204:207], v[12:15], v[172:175]
    ds_read_b64_tr_b16 v[202:203], v250 offset:18432
    s_waitcnt lgkmcnt(6)
    v_mfma_f32_16x16x32_bf16 v[160:163], v[208:211], v[16:19], v[160:163]
    ds_read_b64_tr_b16 v[204:205], v251 offset:16384
    v_cvt_pk_bf16_f32 v222, v228, v229
    v_mfma_f32_16x16x32_bf16 v[164:167], v[208:211], v[24:27], v[164:167]
    ds_read_b64_tr_b16 v[206:207], v251 offset:18432
    v_cvt_pk_bf16_f32 v223, v230, v231
    v_mfma_f32_16x16x32_bf16 v[168:171], v[212:215], v[16:19], v[168:171]
    ds_read_b64_tr_b16 v[208:209], v250 offset:20480
    buffer_store_dwordx4 v[220:223], v252, s[20:23], s51 offen offset:0 sc1
    v_mfma_f32_16x16x32_bf16 v[172:175], v[212:215], v[24:27], v[172:175]
    ds_read_b64_tr_b16 v[210:211], v250 offset:22528
    s_waitcnt lgkmcnt(6)
    v_mfma_f32_16x16x32_bf16 v[160:163], v[192:195], v[20:23], v[160:163]
    ds_read_b64_tr_b16 v[212:213], v251 offset:20480
    v_mfma_f32_16x16x32_bf16 v[164:167], v[192:195], v[28:31], v[164:167]
    ds_read_b64_tr_b16 v[214:215], v251 offset:22528
    s_waitcnt vmcnt(20)
    s_barrier
    s_cmp_eq_u32 s38, 4
    s_cbranch_scc1 L_mlp_chk_1056
L_mlp_chkb_1058:
    v_mfma_f32_16x16x32_bf16 v[168:171], v[196:199], v[20:23], v[168:171]
    ds_read_b64_tr_b16 v[192:193], v248 offset:24576
    v_mfma_f32_16x16x32_bf16 v[172:175], v[196:199], v[28:31], v[172:175]
    ds_read_b64_tr_b16 v[194:195], v248 offset:26624
    s_waitcnt lgkmcnt(6)
    v_mfma_f32_16x16x32_bf16 v[160:163], v[200:203], v[32:35], v[160:163]
    ds_read_b64_tr_b16 v[196:197], v249 offset:24576
    s_add_u32 m0, s36, 122880
    v_mfma_f32_16x16x32_bf16 v[164:167], v[200:203], v[40:43], v[164:167]
    ds_read_b64_tr_b16 v[198:199], v249 offset:26624
    buffer_load_dwordx4 v128, s[16:19], s30 offen offset:0 lds
    v_mfma_f32_16x16x32_bf16 v[168:171], v[204:207], v[32:35], v[168:171]
    ds_read_b64_tr_b16 v[200:201], v248 offset:28672
    v_mfma_f32_16x16x32_bf16 v[172:175], v[204:207], v[40:43], v[172:175]
    ds_read_b64_tr_b16 v[202:203], v248 offset:30720
    s_waitcnt lgkmcnt(6)
    v_mfma_f32_16x16x32_bf16 v[160:163], v[208:211], v[36:39], v[160:163]
    ds_read_b64_tr_b16 v[204:205], v249 offset:28672
    v_mfma_f32_16x16x32_bf16 v[164:167], v[208:211], v[44:47], v[164:167]
    ds_read_b64_tr_b16 v[206:207], v249 offset:30720
    v_mfma_f32_16x16x32_bf16 v[168:171], v[212:215], v[36:39], v[168:171]
    ds_read_b64_tr_b16 v[208:209], v248 offset:32768
    buffer_load_dwordx4 v129, s[16:19], s31 offen offset:1024 lds
    v_mfma_f32_16x16x32_bf16 v[172:175], v[212:215], v[44:47], v[172:175]
    ds_read_b64_tr_b16 v[210:211], v248 offset:34816
    s_waitcnt lgkmcnt(6)
    v_mfma_f32_16x16x32_bf16 v[144:147], v[192:195], v[48:51], v[144:147]
    ds_read_b64_tr_b16 v[212:213], v249 offset:32768
    v_mfma_f32_16x16x32_bf16 v[148:151], v[192:195], v[56:59], v[148:151]
    ds_read_b64_tr_b16 v[214:215], v249 offset:34816
    v_mfma_f32_16x16x32_bf16 v[152:155], v[196:199], v[48:51], v[152:155]
    ds_read_b64_tr_b16 v[192:193], v248 offset:36864
    v_mfma_f32_16x16x32_bf16 v[156:159], v[196:199], v[56:59], v[156:159]
    ds_read_b64_tr_b16 v[194:195], v248 offset:38912
    s_waitcnt lgkmcnt(6)
    v_mfma_f32_16x16x32_bf16 v[144:147], v[200:203], v[52:55], v[144:147]
    ds_read_b64_tr_b16 v[196:197], v249 offset:36864
    buffer_load_dwordx4 v130, s[16:19], s32 offen offset:2048 lds
    v_mfma_f32_16x16x32_bf16 v[148:151], v[200:203], v[60:63], v[148:151]
    ds_read_b64_tr_b16 v[198:199], v249 offset:38912
    v_mfma_f32_16x16x32_bf16 v[152:155], v[204:207], v[52:55], v[152:155]
    ds_read_b64_tr_b16 v[200:201], v248 offset:40960
    v_mfma_f32_16x16x32_bf16 v[156:159], v[204:207], v[60:63], v[156:159]
    ds_read_b64_tr_b16 v[202:203], v248 offset:43008
    s_waitcnt lgkmcnt(6)
    v_mfma_f32_16x16x32_bf16 v[144:147], v[208:211], v[64:67], v[144:147]
    ds_read_b64_tr_b16 v[204:205], v249 offset:40960
    v_mfma_f32_16x16x32_bf16 v[148:151], v[208:211], v[72:75], v[148:151]
    ds_read_b64_tr_b16 v[206:207], v249 offset:43008
    buffer_load_dwordx4 v131, s[16:19], s33 offen offset:3072 lds
    v_mfma_f32_16x16x32_bf16 v[152:155], v[212:215], v[64:67], v[152:155]
    ds_read_b64_tr_b16 v[208:209], v248 offset:45056
    v_mfma_f32_16x16x32_bf16 v[156:159], v[212:215], v[72:75], v[156:159]
    ds_read_b64_tr_b16 v[210:211], v248 offset:47104
    v_add_u32 v248, 0xc000, v248
    s_waitcnt lgkmcnt(6)
    v_mfma_f32_16x16x32_bf16 v[144:147], v[192:195], v[68:71], v[144:147]
    ds_read_b64_tr_b16 v[212:213], v249 offset:45056
    v_cvt_pk_bf16_f32 v232, v232, v233
    v_mfma_f32_16x16x32_bf16 v[148:151], v[192:195], v[76:79], v[148:151]
    ds_read_b64_tr_b16 v[214:215], v249 offset:47104
    v_add_u32 v249, 0xc000, v249
    v_mfma_f32_16x16x32_bf16 v[152:155], v[196:199], v[68:71], v[152:155]
    ds_read_b64_tr_b16 v[192:193], v250 offset:24576
    v_cvt_pk_bf16_f32 v233, v234, v235
    v_mfma_f32_16x16x32_bf16 v[156:159], v[196:199], v[76:79], v[156:159]
    ds_read_b64_tr_b16 v[194:195], v250 offset:26624
    s_waitcnt lgkmcnt(6)
    v_mfma_f32_16x16x32_bf16 v[144:147], v[200:203], v[80:83], v[144:147]
    ds_read_b64_tr_b16 v[196:197], v251 offset:24576
    s_add_u32 m0, s36, 126976
    v_mfma_f32_16x16x32_bf16 v[148:151], v[200:203], v[88:91], v[148:151]
    ds_read_b64_tr_b16 v[198:199], v251 offset:26624
    buffer_load_dwordx4 v132, s[16:19], s34 offen offset:0 lds
    v_mfma_f32_16x16x32_bf16 v[152:155], v[204:207], v[80:83], v[152:155]
    ds_read_b64_tr_b16 v[200:201], v250 offset:28672
    v_cvt_pk_bf16_f32 v234, v240, v241
    v_mfma_f32_16x16x32_bf16 v[156:159], v[204:207], v[88:91], v[156:159]
    ds_read_b64_tr_b16 v[202:203], v250 offset:30720
    s_waitcnt lgkmcnt(6)
    v_mfma_f32_16x16x32_bf16 v[144:147], v[208:211], v[84:87], v[144:147]
    ds_read_b64_tr_b16 v[204:205], v251 offset:28672
    v_cvt_pk_bf16_f32 v235, v242, v243
    v_mfma_f32_16x16x32_bf16 v[148:151], v[208:211], v[92:95], v[148:151]
    ds_read_b64_tr_b16 v[206:207], v251 offset:30720
    buffer_store_dwordx4 v[232:235], v252, s[20:23], s50 offen offset:1024 sc1
    v_mfma_f32_16x16x32_bf16 v[152:155], v[212:215], v[84:87], v[152:155]
    ds_read_b64_tr_b16 v[208:209], v250 offset:32768
    buffer_load_dwordx4 v133, s[16:19], s35 offen offset:1024 lds
    v_mfma_f32_16x16x32_bf16 v[156:159], v[212:215], v[92:95], v[156:159]
    ds_read_b64_tr_b16 v[210:211], v250 offset:34816
    s_waitcnt lgkmcnt(6)
    v_mfma_f32_16x16x32_bf16 v[160:163], v[192:195], v[48:51], v[160:163]
    ds_read_b64_tr_b16 v[212:213], v251 offset:32768
    s_sub_u32 s16, s16, s49
    s_subb_u32 s17, s17, 0
    v_mfma_f32_16x16x32_bf16 v[164:167], v[192:195], v[56:59], v[164:167]
    ds_read_b64_tr_b16 v[214:215], v251 offset:34816
    v_cvt_pk_bf16_f32 v236, v236, v237
    v_mfma_f32_16x16x32_bf16 v[168:171], v[196:199], v[48:51], v[168:171]
    ds_read_b64_tr_b16 v[192:193], v250 offset:36864
    v_cvt_pk_bf16_f32 v237, v238, v239
    v_mfma_f32_16x16x32_bf16 v[172:175], v[196:199], v[56:59], v[172:175]
    ds_read_b64_tr_b16 v[194:195], v250 offset:38912
    s_waitcnt lgkmcnt(6)
    v_mfma_f32_16x16x32_bf16 v[160:163], v[200:203], v[52:55], v[160:163]
    ds_read_b64_tr_b16 v[196:197], v251 offset:36864
    v_cvt_pk_bf16_f32 v238, v244, v245
    v_mfma_f32_16x16x32_bf16 v[164:167], v[200:203], v[60:63], v[164:167]
    ds_read_b64_tr_b16 v[198:199], v251 offset:38912
    v_cvt_pk_bf16_f32 v239, v246, v247
    v_mfma_f32_16x16x32_bf16 v[168:171], v[204:207], v[52:55], v[168:171]
    ds_read_b64_tr_b16 v[200:201], v250 offset:40960
    buffer_store_dwordx4 v[236:239], v252, s[20:23], s51 offen offset:1024 sc1
    v_mfma_f32_16x16x32_bf16 v[172:175], v[204:207], v[60:63], v[172:175]
    ds_read_b64_tr_b16 v[202:203], v250 offset:43008
    s_waitcnt lgkmcnt(6)
    v_mfma_f32_16x16x32_bf16 v[160:163], v[208:211], v[64:67], v[160:163]
    ds_read_b64_tr_b16 v[204:205], v251 offset:40960
    s_add_u32 s50, s50, 2048
    v_mfma_f32_16x16x32_bf16 v[164:167], v[208:211], v[72:75], v[164:167]
    ds_read_b64_tr_b16 v[206:207], v251 offset:43008
    s_add_u32 s51, s51, 2048
    v_mfma_f32_16x16x32_bf16 v[168:171], v[212:215], v[64:67], v[168:171]
    ds_read_b64_tr_b16 v[208:209], v250 offset:45056
    v_mfma_f32_16x16x32_bf16 v[172:175], v[212:215], v[72:75], v[172:175]
    ds_read_b64_tr_b16 v[210:211], v250 offset:47104
    v_add_u32 v250, 0xc000, v250
    s_waitcnt lgkmcnt(6)
    v_mfma_f32_16x16x32_bf16 v[160:163], v[192:195], v[68:71], v[160:163]
    ds_read_b64_tr_b16 v[212:213], v251 offset:45056
    v_mfma_f32_16x16x32_bf16 v[164:167], v[192:195], v[76:79], v[164:167]
    ds_read_b64_tr_b16 v[214:215], v251 offset:47104
    v_add_u32 v251, 0xc000, v251
    s_waitcnt vmcnt(22)
    s_barrier
    v_mfma_f32_16x16x32_bf16 v[168:171], v[196:199], v[68:71], v[168:171]
    ds_read_b64_tr_b16 v[192:193], v248 offset:0
    v_mfma_f32_16x16x32_bf16 v[172:175], v[196:199], v[76:79], v[172:175]
    ds_read_b64_tr_b16 v[194:195], v248 offset:2048
    s_waitcnt lgkmcnt(6)
    v_mfma_f32_16x16x32_bf16 v[160:163], v[200:203], v[80:83], v[160:163]
    ds_read_b64_tr_b16 v[196:197], v249 offset:0
    s_add_u32 m0, s36, 0
    v_mfma_f32_16x16x32_bf16 v[164:167], v[200:203], v[88:91], v[164:167]
    ds_read_b64_tr_b16 v[198:199], v249 offset:2048
    buffer_load_dwordx4 v128, s[16:19], s30 offen offset:0 lds
    v_mfma_f32_16x16x32_bf16 v[168:171], v[204:207], v[80:83], v[168:171]
    ds_read_b64_tr_b16 v[200:201], v248 offset:4096
    v_mfma_f32_16x16x32_bf16 v[172:175], v[204:207], v[88:91], v[172:175]
    ds_read_b64_tr_b16 v[202:203], v248 offset:6144
    s_waitcnt lgkmcnt(6)
    v_mfma_f32_16x16x32_bf16 v[160:163], v[208:211], v[84:87], v[160:163]
    ds_read_b64_tr_b16 v[204:205], v249 offset:4096
    v_mfma_f32_16x16x32_bf16 v[164:167], v[208:211], v[92:95], v[164:167]
    ds_read_b64_tr_b16 v[206:207], v249 offset:6144
    v_mfma_f32_16x16x32_bf16 v[168:171], v[212:215], v[84:87], v[168:171]
    ds_read_b64_tr_b16 v[208:209], v248 offset:8192
    buffer_load_dwordx4 v129, s[16:19], s31 offen offset:1024 lds
    v_mfma_f32_16x16x32_bf16 v[172:175], v[212:215], v[92:95], v[172:175]
    ds_read_b64_tr_b16 v[210:211], v248 offset:10240
    s_waitcnt lgkmcnt(6)
    v_mfma_f32_16x16x32_bf16 v[144:147], v[192:195], v[96:99], v[144:147]
    ds_read_b64_tr_b16 v[212:213], v249 offset:8192
    v_mfma_f32_16x16x32_bf16 v[148:151], v[192:195], v[104:107], v[148:151]
    ds_read_b64_tr_b16 v[214:215], v249 offset:10240
    v_mfma_f32_16x16x32_bf16 v[152:155], v[196:199], v[96:99], v[152:155]
    ds_read_b64_tr_b16 v[192:193], v248 offset:12288
    v_mfma_f32_16x16x32_bf16 v[156:159], v[196:199], v[104:107], v[156:159]
    ds_read_b64_tr_b16 v[194:195], v248 offset:14336
    s_waitcnt lgkmcnt(6)
    v_mfma_f32_16x16x32_bf16 v[144:147], v[200:203], v[100:103], v[144:147]
    ds_read_b64_tr_b16 v[196:197], v249 offset:12288
    buffer_load_dwordx4 v130, s[16:19], s32 offen offset:2048 lds
    v_mfma_f32_16x16x32_bf16 v[148:151], v[200:203], v[108:111], v[148:151]
    ds_read_b64_tr_b16 v[198:199], v249 offset:14336
    v_mfma_f32_16x16x32_bf16 v[152:155], v[204:207], v[100:103], v[152:155]
    ds_read_b64_tr_b16 v[200:201], v248 offset:16384
    v_mfma_f32_16x16x32_bf16 v[156:159], v[204:207], v[108:111], v[156:159]
    ds_read_b64_tr_b16 v[202:203], v248 offset:18432
    s_waitcnt lgkmcnt(6)
    v_mfma_f32_16x16x32_bf16 v[144:147], v[208:211], v[112:115], v[144:147]
    ds_read_b64_tr_b16 v[204:205], v249 offset:16384
    v_mfma_f32_16x16x32_bf16 v[148:151], v[208:211], v[120:123], v[148:151]
    ds_read_b64_tr_b16 v[206:207], v249 offset:18432
    v_mfma_f32_16x16x32_bf16 v[152:155], v[212:215], v[112:115], v[152:155]
    ds_read_b64_tr_b16 v[208:209], v248 offset:20480
    buffer_load_dwordx4 v131, s[16:19], s33 offen offset:3072 lds
    v_mfma_f32_16x16x32_bf16 v[156:159], v[212:215], v[120:123], v[156:159]
    ds_read_b64_tr_b16 v[210:211], v248 offset:22528
    s_waitcnt lgkmcnt(6)
    v_mfma_f32_16x16x32_bf16 v[144:147], v[192:195], v[116:119], v[144:147]
    ds_read_b64_tr_b16 v[212:213], v249 offset:20480
    v_mfma_f32_16x16x32_bf16 v[148:151], v[192:195], v[124:127], v[148:151]
    ds_read_b64_tr_b16 v[214:215], v249 offset:22528
    v_mfma_f32_16x16x32_bf16 v[152:155], v[196:199], v[116:119], v[152:155]
    ds_read_b64_tr_b16 v[192:193], v250 offset:0
    s_add_u32 m0, s36, 4096
    v_mfma_f32_16x16x32_bf16 v[156:159], v[196:199], v[124:127], v[156:159]
    ds_read_b64_tr_b16 v[194:195], v250 offset:2048
    s_waitcnt lgkmcnt(6)
    v_mfma_f32_16x16x32_bf16 v[144:147], v[200:203], v[176:179], v[144:147]
    ds_read_b64_tr_b16 v[196:197], v251 offset:0
    buffer_load_dwordx4 v132, s[16:19], s34 offen offset:0 lds
    v_mfma_f32_16x16x32_bf16 v[148:151], v[200:203], v[184:187], v[148:151]
    ds_read_b64_tr_b16 v[198:199], v251 offset:2048
    v_mfma_f32_16x16x32_bf16 v[152:155], v[204:207], v[176:179], v[152:155]
    ds_read_b64_tr_b16 v[200:201], v250 offset:4096
    v_mfma_f32_16x16x32_bf16 v[156:159], v[204:207], v[184:187], v[156:159]
    ds_read_b64_tr_b16 v[202:203], v250 offset:6144
    s_waitcnt lgkmcnt(6)
    v_mfma_f32_16x16x32_bf16 v[144:147], v[208:211], v[180:183], v[144:147]
    ds_read_b64_tr_b16 v[204:205], v251 offset:4096
    v_mfma_f32_16x16x32_bf16 v[148:151], v[208:211], v[188:191], v[148:151]
    ds_read_b64_tr_b16 v[206:207], v251 offset:6144
    v_mfma_f32_16x16x32_bf16 v[152:155], v[212:215], v[180:183], v[152:155]
    ds_read_b64_tr_b16 v[208:209], v250 offset:8192
    buffer_load_dwordx4 v133, s[16:19], s35 offen offset:1024 lds
    v_mfma_f32_16x16x32_bf16 v[156:159], v[212:215], v[188:191], v[156:159]
    ds_read_b64_tr_b16 v[210:211], v250 offset:10240
    s_waitcnt lgkmcnt(6)
    v_mfma_f32_16x16x32_bf16 v[160:163], v[192:195], v[96:99], v[160:163]
    ds_read_b64_tr_b16 v[212:213], v251 offset:8192
    s_add_u32 s16, s16, s48
    s_addc_u32 s17, s17, 0
    v_mfma_f32_16x16x32_bf16 v[164:167], v[192:195], v[104:107], v[164:167]
    ds_read_b64_tr_b16 v[214:215], v251 offset:10240
    v_mfma_f32_16x16x32_bf16 v[168:171], v[196:199], v[96:99], v[168:171]
    ds_read_b64_tr_b16 v[192:193], v250 offset:12288
    v_mfma_f32_16x16x32_bf16 v[172:175], v[196:199], v[104:107], v[172:175]
    ds_read_b64_tr_b16 v[194:195], v250 offset:14336
    s_waitcnt lgkmcnt(6)
    v_mfma_f32_16x16x32_bf16 v[160:163], v[200:203], v[100:103], v[160:163]
    ds_read_b64_tr_b16 v[196:197], v251 offset:12288
    v_mfma_f32_16x16x32_bf16 v[164:167], v[200:203], v[108:111], v[164:167]
    ds_read_b64_tr_b16 v[198:199], v251 offset:14336
    v_mfma_f32_16x16x32_bf16 v[168:171], v[204:207], v[100:103], v[168:171]
    ds_read_b64_tr_b16 v[200:201], v250 offset:16384
    v_mfma_f32_16x16x32_bf16 v[172:175], v[204:207], v[108:111], v[172:175]
    ds_read_b64_tr_b16 v[202:203], v250 offset:18432
    s_waitcnt lgkmcnt(6)
    v_mfma_f32_16x16x32_bf16 v[160:163], v[208:211], v[112:115], v[160:163]
    ds_read_b64_tr_b16 v[204:205], v251 offset:16384
    v_mfma_f32_16x16x32_bf16 v[164:167], v[208:211], v[120:123], v[164:167]
    ds_read_b64_tr_b16 v[206:207], v251 offset:18432
    v_mfma_f32_16x16x32_bf16 v[168:171], v[212:215], v[112:115], v[168:171]
    ds_read_b64_tr_b16 v[208:209], v250 offset:20480
    v_mfma_f32_16x16x32_bf16 v[172:175], v[212:215], v[120:123], v[172:175]
    ds_read_b64_tr_b16 v[210:211], v250 offset:22528
    s_waitcnt lgkmcnt(6)
    v_mfma_f32_16x16x32_bf16 v[160:163], v[192:195], v[116:119], v[160:163]
    ds_read_b64_tr_b16 v[212:213], v251 offset:20480
    v_mfma_f32_16x16x32_bf16 v[164:167], v[192:195], v[124:127], v[164:167]
    ds_read_b64_tr_b16 v[214:215], v251 offset:22528
    s_waitcnt vmcnt(22)
    s_barrier
    s_cmp_eq_u32 s38, 2
    s_cbranch_scc1 L_mlp_sig_1051
L_mlp_sigb_1053:
    v_mfma_f32_16x16x32_bf16 v[168:171], v[196:199], v[116:119], v[168:171]
    ds_read_b64_tr_b16 v[192:193], v248 offset:24576
    v_mfma_f32_16x16x32_bf16 v[172:175], v[196:199], v[124:127], v[172:175]
    ds_read_b64_tr_b16 v[194:195], v248 offset:26624
    s_waitcnt lgkmcnt(6)
    v_mfma_f32_16x16x32_bf16 v[160:163], v[200:203], v[176:179], v[160:163]
    ds_read_b64_tr_b16 v[196:197], v249 offset:24576
    s_add_u32 m0, s36, 24576
    v_mfma_f32_16x16x32_bf16 v[164:167], v[200:203], v[184:187], v[164:167]
    ds_read_b64_tr_b16 v[198:199], v249 offset:26624
    buffer_load_dwordx4 v128, s[16:19], s30 offen offset:0 lds
    v_mfma_f32_16x16x32_bf16 v[168:171], v[204:207], v[176:179], v[168:171]
    ds_read_b64_tr_b16 v[200:201], v248 offset:28672
    v_mfma_f32_16x16x32_bf16 v[172:175], v[204:207], v[184:187], v[172:175]
    ds_read_b64_tr_b16 v[202:203], v248 offset:30720
    s_waitcnt lgkmcnt(6)
    v_mfma_f32_16x16x32_bf16 v[160:163], v[208:211], v[180:183], v[160:163]
    ds_read_b64_tr_b16 v[204:205], v249 offset:28672
    v_mfma_f32_16x16x32_bf16 v[164:167], v[208:211], v[188:191], v[164:167]
    ds_read_b64_tr_b16 v[206:207], v249 offset:30720
    v_mfma_f32_16x16x32_bf16 v[168:171], v[212:215], v[180:183], v[168:171]
    ds_read_b64_tr_b16 v[208:209], v248 offset:32768
    v_mfma_f32_16x16x32_bf16 v[172:175], v[212:215], v[188:191], v[172:175]
    ds_read_b64_tr_b16 v[210:211], v248 offset:34816
    s_cmp_eq_u32 s38, 4
    s_cbranch_scc1 L_mlp_done_1050
    s_waitcnt lgkmcnt(6)
    v_mfma_f32_16x16x32_bf16 v[216:219], v[192:195], v[0:3], 0
    ds_read_b64_tr_b16 v[212:213], v249 offset:32768
    buffer_load_dwordx4 v129, s[16:19], s31 offen offset:1024 lds
    v_mfma_f32_16x16x32_bf16 v[220:223], v[192:195], v[8:11], 0
    ds_read_b64_tr_b16 v[214:215], v249 offset:34816
    v_mfma_f32_16x16x32_bf16 v[224:227], v[196:199], v[0:3], 0
    ds_read_b64_tr_b16 v[192:193], v248 offset:36864
    v_mfma_f32_16x16x32_bf16 v[228:231], v[196:199], v[8:11], 0
    ds_read_b64_tr_b16 v[194:195], v248 offset:38912
    s_waitcnt lgkmcnt(6)
    v_mfma_f32_16x16x32_bf16 v[216:219], v[200:203], v[4:7], v[216:219]
    ds_read_b64_tr_b16 v[196:197], v249 offset:36864
    v_mfma_f32_16x16x32_bf16 v[220:223], v[200:203], v[12:15], v[220:223]
    ds_read_b64_tr_b16 v[198:199], v249 offset:38912
    buffer_load_dwordx4 v130, s[16:19], s32 offen offset:2048 lds
    v_mfma_f32_16x16x32_bf16 v[224:227], v[204:207], v[4:7], v[224:227]
    ds_read_b64_tr_b16 v[200:201], v248 offset:40960
    v_mfma_f32_16x16x32_bf16 v[228:231], v[204:207], v[12:15], v[228:231]
    ds_read_b64_tr_b16 v[202:203], v248 offset:43008
    s_waitcnt lgkmcnt(6)
    v_mfma_f32_16x16x32_bf16 v[216:219], v[208:211], v[16:19], v[216:219]
    ds_read_b64_tr_b16 v[204:205], v249 offset:40960
    v_mfma_f32_16x16x32_bf16 v[220:223], v[208:211], v[24:27], v[220:223]
    ds_read_b64_tr_b16 v[206:207], v249 offset:43008
    v_mfma_f32_16x16x32_bf16 v[224:227], v[212:215], v[16:19], v[224:227]
    ds_read_b64_tr_b16 v[208:209], v248 offset:45056
    buffer_load_dwordx4 v131, s[16:19], s33 offen offset:3072 lds
    v_mfma_f32_16x16x32_bf16 v[228:231], v[212:215], v[24:27], v[228:231]
    ds_read_b64_tr_b16 v[210:211], v248 offset:47104
    v_add_u32 v248, 0xc000, v248
    s_waitcnt lgkmcnt(6)
    v_mfma_f32_16x16x32_bf16 v[216:219], v[192:195], v[20:23], v[216:219]
    ds_read_b64_tr_b16 v[212:213], v249 offset:45056
    s_mov_b32 s22, 0x10000000
    v_mfma_f32_16x16x32_bf16 v[220:223], v[192:195], v[28:31], v[220:223]
    ds_read_b64_tr_b16 v[214:215], v249 offset:47104
    v_add_u32 v249, 0xc000, v249
    v_mfma_f32_16x16x32_bf16 v[224:227], v[196:199], v[20:23], v[224:227]
    ds_read_b64_tr_b16 v[192:193], v250 offset:24576
    v_cvt_pk_bf16_f32 v144, v144, v145
    v_mfma_f32_16x16x32_bf16 v[228:231], v[196:199], v[28:31], v[228:231]
    ds_read_b64_tr_b16 v[194:195], v250 offset:26624
    s_waitcnt lgkmcnt(6)
    v_mfma_f32_16x16x32_bf16 v[216:219], v[200:203], v[32:35], v[216:219]
    ds_read_b64_tr_b16 v[196:197], v251 offset:24576
    s_add_u32 m0, s36, 28672
    v_mfma_f32_16x16x32_bf16 v[220:223], v[200:203], v[40:43], v[220:223]
    ds_read_b64_tr_b16 v[198:199], v251 offset:26624
    buffer_load_dwordx4 v132, s[16:19], s34 offen offset:0 lds
    v_mfma_f32_16x16x32_bf16 v[224:227], v[204:207], v[32:35], v[224:227]
    ds_read_b64_tr_b16 v[200:201], v250 offset:28672
    v_cvt_pk_bf16_f32 v145, v146, v147
    v_mfma_f32_16x16x32_bf16 v[228:231], v[204:207], v[40:43], v[228:231]
    ds_read_b64_tr_b16 v[202:203], v250 offset:30720
    s_waitcnt lgkmcnt(6)
    v_mfma_f32_16x16x32_bf16 v[216:219], v[208:211], v[36:39], v[216:219]
    ds_read_b64_tr_b16 v[204:205], v251 offset:28672
    v_cvt_pk_bf16_f32 v146, v152, v153
    v_mfma_f32_16x16x32_bf16 v[220:223], v[208:211], v[44:47], v[220:223]
    ds_read_b64_tr_b16 v[206:207], v251 offset:30720
    v_cvt_pk_bf16_f32 v147, v154, v155
    v_mfma_f32_16x16x32_bf16 v[224:227], v[212:215], v[36:39], v[224:227]
    ds_read_b64_tr_b16 v[208:209], v250 offset:32768
    buffer_load_dwordx4 v133, s[16:19], s35 offen offset:1024 lds
    v_mfma_f32_16x16x32_bf16 v[228:231], v[212:215], v[44:47], v[228:231]
    ds_read_b64_tr_b16 v[210:211], v250 offset:34816
    s_waitcnt lgkmcnt(6)
    v_mfma_f32_16x16x32_bf16 v[232:235], v[192:195], v[0:3], 0
    ds_read_b64_tr_b16 v[212:213], v251 offset:32768
    s_add_u32 s16, s16, s48
    s_addc_u32 s17, s17, 0
    v_mfma_f32_16x16x32_bf16 v[236:239], v[192:195], v[8:11], 0
    ds_read_b64_tr_b16 v[214:215], v251 offset:34816
    buffer_store_dwordx4 v[144:147], v252, s[20:23], s50 offen offset:0 sc1
    v_mfma_f32_16x16x32_bf16 v[240:243], v[196:199], v[0:3], 0
    ds_read_b64_tr_b16 v[192:193], v250 offset:36864
    v_cvt_pk_bf16_f32 v148, v148, v149
    v_mfma_f32_16x16x32_bf16 v[244:247], v[196:199], v[8:11], 0
    ds_read_b64_tr_b16 v[194:195], v250 offset:38912
    s_waitcnt lgkmcnt(6)
    v_mfma_f32_16x16x32_bf16 v[232:235], v[200:203], v[4:7], v[232:235]
    ds_read_b64_tr_b16 v[196:197], v251 offset:36864
    v_cvt_pk_bf16_f32 v149, v150, v151
    v_mfma_f32_16x16x32_bf16 v[236:239], v[200:203], v[12:15], v[236:239]
    ds_read_b64_tr_b16 v[198:199], v251 offset:38912
    v_cvt_pk_bf16_f32 v150, v156, v157
    v_mfma_f32_16x16x32_bf16 v[240:243], v[204:207], v[4:7], v[240:243]
    ds_read_b64_tr_b16 v[200:201], v250 offset:40960
    v_cvt_pk_bf16_f32 v151, v158, v159
    v_mfma_f32_16x16x32_bf16 v[244:247], v[204:207], v[12:15], v[244:247]
    ds_read_b64_tr_b16 v[202:203], v250 offset:43008
    s_waitcnt lgkmcnt(6)
    v_mfma_f32_16x16x32_bf16 v[232:235], v[208:211], v[16:19], v[232:235]
    ds_read_b64_tr_b16 v[204:205], v251 offset:40960
    buffer_store_dwordx4 v[148:151], v252, s[20:23], s51 offen offset:0 sc1
    v_mfma_f32_16x16x32_bf16 v[236:239], v[208:211], v[24:27], v[236:239]
    ds_read_b64_tr_b16 v[206:207], v251 offset:43008
    v_mfma_f32_16x16x32_bf16 v[240:243], v[212:215], v[16:19], v[240:243]
    ds_read_b64_tr_b16 v[208:209], v250 offset:45056
    v_mfma_f32_16x16x32_bf16 v[244:247], v[212:215], v[24:27], v[244:247]
    ds_read_b64_tr_b16 v[210:211], v250 offset:47104
    v_add_u32 v250, 0xc000, v250
    s_waitcnt lgkmcnt(6)
    v_mfma_f32_16x16x32_bf16 v[232:235], v[192:195], v[20:23], v[232:235]
    ds_read_b64_tr_b16 v[212:213], v251 offset:45056
    v_mfma_f32_16x16x32_bf16 v[236:239], v[192:195], v[28:31], v[236:239]
    ds_read_b64_tr_b16 v[214:215], v251 offset:47104
    v_add_u32 v251, 0xc000, v251
    s_waitcnt vmcnt(24)
    s_barrier
    s_cmp_eq_u32 s38, 2
    s_cbranch_scc1 L_mlp_chk_1055
L_mlp_chkb_1057:
    v_mfma_f32_16x16x32_bf16 v[240:243], v[196:199], v[20:23], v[240:243]
    ds_read_b64_tr_b16 v[192:193], v248 offset:0
    v_mfma_f32_16x16x32_bf16 v[244:247], v[196:199], v[28:31], v[244:247]
    ds_read_b64_tr_b16 v[194:195], v248 offset:2048
    s_waitcnt lgkmcnt(6)
    v_mfma_f32_16x16x32_bf16 v[232:235], v[200:203], v[32:35], v[232:235]
    ds_read_b64_tr_b16 v[196:197], v249 offset:0
    s_cmp_eq_u32 s38, 3
    s_cselect_b32 s48, 0, s48
    s_cselect_b32 s49, 0, s49
    v_mfma_f32_16x16x32_bf16 v[236:239], v[200:203], v[40:43], v[236:239]
    ds_read_b64_tr_b16 v[198:199], v249 offset:2048
    s_add_u32 m0, s36, 49152
    v_mfma_f32_16x16x32_bf16 v[240:243], v[204:207], v[32:35], v[240:243]
    ds_read_b64_tr_b16 v[200:201], v248 offset:4096
    buffer_load_dwordx4 v128, s[16:19], s30 offen offset:0 lds
    v_mfma_f32_16x16x32_bf16 v[244:247], v[204:207], v[40:43], v[244:247]
    ds_read_b64_tr_b16 v[202:203], v248 offset:6144
    s_waitcnt lgkmcnt(6)
    v_mfma_f32_16x16x32_bf16 v[232:235], v[208:211], v[36:39], v[232:235]
    ds_read_b64_tr_b16 v[204:205], v249 offset:4096
    v_mfma_f32_16x16x32_bf16 v[236:239], v[208:211], v[44:47], v[236:239]
    ds_read_b64_tr_b16 v[206:207], v249 offset:6144
    v_mfma_f32_16x16x32_bf16 v[240:243], v[212:215], v[36:39], v[240:243]
    ds_read_b64_tr_b16 v[208:209], v248 offset:8192
    buffer_load_dwordx4 v129, s[16:19], s31 offen offset:1024 lds
    v_mfma_f32_16x16x32_bf16 v[244:247], v[212:215], v[44:47], v[244:247]
    ds_read_b64_tr_b16 v[210:211], v248 offset:10240
    s_waitcnt lgkmcnt(6)
    v_mfma_f32_16x16x32_bf16 v[216:219], v[192:195], v[48:51], v[216:219]
    ds_read_b64_tr_b16 v[212:213], v249 offset:8192
    v_mfma_f32_16x16x32_bf16 v[220:223], v[192:195], v[56:59], v[220:223]
    ds_read_b64_tr_b16 v[214:215], v249 offset:10240
    v_mfma_f32_16x16x32_bf16 v[224:227], v[196:199], v[48:51], v[224:227]
    ds_read_b64_tr_b16 v[192:193], v248 offset:12288
    v_mfma_f32_16x16x32_bf16 v[228:231], v[196:199], v[56:59], v[228:231]
    ds_read_b64_tr_b16 v[194:195], v248 offset:14336
    s_waitcnt lgkmcnt(6)
    v_mfma_f32_16x16x32_bf16 v[216:219], v[200:203], v[52:55], v[216:219]
    ds_read_b64_tr_b16 v[196:197], v249 offset:12288
    buffer_load_dwordx4 v130, s[16:19], s32 offen offset:2048 lds
    v_mfma_f32_16x16x32_bf16 v[220:223], v[200:203], v[60:63], v[220:223]
    ds_read_b64_tr_b16 v[198:199], v249 offset:14336
    v_mfma_f32_16x16x32_bf16 v[224:227], v[204:207], v[52:55], v[224:227]
    ds_read_b64_tr_b16 v[200:201], v248 offset:16384
    v_mfma_f32_16x16x32_bf16 v[228:231], v[204:207], v[60:63], v[228:231]
    ds_read_b64_tr_b16 v[202:203], v248 offset:18432
    s_waitcnt lgkmcnt(6)
    v_mfma_f32_16x16x32_bf16 v[216:219], v[208:211], v[64:67], v[216:219]
    ds_read_b64_tr_b16 v[204:205], v249 offset:16384
    v_mfma_f32_16x16x32_bf16 v[220:223], v[208:211], v[72:75], v[220:223]
    ds_read_b64_tr_b16 v[206:207], v249 offset:18432
    v_mfma_f32_16x16x32_bf16 v[224:227], v[212:215], v[64:67], v[224:227]
    ds_read_b64_tr_b16 v[208:209], v248 offset:20480
    buffer_load_dwordx4 v131, s[16:19], s33 offen offset:3072 lds
    v_mfma_f32_16x16x32_bf16 v[228:231], v[212:215], v[72:75], v[228:231]
    ds_read_b64_tr_b16 v[210:211], v248 offset:22528
    s_waitcnt lgkmcnt(6)
    v_mfma_f32_16x16x32_bf16 v[216:219], v[192:195], v[68:71], v[216:219]
    ds_read_b64_tr_b16 v[212:213], v249 offset:20480
    v_cvt_pk_bf16_f32 v160, v160, v161
    v_mfma_f32_16x16x32_bf16 v[220:223], v[192:195], v[76:79], v[220:223]
    ds_read_b64_tr_b16 v[214:215], v249 offset:22528
    v_cvt_pk_bf16_f32 v161, v162, v163
    v_mfma_f32_16x16x32_bf16 v[224:227], v[196:199], v[68:71], v[224:227]
    ds_read_b64_tr_b16 v[192:193], v250 offset:0
    s_add_u32 m0, s36, 53248
    v_mfma_f32_16x16x32_bf16 v[228:231], v[196:199], v[76:79], v[228:231]
    ds_read_b64_tr_b16 v[194:195], v250 offset:2048
    s_waitcnt lgkmcnt(6)
    v_mfma_f32_16x16x32_bf16 v[216:219], v[200:203], v[80:83], v[216:219]
    ds_read_b64_tr_b16 v[196:197], v251 offset:0
    buffer_load_dwordx4 v132, s[16:19], s34 offen offset:0 lds
    v_mfma_f32_16x16x32_bf16 v[220:223], v[200:203], v[88:91], v[220:223]
    ds_read_b64_tr_b16 v[198:199], v251 offset:2048
    v_cvt_pk_bf16_f32 v162, v168, v169
    v_mfma_f32_16x16x32_bf16 v[224:227], v[204:207], v[80:83], v[224:227]
    ds_read_b64_tr_b16 v[200:201], v250 offset:4096
    v_cvt_pk_bf16_f32 v163, v170, v171
    v_mfma_f32_16x16x32_bf16 v[228:231], v[204:207], v[88:91], v[228:231]
    ds_read_b64_tr_b16 v[202:203], v250 offset:6144
    s_waitcnt lgkmcnt(6)
    v_mfma_f32_16x16x32_bf16 v[216:219], v[208:211], v[84:87], v[216:219]
    ds_read_b64_tr_b16 v[204:205], v251 offset:4096
    buffer_store_dwordx4 v[160:163], v252, s[20:23], s50 offen offset:1024 sc1
    v_mfma_f32_16x16x32_bf16 v[220:223], v[208:211], v[92:95], v[220:223]
    ds_read_b64_tr_b16 v[206:207], v251 offset:6144
    v_cvt_pk_bf16_f32 v164, v164, v165
    v_mfma_f32_16x16x32_bf16 v[224:227], v[212:215], v[84:87], v[224:227]
    ds_read_b64_tr_b16 v[208:209], v250 offset:8192
    buffer_load_dwordx4 v133, s[16:19], s35 offen offset:1024 lds
    v_mfma_f32_16x16x32_bf16 v[228:231], v[212:215], v[92:95], v[228:231]
    ds_read_b64_tr_b16 v[210:211], v250 offset:10240
    s_waitcnt lgkmcnt(6)
    v_mfma_f32_16x16x32_bf16 v[232:235], v[192:195], v[48:51], v[232:235]
    ds_read_b64_tr_b16 v[212:213], v251 offset:8192
    s_sub_u32 s16, s16, s49
    s_subb_u32 s17, s17, 0
    v_mfma_f32_16x16x32_bf16 v[236:239], v[192:195], v[56:59], v[236:239]
    ds_read_b64_tr_b16 v[214:215], v251 offset:10240
    v_cvt_pk_bf16_f32 v165, v166, v167
    v_mfma_f32_16x16x32_bf16 v[240:243], v[196:199], v[48:51], v[240:243]
    ds_read_b64_tr_b16 v[192:193], v250 offset:12288
    v_cvt_pk_bf16_f32 v166, v172, v173
    v_mfma_f32_16x16x32_bf16 v[244:247], v[196:199], v[56:59], v[244:247]
    ds_read_b64_tr_b16 v[194:195], v250 offset:14336
    s_waitcnt lgkmcnt(6)
    v_mfma_f32_16x16x32_bf16 v[232:235], v[200:203], v[52:55], v[232:235]
    ds_read_b64_tr_b16 v[196:197], v251 offset:12288
    v_cvt_pk_bf16_f32 v167, v174, v175
    v_mfma_f32_16x16x32_bf16 v[236:239], v[200:203], v[60:63], v[236:239]
    ds_read_b64_tr_b16 v[198:199], v251 offset:14336
    buffer_store_dwordx4 v[164:167], v252, s[20:23], s51 offen offset:1024 sc1
    v_mfma_f32_16x16x32_bf16 v[240:243], v[204:207], v[52:55], v[240:243]
    ds_read_b64_tr_b16 v[200:201], v250 offset:16384
    s_add_u32 s50, s50, 2048
    v_mfma_f32_16x16x32_bf16 v[244:247], v[204:207], v[60:63], v[244:247]
    ds_read_b64_tr_b16 v[202:203], v250 offset:18432
    s_waitcnt lgkmcnt(6)
    v_mfma_f32_16x16x32_bf16 v[232:235], v[208:211], v[64:67], v[232:235]
    ds_read_b64_tr_b16 v[204:205], v251 offset:16384
    s_add_u32 s51, s51, 2048
    v_mfma_f32_16x16x32_bf16 v[236:239], v[208:211], v[72:75], v[236:239]
    ds_read_b64_tr_b16 v[206:207], v251 offset:18432
    v_mfma_f32_16x16x32_bf16 v[240:243], v[212:215], v[64:67], v[240:243]
    ds_read_b64_tr_b16 v[208:209], v250 offset:20480
    v_mfma_f32_16x16x32_bf16 v[244:247], v[212:215], v[72:75], v[244:247]
    ds_read_b64_tr_b16 v[210:211], v250 offset:22528
    s_waitcnt lgkmcnt(6)
    v_mfma_f32_16x16x32_bf16 v[232:235], v[192:195], v[68:71], v[232:235]
    ds_read_b64_tr_b16 v[212:213], v251 offset:20480
    v_mfma_f32_16x16x32_bf16 v[236:239], v[192:195], v[76:79], v[236:239]
    ds_read_b64_tr_b16 v[214:215], v251 offset:22528
    s_waitcnt vmcnt(23)
    s_barrier
    s_cmp_eq_u32 s38, 3
    s_cbranch_scc1 L_mlp_we_1059
L_mlp_web_1060:
    v_mfma_f32_16x16x32_bf16 v[240:243], v[196:199], v[68:71], v[240:243]
    ds_read_b64_tr_b16 v[192:193], v248 offset:24576
    v_mfma_f32_16x16x32_bf16 v[244:247], v[196:199], v[76:79], v[244:247]
    ds_read_b64_tr_b16 v[194:195], v248 offset:26624
    s_waitcnt lgkmcnt(6)
    v_mfma_f32_16x16x32_bf16 v[232:235], v[200:203], v[80:83], v[232:235]
    ds_read_b64_tr_b16 v[196:197], v249 offset:24576
    s_add_u32 m0, s36, 73728
    v_mfma_f32_16x16x32_bf16 v[236:239], v[200:203], v[88:91], v[236:239]
    ds_read_b64_tr_b16 v[198:199], v249 offset:26624
    buffer_load_dwordx4 v128, s[16:19], s30 offen offset:0 lds
    v_mfma_f32_16x16x32_bf16 v[240:243], v[204:207], v[80:83], v[240:243]
    ds_read_b64_tr_b16 v[200:201], v248 offset:28672
    v_mfma_f32_16x16x32_bf16 v[244:247], v[204:207], v[88:91], v[244:247]
    ds_read_b64_tr_b16 v[202:203], v248 offset:30720
    s_waitcnt lgkmcnt(6)
    v_mfma_f32_16x16x32_bf16 v[232:235], v[208:211], v[84:87], v[232:235]
    ds_read_b64_tr_b16 v[204:205], v249 offset:28672
    v_mfma_f32_16x16x32_bf16 v[236:239], v[208:211], v[92:95], v[236:239]
    ds_read_b64_tr_b16 v[206:207], v249 offset:30720
    v_mfma_f32_16x16x32_bf16 v[240:243], v[212:215], v[84:87], v[240:243]
    ds_read_b64_tr_b16 v[208:209], v248 offset:32768
    buffer_load_dwordx4 v129, s[16:19], s31 offen offset:1024 lds
    v_mfma_f32_16x16x32_bf16 v[244:247], v[212:215], v[92:95], v[244:247]
    ds_read_b64_tr_b16 v[210:211], v248 offset:34816
    s_waitcnt lgkmcnt(6)
    v_mfma_f32_16x16x32_bf16 v[216:219], v[192:195], v[96:99], v[216:219]
    ds_read_b64_tr_b16 v[212:213], v249 offset:32768
    v_mfma_f32_16x16x32_bf16 v[220:223], v[192:195], v[104:107], v[220:223]
    ds_read_b64_tr_b16 v[214:215], v249 offset:34816
    v_mfma_f32_16x16x32_bf16 v[224:227], v[196:199], v[96:99], v[224:227]
    ds_read_b64_tr_b16 v[192:193], v248 offset:36864
    v_mfma_f32_16x16x32_bf16 v[228:231], v[196:199], v[104:107], v[228:231]
    ds_read_b64_tr_b16 v[194:195], v248 offset:38912
    s_waitcnt lgkmcnt(6)
    v_mfma_f32_16x16x32_bf16 v[216:219], v[200:203], v[100:103], v[216:219]
    ds_read_b64_tr_b16 v[196:197], v249 offset:36864
    buffer_load_dwordx4 v130, s[16:19], s32 offen offset:2048 lds
    v_mfma_f32_16x16x32_bf16 v[220:223], v[200:203], v[108:111], v[220:223]
    ds_read_b64_tr_b16 v[198:199], v249 offset:38912
    v_mfma_f32_16x16x32_bf16 v[224:227], v[204:207], v[100:103], v[224:227]
    ds_read_b64_tr_b16 v[200:201], v248 offset:40960
    v_mfma_f32_16x16x32_bf16 v[228:231], v[204:207], v[108:111], v[228:231]
    ds_read_b64_tr_b16 v[202:203], v248 offset:43008
    s_waitcnt lgkmcnt(6)
    v_mfma_f32_16x16x32_bf16 v[216:219], v[208:211], v[112:115], v[216:219]
    ds_read_b64_tr_b16 v[204:205], v249 offset:40960
    v_mfma_f32_16x16x32_bf16 v[220:223], v[208:211], v[120:123], v[220:223]
    ds_read_b64_tr_b16 v[206:207], v249 offset:43008
    buffer_load_dwordx4 v131, s[16:19], s33 offen offset:3072 lds
    v_mfma_f32_16x16x32_bf16 v[224:227], v[212:215], v[112:115], v[224:227]
    ds_read_b64_tr_b16 v[208:209], v248 offset:45056
    v_mfma_f32_16x16x32_bf16 v[228:231], v[212:215], v[120:123], v[228:231]
    ds_read_b64_tr_b16 v[210:211], v248 offset:47104
    v_add_u32 v248, 0xfffe8000, v248
    s_waitcnt lgkmcnt(6)
    v_mfma_f32_16x16x32_bf16 v[216:219], v[192:195], v[116:119], v[216:219]
    ds_read_b64_tr_b16 v[212:213], v249 offset:45056
    v_mfma_f32_16x16x32_bf16 v[220:223], v[192:195], v[124:127], v[220:223]
    ds_read_b64_tr_b16 v[214:215], v249 offset:47104
    v_add_u32 v249, 0xfffe8000, v249
    v_mfma_f32_16x16x32_bf16 v[224:227], v[196:199], v[116:119], v[224:227]
    ds_read_b64_tr_b16 v[192:193], v250 offset:24576
    v_mfma_f32_16x16x32_bf16 v[228:231], v[196:199], v[124:127], v[228:231]
    ds_read_b64_tr_b16 v[194:195], v250 offset:26624
    s_waitcnt lgkmcnt(6)
    v_mfma_f32_16x16x32_bf16 v[216:219], v[200:203], v[176:179], v[216:219]
    ds_read_b64_tr_b16 v[196:197], v251 offset:24576
    s_add_u32 m0, s36, 77824
    v_mfma_f32_16x16x32_bf16 v[220:223], v[200:203], v[184:187], v[220:223]
    ds_read_b64_tr_b16 v[198:199], v251 offset:26624
    buffer_load_dwordx4 v132, s[16:19], s34 offen offset:0 lds
    v_mfma_f32_16x16x32_bf16 v[224:227], v[204:207], v[176:179], v[224:227]
    ds_read_b64_tr_b16 v[200:201], v250 offset:28672
    v_mfma_f32_16x16x32_bf16 v[228:231], v[204:207], v[184:187], v[228:231]
    ds_read_b64_tr_b16 v[202:203], v250 offset:30720
    s_waitcnt lgkmcnt(6)
    v_mfma_f32_16x16x32_bf16 v[216:219], v[208:211], v[180:183], v[216:219]
    ds_read_b64_tr_b16 v[204:205], v251 offset:28672
    v_mfma_f32_16x16x32_bf16 v[220:223], v[208:211], v[188:191], v[220:223]
    ds_read_b64_tr_b16 v[206:207], v251 offset:30720
    v_mfma_f32_16x16x32_bf16 v[224:227], v[212:215], v[180:183], v[224:227]
    ds_read_b64_tr_b16 v[208:209], v250 offset:32768
    buffer_load_dwordx4 v133, s[16:19], s35 offen offset:1024 lds
    v_mfma_f32_16x16x32_bf16 v[228:231], v[212:215], v[188:191], v[228:231]
    ds_read_b64_tr_b16 v[210:211], v250 offset:34816
    s_waitcnt lgkmcnt(6)
    v_mfma_f32_16x16x32_bf16 v[232:235], v[192:195], v[96:99], v[232:235]
    ds_read_b64_tr_b16 v[212:213], v251 offset:32768
    s_add_u32 s16, s16, s48
    s_addc_u32 s17, s17, 0
    v_mfma_f32_16x16x32_bf16 v[236:239], v[192:195], v[104:107], v[236:239]
    ds_read_b64_tr_b16 v[214:215], v251 offset:34816
    v_mfma_f32_16x16x32_bf16 v[240:243], v[196:199], v[96:99], v[240:243]
    ds_read_b64_tr_b16 v[192:193], v250 offset:36864
    v_mfma_f32_16x16x32_bf16 v[244:247], v[196:199], v[104:107], v[244:247]
    ds_read_b64_tr_b16 v[194:195], v250 offset:38912
    s_waitcnt lgkmcnt(6)
    v_mfma_f32_16x16x32_bf16 v[232:235], v[200:203], v[100:103], v[232:235]
    ds_read_b64_tr_b16 v[196:197], v251 offset:36864
    v_mfma_f32_16x16x32_bf16 v[236:239], v[200:203], v[108:111], v[236:239]
    ds_read_b64_tr_b16 v[198:199], v251 offset:38912
    v_mfma_f32_16x16x32_bf16 v[240:243], v[204:207], v[100:103], v[240:243]
    ds_read_b64_tr_b16 v[200:201], v250 offset:40960
    v_mfma_f32_16x16x32_bf16 v[244:247], v[204:207], v[108:111], v[244:247]
    ds_read_b64_tr_b16 v[202:203], v250 offset:43008
    s_waitcnt lgkmcnt(6)
    v_mfma_f32_16x16x32_bf16 v[232:235], v[208:211], v[112:115], v[232:235]
    ds_read_b64_tr_b16 v[204:205], v251 offset:40960
    v_mfma_f32_16x16x32_bf16 v[236:239], v[208:211], v[120:123], v[236:239]
    ds_read_b64_tr_b16 v[206:207], v251 offset:43008
    v_mfma_f32_16x16x32_bf16 v[240:243], v[212:215], v[112:115], v[240:243]
    ds_read_b64_tr_b16 v[208:209], v250 offset:45056
    v_mfma_f32_16x16x32_bf16 v[244:247], v[212:215], v[120:123], v[244:247]
    ds_read_b64_tr_b16 v[210:211], v250 offset:47104
    v_add_u32 v250, 0xfffe8000, v250
    s_waitcnt lgkmcnt(6)
    v_mfma_f32_16x16x32_bf16 v[232:235], v[192:195], v[116:119], v[232:235]
    ds_read_b64_tr_b16 v[212:213], v251 offset:45056
    v_mfma_f32_16x16x32_bf16 v[236:239], v[192:195], v[124:127], v[236:239]
    ds_read_b64_tr_b16 v[214:215], v251 offset:47104
    v_add_u32 v251, 0xfffe8000, v251
    s_waitcnt vmcnt(22)
    s_barrier
    s_cmp_eq_u32 s38, 3
    s_cbranch_scc1 L_mlp_sig_1052
L_mlp_sigb_1054:
    v_mfma_f32_16x16x32_bf16 v[240:243], v[196:199], v[116:119], v[240:243]
    ds_read_b64_tr_b16 v[192:193], v248 offset:0
    v_mfma_f32_16x16x32_bf16 v[244:247], v[196:199], v[124:127], v[244:247]
    ds_read_b64_tr_b16 v[194:195], v248 offset:2048
    s_waitcnt lgkmcnt(6)
    v_mfma_f32_16x16x32_bf16 v[232:235], v[200:203], v[176:179], v[232:235]
    ds_read_b64_tr_b16 v[196:197], v249 offset:0
    v_mfma_f32_16x16x32_bf16 v[236:239], v[200:203], v[184:187], v[236:239]
    ds_read_b64_tr_b16 v[198:199], v249 offset:2048
    v_mfma_f32_16x16x32_bf16 v[240:243], v[204:207], v[176:179], v[240:243]
    ds_read_b64_tr_b16 v[200:201], v248 offset:4096
    v_mfma_f32_16x16x32_bf16 v[244:247], v[204:207], v[184:187], v[244:247]
    ds_read_b64_tr_b16 v[202:203], v248 offset:6144
    s_waitcnt lgkmcnt(6)
    v_mfma_f32_16x16x32_bf16 v[232:235], v[208:211], v[180:183], v[232:235]
    ds_read_b64_tr_b16 v[204:205], v249 offset:4096
    v_mfma_f32_16x16x32_bf16 v[236:239], v[208:211], v[188:191], v[236:239]
    ds_read_b64_tr_b16 v[206:207], v249 offset:6144
    v_mfma_f32_16x16x32_bf16 v[240:243], v[212:215], v[180:183], v[240:243]
    ds_read_b64_tr_b16 v[208:209], v248 offset:8192
    v_mfma_f32_16x16x32_bf16 v[244:247], v[212:215], v[188:191], v[244:247]
    ds_read_b64_tr_b16 v[210:211], v248 offset:10240
    s_add_u32 s38, s38, 1
    s_branch L_mlp_p2_1049
L_mlp_sw_1045:
    s_mov_b32 s24, s30
    s_mov_b32 s25, s31
    s_mov_b32 s26, s32
    s_mov_b32 s27, s33
    s_mov_b32 s28, s34
    s_mov_b32 s29, s35
    v_mov_b32 v252, v253
    s_mov_b32 s8, s16
    s_mov_b32 s9, s17
    s_mov_b32 s10, s18
    s_mov_b32 s47, 221184
    s_add_u32 s12, s16, 128
    s_addc_u32 s13, s17, 0
    s_mov_b32 s14, s18
    s_add_u32 s16, s16, 221312
    s_addc_u32 s17, s17, 0
    s_branch L_mlp_swb_1046
L_mlp_we_1059:
    s_cmp_ge_u32 s2, 192
    s_cbranch_scc1 L_mlp_web_1060
    v_accvgpr_read_b32 v128, a144
    v_accvgpr_read_b32 v129, a145
    v_accvgpr_read_b32 v130, a146
    v_accvgpr_read_b32 v131, a147
    v_accvgpr_read_b32 v132, a148
    v_accvgpr_read_b32 v133, a149
    s_lshr_b32 s42, s37, 1
    s_mul_i32 s42, s42, 82944
    s_lshr_b32 s40, s2, 5
    s_mul_i32 s40, s40, 192
    s_add_u32 s42, s42, s40
    s_add_u32 s30, s42, 4096
    s_add_u32 s31, s42, 3072
    s_add_u32 s32, s42, 2048
    s_add_u32 s33, s42, 1024
    s_add_u32 s34, s42, 4096
    s_add_u32 s35, s42, 3072
    s_mov_b32 s48, 165888
    s_mov_b32 s49, 497664
    s_mov_b32 s18, 501760
    s_add_u32 s16, s8, 161792
    s_addc_u32 s17, s9, 0
    s_branch L_mlp_web_1060
L_mlp_sig_1051:
    s_cmp_lg_u32 s37, 0
    s_cbranch_scc1 L_mlp_sigb_1053
    v_mov_b32 v255, 1
    s_lshl_b32 s42, s44, 2
    s_mov_b64 exec, 1
    buffer_atomic_add v255, off, s[4:7], s42 offset:64 sc0 sc1
    s_mov_b64 exec, -1
    s_branch L_mlp_sigb_1053
L_mlp_chk_1055:
    s_cmp_lg_u32 s37, 0
    s_cbranch_scc1 L_mlp_chkb_1057
    s_waitcnt vmcnt(8)
    v_readfirstlane_b32 s42, v255
    s_bfe_u32 s42, s42, 0x80000
    s_cmp_lg_u32 s42, 7
    s_cbranch_scc1 L_mlp_chkb_1057
    v_mov_b32 v255, 1
    s_lshl_b32 s42, s44, 2
    s_mov_b64 exec, 1
    buffer_atomic_add v255, off, s[4:7], s42 offset:192 sc1
    s_mov_b64 exec, -1
    s_branch L_mlp_chkb_1057
L_mlp_sig_1052:
    s_cmp_lg_u32 s37, 0
    s_cbranch_scc1 L_mlp_sigb_1054
    v_mov_b32 v255, 256
    s_lshl_b32 s42, s44, 2
    s_mov_b64 exec, 1
    buffer_atomic_add v255, off, s[4:7], s42 offset:64 sc0 sc1
    s_mov_b64 exec, -1
    s_branch L_mlp_sigb_1054
L_mlp_chk_1056:
    s_cmp_lg_u32 s37, 0
    s_cbranch_scc1 L_mlp_chkb_1058
    s_waitcnt vmcnt(8)
    v_readfirstlane_b32 s42, v255
    s_bfe_u32 s42, s42, 0x80008
    s_cmp_lg_u32 s42, 7
    s_cbranch_scc1 L_mlp_chkb_1058
    v_mov_b32 v255, 256
    s_lshl_b32 s42, s44, 2
    s_mov_b64 exec, 1
    buffer_atomic_add v255, off, s[4:7], s42 offset:192 sc1
    s_mov_b64 exec, -1
    s_branch L_mlp_chkb_1058
L_mlp_done_1050:
    s_nop 7
    v_cvt_pk_bf16_f32 v144, v144, v145
    v_cvt_pk_bf16_f32 v145, v146, v147
    v_cvt_pk_bf16_f32 v146, v152, v153
    v_cvt_pk_bf16_f32 v147, v154, v155
    buffer_store_dwordx4 v[144:147], v252, s[20:23], s50 offen offset:0 sc1
    v_cvt_pk_bf16_f32 v148, v148, v149
    v_cvt_pk_bf16_f32 v149, v150, v151
    v_cvt_pk_bf16_f32 v150, v156, v157
    v_cvt_pk_bf16_f32 v151, v158, v159
    buffer_store_dwordx4 v[148:151], v252, s[20:23], s51 offen offset:0 sc1
    v_cvt_pk_bf16_f32 v160, v160, v161
    v_cvt_pk_bf16_f32 v161, v162, v163
    v_cvt_pk_bf16_f32 v162, v168, v169
    v_cvt_pk_bf16_f32 v163, v170, v171
    buffer_store_dwordx4 v[160:163], v252, s[20:23], s50 offen offset:1024 sc1
    v_cvt_pk_bf16_f32 v164, v164, v165
    v_cvt_pk_bf16_f32 v165, v166, v167
    v_cvt_pk_bf16_f32 v166, v172, v173
    v_cvt_pk_bf16_f32 v167, v174, v175
    buffer_store_dwordx4 v[164:167], v252, s[20:23], s51 offen offset:1024 sc1
    s_waitcnt lgkmcnt(0)
    s_load_dwordx2 s[20:21], s[0:1], 64
    s_lshl_b32 s52, s44, 2
    s_add_u32 s52, s52, 64
    s_mov_b32 s58, 1
    s_mov_b32 s59, 0
    s_cmp_lt_u32 s2, 192
    s_cbranch_scc1 L_fin_uni
    s_mov_b32 s50, 16
    s_mov_b32 s51, 7
    s_waitcnt vmcnt(0)
    s_waitcnt lgkmcnt(0)
    s_mov_b32 s22, 256
    s_mov_b32 s23, 0x00020000
    s_barrier
    s_cmp_lg_u32 s37, 0
    s_cbranch_scc1 L_sig_1061
    s_lshl_b32 s56, 1, s50
    v_mov_b32 v251, s56
    v_mov_b32 v252, s56
    s_mov_b64 exec, 1
    buffer_atomic_add v251, off, s[20:23], s52 sc0 sc1
    s_waitcnt vmcnt(0)
    v_readfirstlane_b32 s56, v251
    s_lshr_b32 s56, s56, s50
    s_and_b32 s56, s56, 0xff
    s_cmp_lg_u32 s56, s51
    s_cbranch_scc1 L_sig2_1062
    buffer_atomic_add v252, off, s[20:23], s52 offset:128 sc1
L_sig2_1062:
    s_mov_b64 exec, -1
L_sig_1061:
L_mid_exit:
    s_endpgm
L_code_end:
.section .rodata,"a"
.p2align 6
.amdhsa_kernel recurrent_scan__softmax_full_mha__glu_gated_bilinear__prompt_kernel
  .amdhsa_next_free_vgpr 512
  .amdhsa_next_free_sgpr 96
  .amdhsa_accum_offset 256
  .amdhsa_group_segment_fixed_size 0
  .amdhsa_kernarg_size 80
  .amdhsa_user_sgpr_count 2
  .amdhsa_user_sgpr_kernarg_segment_ptr 1
  .amdhsa_system_sgpr_workgroup_id_x 1
.end_amdhsa_kernel
```
